```python
import torch

def _softmax(x, axis=-1):
    return torch.softmax(x, dim=axis)
def _gelu(x):
    return torch.nn.functional.gelu(x, approximate="tanh")
def _silu(x):
    return torch.nn.functional.silu(x)
def _sigmoid(x):
    return torch.sigmoid(x)
def _layernorm(x, axis=-1, eps=1e-5):
    m = x.mean(dim=axis, keepdim=True)
    v = x.var(dim=axis, keepdim=True, unbiased=False)
    return (x - m) / torch.sqrt(v + eps)
def _scatter_add(tgt, idx, src, axis=0):
    return tgt.clone().index_add_(axis, idx, src)
def _segment_sum(src, seg, n):
    out = torch.zeros((n,) + src.shape[1:], dtype=src.dtype)
    return out.index_add_(0, seg, src)
def _pad(x, pw):
    flat = tuple(v for pair in reversed(pw) for v in pair)
    return torch.nn.functional.pad(x, flat)

kernel_name = 'interleave_layers__linear_attn_block__mixer_token_mlp__prompt'

def setup_inputs():

    _w = (lambda a: (lambda t: t.to(torch.bfloat16) if t.is_floating_point() else t)(torch.as_tensor(a)))
    def _A_setup():
        B, S, D = 1, 2048, 448
        return {
            "x": _w((lambda *s: torch.randn(*s, dtype=torch.bfloat16) * 0.05)(B, S, D)),
            "wqkv": _w((lambda *s: torch.randn(*s, dtype=torch.bfloat16) * 0.1)(D, 3 * D)),
            "wo": _w((lambda *s: torch.randn(*s, dtype=torch.bfloat16) * 0.05)(D, D)),
        }
    _A_in = _A_setup()

    def _B_setup():
        B, S, D, F = 1, 2048, 448, 1792
        return {
            "x": _w((lambda *s: torch.randn(*s, dtype=torch.bfloat16) * 0.05)(B, S, D)),
            "w1": _w((lambda *s: torch.randn(*s, dtype=torch.bfloat16) * 0.8)(S, F) * (S ** -0.5)),
            "b1": _w((lambda *s: torch.randn(*s, dtype=torch.bfloat16) * 12.8)(F) * 0.02),
            "w2": _w((lambda *s: torch.randn(*s, dtype=torch.bfloat16) * 0.4)(F, S) * (F ** -0.5)),
            "b2": _w((lambda *s: torch.randn(*s, dtype=torch.bfloat16) * 6.4)(S) * 0.02),
        }
    _B_in = _B_setup()

    return {
        "A_x": _A_in["x"],
        "A_wqkv": _A_in["wqkv"],
        "A_wo": _A_in["wo"],
        "B_x": _B_in["x"],
        "B_w1": _B_in["w1"],
        "B_b1": _B_in["b1"],
        "B_w2": _B_in["w2"],
        "B_b2": _B_in["b2"],
    }

def reference(A_x, A_wqkv, A_wo, B_x, B_w1, B_b1, B_w2, B_b2):
    def _A_ref(x, wqkv, wo):
        B, S, D = x.shape
        H = 16; Dh = D // H
        qkv = (lambda x, *d: x.permute(*d))((x @ wqkv).reshape(B, S, 3, H, Dh), 2, 0, 3, 1, 4)
        q, k, v = qkv[0], qkv[1], qkv[2]
        phi = lambda t: torch.where(t > 0, t + 1, torch.exp(t)) + 1e-6
        pq, pk = phi(q), phi(k)
        kv = torch.einsum("bhsd,bhse->bhde", pk, v)
        z = torch.einsum("bhsd->bhd", pk)
        num = torch.einsum("bhqd,bhde->bhqe", pq, kv)
        den = torch.einsum("bhqd,bhd->bhq", pq, z)[..., None] + 1e-6
        o = num / den
        return (lambda x, *d: x.permute(*d))(o, 0, 2, 1, 3).reshape(B, S, D) @ wo

    def _B_ref(x, w1, b1, w2, b2):
        B, S, D = x.shape
        h = _layernorm(x, axis=-1)
        u = torch.einsum("bsd,sf->bdf", h, w1) + b1
        u = _gelu(u)
        y = torch.einsum("bdf,fs->bds", u, w2) + b2
        return (lambda x, *d: x.permute(*d))(y, 0, 2, 1)

    x = A_x
    x = x + _A_ref(_layernorm(x, axis=-1), A_wqkv, A_wo)
    x = x + _B_ref(_layernorm(x, axis=-1), B_w1, B_b1, B_w2, B_b2)
    x = x + _A_ref(_layernorm(x, axis=-1), A_wqkv, A_wo)
    x = x + _B_ref(_layernorm(x, axis=-1), B_w1, B_b1, B_w2, B_b2)
    return x
```

```asm
; @launch grid=(256,1,1) block=(256,1,1) lds=163840
.amdgcn_target "amdgcn-amd-amdhsa--gfx950"
.text
.globl interleave_layers__linear_attn_block__mixer_token_mlp__prompt_kernel
.p2align 8
.type interleave_layers__linear_attn_block__mixer_token_mlp__prompt_kernel,@function
interleave_layers__linear_attn_block__mixer_token_mlp__prompt_kernel:

    s_cmp_ge_u32 s2, 256
    s_cbranch_scc1 L_end

    s_load_dwordx16 s[72:87], s[0:1], 0
    s_load_dwordx4 s[88:91], s[0:1], 64
    s_load_dwordx2 s[92:93], s[0:1], 80
    v_lshrrev_b32 v2, 6, v0
    v_and_b32 v244, 63, v0
    v_readfirstlane_b32 s3, v2
    v_lshrrev_b32 v242, 5, v244
    v_and_b32 v243, 31, v244
    v_lshlrev_b32 v240, 4, v244
    v_lshlrev_b32 v245, 3, v244
    v_add_u32 v241, 0x1000, v240
    s_and_b32 s56, s2, 7
    s_lshr_b32 s57, s2, 3
    s_lshr_b32 s58, s56, 1
    s_and_b32 s59, s56, 1
    s_lshl_b32 s44, s56, 1
    s_lshr_b32 s60, s57, 4
    s_add_u32 s44, s44, s60
    s_and_b32 s45, s57, 15
    s_mul_i32 s60, s57, 43
    s_lshr_b32 s60, s60, 7
    s_mul_i32 s63, s60, 3
    s_sub_u32 s63, s57, s63
    s_lshl_b32 s61, s59, 2
    s_add_u32 s99, s63, s61
    s_add_u32 s62, s61, s57
    s_sub_u32 s62, s62, 24
    s_cmp_ge_u32 s57, 24
    s_cselect_b32 s60, s62, s60
    s_cselect_b32 s99, 3, s99
    s_cmp_ge_u32 s57, 28
    s_cselect_b32 s60, 8, s60
    s_mul_i32 s61, s57, 37
    s_lshr_b32 s61, s61, 8
    s_mul_i32 s62, s61, 7
    s_sub_u32 s46, s57, s62
    s_lshl_b32 s47, s56, 2
    s_add_u32 s47, s47, s61
    s_getreg_b32 s101, hwreg(HW_REG_XCC_ID)
    s_and_b32 s101, s101, 15
    s_min_u32 s101, s101, 9
    s_mul_i32 s101, s101, 6
    s_mov_b32 s100, 0
    s_mul_i32 s48, s58, 7
    s_add_u32 s48, s48, s60
    s_mov_b32 s49, s60
    s_mov_b32 s50, 0
    s_mov_b32 s51, 0
    s_mov_b32 s52, 1500000
    s_lshr_b32 s53, s3, 1
    s_and_b32 s54, s3, 1

    s_getpc_b64 s[94:95]
CWM_1:
    s_sub_u32 s94, s94, CWM_1-interleave_layers__linear_attn_block__mixer_token_mlp__prompt_kernel
    s_subb_u32 s95, s95, 0
    s_lshr_b32 s58, s2, 3
    s_lshl_b32 s58, s58, 2
    s_add_u32 s58, s58, s3
    s_mul_i32 s58, s58, 640
    v_min_u32 v2, 4, v244
    v_lshlrev_b32 v2, 7, v2
    v_add_u32_e64 v2, s58, v2
    s_mov_b32 s58, L_codeend-interleave_layers__linear_attn_block__mixer_token_mlp__prompt_kernel-4
    v_min_u32 v2, s58, v2
    v_mov_b32 v3, s95
    v_add_co_u32 v2, vcc, s94, v2
    s_nop 1
    v_addc_co_u32 v3, vcc, 0, v3, vcc
    global_load_dword v251, v[2:3], off

    s_lshl_b32 s56, s2, 2
    s_add_u32 s56, s56, s3
    s_mul_i32 s57, s56, 1280
    s_mul_i32 s56, s56, 1792
    v_min_u32 v4, 9, v244
    v_lshlrev_b32 v4, 7, v4
    v_min_u32 v5, 13, v244
    v_lshlrev_b32 v5, 7, v5

    s_waitcnt lgkmcnt(0)
    s_mov_b32 s4, s72
    s_mov_b32 s5, s73
    s_mov_b32 s6, 1835008
    s_mov_b32 s7, 0x00020000
    buffer_load_dword v234, v5, s[4:7], s56 offen
    s_mov_b32 s8, s74
    s_mov_b32 s9, s75
    s_mov_b32 s10, 1204224
    s_mov_b32 s11, 0x00020000
    buffer_load_dword v234, v4, s[8:11], s57 offen
    s_mov_b32 s36, s92
    s_mov_b32 s37, s93
    s_mov_b32 s38, 268435456
    s_mov_b32 s39, 0x00020000
    s_mov_b32 s12, s76
    s_mov_b32 s13, s77
    s_mov_b32 s14, 401408
    s_mov_b32 s15, 0x00020000
    s_mov_b32 s16, s80
    s_mov_b32 s17, s81
    s_mov_b32 s18, 7340032
    s_mov_b32 s19, 0x00020000
    s_mov_b32 s24, s82
    s_mov_b32 s25, s83
    s_mov_b32 s26, 3584
    s_mov_b32 s27, 0x00020000
    s_mov_b32 s20, s84
    s_mov_b32 s21, s85
    s_mov_b32 s22, 7340032
    s_mov_b32 s23, 0x00020000
    s_mov_b32 s28, s86
    s_mov_b32 s29, s87
    s_mov_b32 s30, 4096
    s_mov_b32 s31, 0x00020000
    s_mov_b32 s32, s88
    s_mov_b32 s33, s89
    s_mov_b32 s34, 1835008
    s_mov_b32 s35, 0x00020000
    s_mov_b32 s40, s90
    s_mov_b32 s41, s91
    s_mov_b32 s42, 256
    s_mov_b32 s43, 0x00020000
L_iter:
    s_cmp_eq_u32 s50, 0
    s_cbranch_scc0 A1_2_it1

    v_lshrrev_b32_e64 v2, 3, v244
    v_mul_u32_u24 v2, 896, v2
    v_and_b32 v3, 7, v244
    v_lshrrev_b32 v5, 4, v244
    v_xor_b32_e64 v3, v3, v5
    v_lshl_add_u32 v228, v3, 4, v2
    v_xor_b32 v229, 64, v228
    s_lshl_b32 s66, s44, 2
    s_add_u32 s66, s66, s3
    s_mul_i32 s66, s66, 28672
    s_lshl_b32 s55, s53, 16
    s_lshl_b32 s58, s54, 14
    s_add_u32 s55, s55, s58

    s_add_u32 m0, s55, 32768
    s_add_u32 s58, s66, 0
    s_nop 0
    buffer_load_dwordx4 v228, s[4:7], s58 offen lds
    s_add_u32 m0, s55, 33792
    s_add_u32 s58, s66, 128
    buffer_load_dwordx4 v228, s[4:7], s58 offen lds
    s_add_u32 m0, s55, 34816
    s_add_u32 s58, s66, 256
    buffer_load_dwordx4 v228, s[4:7], s58 offen lds
    s_add_u32 m0, s55, 35840
    s_add_u32 s58, s66, 384
    buffer_load_dwordx4 v228, s[4:7], s58 offen lds
    s_add_u32 m0, s55, 36864
    s_add_u32 s58, s66, 7168
    buffer_load_dwordx4 v229, s[4:7], s58 offen lds
    s_add_u32 m0, s55, 37888
    s_add_u32 s58, s66, 7296
    buffer_load_dwordx4 v229, s[4:7], s58 offen lds
    s_add_u32 m0, s55, 38912
    s_add_u32 s58, s66, 7424
    buffer_load_dwordx4 v229, s[4:7], s58 offen lds
    s_add_u32 m0, s55, 39936
    s_add_u32 s58, s66, 7552
    buffer_load_dwordx4 v229, s[4:7], s58 offen lds
    s_add_u32 m0, s55, 40960
    s_add_u32 s58, s66, 14336
    buffer_load_dwordx4 v228, s[4:7], s58 offen lds
    s_add_u32 m0, s55, 41984
    s_add_u32 s58, s66, 14464
    buffer_load_dwordx4 v228, s[4:7], s58 offen lds
    s_add_u32 m0, s55, 43008
    s_add_u32 s58, s66, 14592
    buffer_load_dwordx4 v228, s[4:7], s58 offen lds
    s_add_u32 m0, s55, 44032
    s_add_u32 s58, s66, 14720
    buffer_load_dwordx4 v228, s[4:7], s58 offen lds
    s_add_u32 m0, s55, 45056
    s_add_u32 s58, s66, 21504
    buffer_load_dwordx4 v229, s[4:7], s58 offen lds
    s_add_u32 m0, s55, 46080
    s_add_u32 s58, s66, 21632
    buffer_load_dwordx4 v229, s[4:7], s58 offen lds
    s_add_u32 m0, s55, 47104
    s_add_u32 s58, s66, 21760
    buffer_load_dwordx4 v229, s[4:7], s58 offen lds
    s_add_u32 m0, s55, 48128
    s_add_u32 s58, s66, 21888
    buffer_load_dwordx4 v229, s[4:7], s58 offen lds

    v_lshrrev_b32_e64 v1, 2, v244
    v_mul_u32_u24 v1, 2688, v1
    v_and_b32_e64 v5, 3, v244
    v_lshl_add_u32 v1, v5, 4, v1
    s_mul_i32 s64, s45, 56
    s_and_b32 s64, s64, 0xfff0
    s_mul_i32 s65, s3, 43008
    s_add_u32 s65, s65, s64
    s_mul_i32 s58, s53, 43008
    s_add_u32 s64, s64, s58
    s_mul_i32 s58, s54, 896
    s_add_u32 s64, s64, s58
    s_lshl_b32 s67, s3, 10

    s_add_u32 m0, s67, 0
    s_add_u32 s58, s64, 896
    buffer_load_dwordx4 v1, s[8:11], s58 offen lds
    s_add_u32 m0, s67, 4096
    s_add_u32 s58, s64, 86912
    buffer_load_dwordx4 v1, s[8:11], s58 offen lds
    s_add_u32 m0, s67, 8192
    s_add_u32 s58, s64, 172928
    buffer_load_dwordx4 v1, s[8:11], s58 offen lds
    s_add_u32 m0, s67, 12288
    s_add_u32 s58, s64, 258944
    buffer_load_dwordx4 v1, s[8:11], s58 offen lds
    s_add_u32 m0, s67, 16384
    s_add_u32 s58, s64, 344960
    buffer_load_dwordx4 v1, s[8:11], s58 offen lds
    s_add_u32 m0, s67, 20480
    s_add_u32 s58, s64, 430976
    buffer_load_dwordx4 v1, s[8:11], s58 offen lds
    s_add_u32 m0, s67, 24576
    s_add_u32 s58, s64, 516992
    buffer_load_dwordx4 v1, s[8:11], s58 offen lds
    s_add_u32 m0, s67, 28672
    s_add_u32 s58, s64, 603008
    buffer_load_dwordx4 v1, s[8:11], s58 offen lds

    s_lshr_b32 s68, 0xc5ab, s45
    s_and_b32 s68, s68, 1
    s_lshl_b32 s56, 1, s45
    s_sub_u32 s56, s56, 1
    s_and_b32 s56, s56, 0xc5ab
    s_bcnt1_i32_b32 s56, s56
    s_lshl_b32 s56, s56, 4
    s_add_u32 s56, s56, s44
    s_lshl_b32 s56, s56, 2
    s_add_u32 s56, s56, s3
    s_lshl_b32 s70, s56, 13
    s_cmp_ge_u32 s70, 4685824
    s_cselect_b32 s68, 0, s68
    s_cmp_eq_u32 s68, 0
    s_cselect_b32 s70, 0x20000000, s70
    v_mov_b32 v236, -1
    v_mov_b32 v237, -1
    v_mov_b32 v238, -1
    v_mov_b32 v239, -1

    v_lshrrev_b32 v2, 3, v244
    v_mul_u32_u24 v246, 3584, v2
    v_lshrrev_b32 v2, 4, v244
    v_and_b32 v2, 1, v2
    v_lshlrev_b32 v2, 2, v2
    v_and_b32 v3, 7, v244
    v_xor_b32_e64 v2, v2, v3
    v_lshl_add_u32 v246, v2, 4, v246

    v_lshrrev_b32_e64 v2, 3, v244
    v_mul_u32_u24 v247, 4096, v2
    v_lshrrev_b32 v2, 4, v244
    v_and_b32 v2, 1, v2
    v_lshlrev_b32 v2, 2, v2
    v_and_b32 v3, 7, v244
    v_xor_b32_e64 v2, v2, v3
    v_lshl_add_u32 v247, v2, 4, v247

    v_lshrrev_b32_e64 v2, 3, v244
    v_mul_u32_u24 v250, 896, v2
    v_lshrrev_b32 v2, 4, v244
    v_and_b32 v2, 1, v2
    v_lshlrev_b32 v2, 2, v2
    v_and_b32 v3, 7, v244
    v_xor_b32_e64 v2, v2, v3
    v_lshl_add_u32 v250, v2, 4, v250

    s_mul_i32 s72, s3, 1835008
    s_min_u32 s58, s48, 27
    s_lshl_b32 s58, s58, 7
    s_add_u32 s72, s72, s58
    s_mul_i32 s73, s3, 1835008
    s_min_u32 s58, s47, 31
    s_lshl_b32 s58, s58, 7
    s_add_u32 s73, s73, s58

    s_mul_i32 s74, s53, 200704
    s_mul_i32 s58, s54, 7168
    s_add_u32 s74, s74, s58
    s_lshl_b32 s58, s46, 7
    s_add_u32 s74, s74, s58
    s_lshl_b32 s75, s53, 16
    s_lshl_b32 s58, s54, 10
    s_add_u32 s75, s75, s58

    v_lshrrev_b32 v2, 2, v244
    v_and_b32 v2, 3, v2
    v_lshrrev_b32 v3, 4, v244
    v_and_b32 v3, 1, v3
    v_lshlrev_b32 v3, 2, v3
    v_and_b32 v10, 3, v244
    v_add_u32 v3, v3, v10
    s_and_b32 s56, s45, 1
    v_add_u32 v3, s56, v3
    v_and_b32 v3, 7, v3
    v_lshlrev_b32_e64 v3, 3, v3
    v_lshl_add_u32 v4, v2, 6, v3
    v_lshl_add_u32 v4, v242, 9, v4
    v_add_u32 v5, 0x10000, v4
    v_add_u32 v6, 0x20000, v4
    v_add_u32 v7, 256, v4
    v_add_u32 v8, 256, v5
    v_add_u32 v9, 256, v6
    s_lshl_b32 s56, s3, 8
    s_add_u32 s56, s56, 160768
    v_lshlrev_b32 v11, 2, v244
    v_add_u32 v11, s56, v11
    v_lshlrev_b32 v15, 4, v242
    v_add_u32 v15, s56, v15

    v_lshrrev_b32 v2, 3, v243
    v_lshlrev_b32 v2, 12, v2
    v_and_b32 v3, 7, v243
    v_lshl_add_u32 v2, v3, 7, v2
    v_add_u32 v2, s55, v2
    v_lshrrev_b32 v3, 1, v243
    v_and_b32 v3, 7, v3
    v_xor_b32 v3, v3, v242

    v_xor_b32_e64 v10, 0, v3
    v_lshl_add_u32 v224, v10, 4, v2
    v_xor_b32_e64 v10, 2, v3
    v_lshl_add_u32 v225, v10, 4, v2
    v_xor_b32_e64 v10, 4, v3
    v_lshl_add_u32 v226, v10, 4, v2
    v_xor_b32_e64 v10, 6, v3
    v_lshl_add_u32 v227, v10, 4, v2

    v_mov_b32 v230, 0
    v_mov_b32 v231, 0
    v_mov_b32 v232, 0
    v_mov_b32 v233, 0
    v_mov_b32 v248, 0
    v_mov_b32 v249, 0
    v_mov_b32 v14, 0x3f803f80
    v_lshlrev_b32_e64 v235, 7, v244
    v_min_u32 v254, 0x780, v235
    s_lshr_b32 s69, s2, 2
    s_lshl_b32 s69, s69, 13
    s_cmp_eq_u32 s3, 3
    s_cselect_b32 s69, s69, 0x1000000

    buffer_load_dword v234, v235, s[12:15], s69 offen
    s_waitcnt vmcnt(9) lgkmcnt(0)
    ds_read_b128 v[64:67], v224 offset:32768
    ds_read_b128 v[68:71], v225 offset:32768
    ds_read_b128 v[72:75], v226 offset:32768
    ds_read_b128 v[76:79], v227 offset:32768
    ds_read_b128 v[80:83], v224 offset:33792
    ds_read_b128 v[84:87], v225 offset:33792
    ds_read_b128 v[88:91], v226 offset:33792
    ds_read_b128 v[92:95], v227 offset:33792
    ds_read_b128 v[96:99], v224 offset:34816
    ds_read_b128 v[100:103], v225 offset:34816
    ds_read_b128 v[104:107], v226 offset:34816
    ds_read_b128 v[108:111], v227 offset:34816
    s_waitcnt lgkmcnt(4)
    ds_read_b128 v[112:115], v224 offset:35840
    ds_read_b128 v[116:119], v225 offset:35840
    ds_read_b128 v[120:123], v226 offset:35840
    ds_read_b128 v[124:127], v227 offset:35840
    s_waitcnt lgkmcnt(0)
    buffer_store_dwordx4 v[236:239], v240, s[36:39], s70 offen offset:0 sc1
    v_dot2c_f32_bf16 v230, v64, v14
    v_dot2c_f32_bf16 v232, v64, v64
    v_dot2c_f32_bf16 v231, v65, v14
    v_dot2c_f32_bf16 v233, v65, v65
    v_dot2c_f32_bf16 v230, v66, v14
    v_dot2c_f32_bf16 v232, v66, v66
    buffer_store_dwordx4 v[236:239], v240, s[36:39], s70 offen offset:1024 sc1
    v_dot2c_f32_bf16 v231, v67, v14
    v_dot2c_f32_bf16 v233, v67, v67
    v_dot2c_f32_bf16 v230, v68, v14
    v_dot2c_f32_bf16 v232, v68, v68
    v_dot2c_f32_bf16 v231, v69, v14
    v_dot2c_f32_bf16 v233, v69, v69
    buffer_store_dwordx4 v[236:239], v240, s[36:39], s70 offen offset:2048 sc1
    v_dot2c_f32_bf16 v230, v70, v14
    v_dot2c_f32_bf16 v232, v70, v70
    v_dot2c_f32_bf16 v231, v71, v14
    v_dot2c_f32_bf16 v233, v71, v71
    v_dot2c_f32_bf16 v230, v72, v14
    v_dot2c_f32_bf16 v232, v72, v72
    buffer_store_dwordx4 v[236:239], v240, s[36:39], s70 offen offset:3072 sc1
    v_dot2c_f32_bf16 v231, v73, v14
    v_dot2c_f32_bf16 v233, v73, v73
    v_dot2c_f32_bf16 v230, v74, v14
    v_dot2c_f32_bf16 v232, v74, v74
    v_dot2c_f32_bf16 v231, v75, v14
    v_dot2c_f32_bf16 v233, v75, v75
    buffer_store_dwordx4 v[236:239], v241, s[36:39], s70 offen offset:0 sc1
    v_dot2c_f32_bf16 v230, v76, v14
    v_dot2c_f32_bf16 v232, v76, v76
    v_dot2c_f32_bf16 v231, v77, v14
    v_dot2c_f32_bf16 v233, v77, v77
    v_dot2c_f32_bf16 v230, v78, v14
    v_dot2c_f32_bf16 v232, v78, v78
    buffer_store_dwordx4 v[236:239], v241, s[36:39], s70 offen offset:1024 sc1
    v_dot2c_f32_bf16 v231, v79, v14
    v_dot2c_f32_bf16 v233, v79, v79
    v_dot2c_f32_bf16 v230, v80, v14
    v_dot2c_f32_bf16 v232, v80, v80
    v_dot2c_f32_bf16 v231, v81, v14
    v_dot2c_f32_bf16 v233, v81, v81
    buffer_store_dwordx4 v[236:239], v241, s[36:39], s70 offen offset:2048 sc1
    v_dot2c_f32_bf16 v230, v82, v14
    v_dot2c_f32_bf16 v232, v82, v82
    v_dot2c_f32_bf16 v231, v83, v14
    v_dot2c_f32_bf16 v233, v83, v83
    v_dot2c_f32_bf16 v230, v84, v14
    v_dot2c_f32_bf16 v232, v84, v84
    buffer_store_dwordx4 v[236:239], v241, s[36:39], s70 offen offset:3072 sc1
    v_dot2c_f32_bf16 v231, v85, v14
    v_dot2c_f32_bf16 v233, v85, v85
    v_dot2c_f32_bf16 v230, v86, v14
    v_dot2c_f32_bf16 v232, v86, v86
    v_dot2c_f32_bf16 v231, v87, v14
    v_dot2c_f32_bf16 v233, v87, v87
    s_add_u32 m0, s55, 32768
    s_add_u32 s58, s66, 512
    buffer_load_dwordx4 v228, s[4:7], s58 offen lds
    v_dot2c_f32_bf16 v230, v88, v14
    v_dot2c_f32_bf16 v232, v88, v88
    v_dot2c_f32_bf16 v231, v89, v14
    v_dot2c_f32_bf16 v233, v89, v89
    v_dot2c_f32_bf16 v230, v90, v14
    v_dot2c_f32_bf16 v232, v90, v90
    s_add_u32 m0, s55, 33792
    s_add_u32 s58, s66, 640
    buffer_load_dwordx4 v228, s[4:7], s58 offen lds
    v_dot2c_f32_bf16 v231, v91, v14
    v_dot2c_f32_bf16 v233, v91, v91
    v_dot2c_f32_bf16 v230, v92, v14
    v_dot2c_f32_bf16 v232, v92, v92
    v_dot2c_f32_bf16 v231, v93, v14
    v_dot2c_f32_bf16 v233, v93, v93
    s_add_u32 m0, s55, 34816
    s_add_u32 s58, s66, 768
    buffer_load_dwordx4 v228, s[4:7], s58 offen lds
    v_dot2c_f32_bf16 v230, v94, v14
    v_dot2c_f32_bf16 v232, v94, v94
    v_dot2c_f32_bf16 v231, v95, v14
    v_dot2c_f32_bf16 v233, v95, v95
    v_dot2c_f32_bf16 v230, v96, v14
    v_dot2c_f32_bf16 v232, v96, v96
    s_add_u32 m0, s55, 36864
    s_add_u32 s58, s66, 7680
    buffer_load_dwordx4 v229, s[4:7], s58 offen lds
    v_dot2c_f32_bf16 v231, v97, v14
    v_dot2c_f32_bf16 v233, v97, v97
    v_dot2c_f32_bf16 v230, v98, v14
    v_dot2c_f32_bf16 v232, v98, v98
    v_dot2c_f32_bf16 v231, v99, v14
    v_dot2c_f32_bf16 v233, v99, v99
    s_add_u32 m0, s55, 37888
    s_add_u32 s58, s66, 7808
    buffer_load_dwordx4 v229, s[4:7], s58 offen lds
    v_dot2c_f32_bf16 v230, v100, v14
    v_dot2c_f32_bf16 v232, v100, v100
    v_dot2c_f32_bf16 v231, v101, v14
    v_dot2c_f32_bf16 v233, v101, v101
    v_dot2c_f32_bf16 v230, v102, v14
    v_dot2c_f32_bf16 v232, v102, v102
    s_add_u32 m0, s55, 38912
    s_add_u32 s58, s66, 7936
    buffer_load_dwordx4 v229, s[4:7], s58 offen lds
    v_dot2c_f32_bf16 v231, v103, v14
    v_dot2c_f32_bf16 v233, v103, v103
    v_dot2c_f32_bf16 v230, v104, v14
    v_dot2c_f32_bf16 v232, v104, v104
    v_dot2c_f32_bf16 v231, v105, v14
    v_dot2c_f32_bf16 v233, v105, v105
    s_add_u32 m0, s55, 40960
    s_add_u32 s58, s66, 14848
    buffer_load_dwordx4 v228, s[4:7], s58 offen lds
    v_dot2c_f32_bf16 v230, v106, v14
    v_dot2c_f32_bf16 v232, v106, v106
    v_dot2c_f32_bf16 v231, v107, v14
    v_dot2c_f32_bf16 v233, v107, v107
    v_dot2c_f32_bf16 v230, v108, v14
    v_dot2c_f32_bf16 v232, v108, v108
    s_add_u32 m0, s55, 41984
    s_add_u32 s58, s66, 14976
    buffer_load_dwordx4 v228, s[4:7], s58 offen lds
    v_dot2c_f32_bf16 v231, v109, v14
    v_dot2c_f32_bf16 v233, v109, v109
    v_dot2c_f32_bf16 v230, v110, v14
    v_dot2c_f32_bf16 v232, v110, v110
    v_dot2c_f32_bf16 v231, v111, v14
    v_dot2c_f32_bf16 v233, v111, v111
    s_add_u32 m0, s55, 43008
    s_add_u32 s58, s66, 15104
    buffer_load_dwordx4 v228, s[4:7], s58 offen lds
    v_dot2c_f32_bf16 v230, v112, v14
    v_dot2c_f32_bf16 v232, v112, v112
    v_dot2c_f32_bf16 v231, v113, v14
    v_dot2c_f32_bf16 v233, v113, v113
    v_dot2c_f32_bf16 v230, v114, v14
    v_dot2c_f32_bf16 v232, v114, v114
    s_add_u32 m0, s55, 45056
    s_add_u32 s58, s66, 22016
    buffer_load_dwordx4 v229, s[4:7], s58 offen lds
    v_dot2c_f32_bf16 v231, v115, v14
    v_dot2c_f32_bf16 v233, v115, v115
    v_dot2c_f32_bf16 v230, v116, v14
    v_dot2c_f32_bf16 v232, v116, v116
    v_dot2c_f32_bf16 v231, v117, v14
    v_dot2c_f32_bf16 v233, v117, v117
    s_add_u32 m0, s55, 46080
    s_add_u32 s58, s66, 22144
    buffer_load_dwordx4 v229, s[4:7], s58 offen lds
    v_dot2c_f32_bf16 v230, v118, v14
    v_dot2c_f32_bf16 v232, v118, v118
    v_dot2c_f32_bf16 v231, v119, v14
    v_dot2c_f32_bf16 v233, v119, v119
    v_dot2c_f32_bf16 v230, v120, v14
    v_dot2c_f32_bf16 v232, v120, v120
    s_add_u32 m0, s55, 47104
    s_add_u32 s58, s66, 22272
    buffer_load_dwordx4 v229, s[4:7], s58 offen lds
    v_dot2c_f32_bf16 v231, v121, v14
    v_dot2c_f32_bf16 v233, v121, v121
    v_dot2c_f32_bf16 v230, v122, v14
    v_dot2c_f32_bf16 v232, v122, v122
    v_dot2c_f32_bf16 v231, v123, v14
    v_dot2c_f32_bf16 v233, v123, v123
    v_dot2c_f32_bf16 v230, v124, v14
    v_dot2c_f32_bf16 v232, v124, v124
    v_dot2c_f32_bf16 v231, v125, v14
    v_dot2c_f32_bf16 v233, v125, v125
    v_dot2c_f32_bf16 v230, v126, v14
    v_dot2c_f32_bf16 v232, v126, v126
    v_dot2c_f32_bf16 v231, v127, v14
    v_dot2c_f32_bf16 v233, v127, v127

    s_waitcnt vmcnt(12)
    s_barrier
    s_cmp_eq_u32 s3, 0
    s_cbranch_scc1 A1f_3_sg
A1f_3_sgr:

    ds_read_b64_tr_b16 v[176:177], v4 offset:0
    ds_read_b64_tr_b16 v[178:179], v7 offset:0
    ds_read_b64_tr_b16 v[180:181], v4 offset:1024
    ds_read_b64_tr_b16 v[182:183], v7 offset:1024
    ds_read_b64_tr_b16 v[184:185], v4 offset:2048
    ds_read_b64_tr_b16 v[186:187], v7 offset:2048
    ds_read_b64_tr_b16 v[188:189], v4 offset:3072
    ds_read_b64_tr_b16 v[190:191], v7 offset:3072
    ds_read_b64_tr_b16 v[192:193], v4 offset:4096
    ds_read_b64_tr_b16 v[194:195], v7 offset:4096
    ds_read_b64_tr_b16 v[196:197], v4 offset:5120
    ds_read_b64_tr_b16 v[198:199], v7 offset:5120
    s_waitcnt lgkmcnt(8)
    s_nop 0
    v_mfma_f32_32x32x16_bf16 v[32:47], v[64:67], v[176:179], 0
    ds_read_b64_tr_b16 v[200:201], v4 offset:6144
    ds_read_b64_tr_b16 v[202:203], v7 offset:6144
    v_mfma_f32_32x32x16_bf16 v[48:63], v[64:67], v[180:183], 0
    ds_read_b64_tr_b16 v[204:205], v4 offset:7168
    ds_read_b64_tr_b16 v[206:207], v7 offset:7168
    s_add_u32 m0, s67, 65536
    s_add_u32 s58, s64, 689024
    buffer_load_dwordx4 v1, s[8:11], s58 offen lds
    s_waitcnt lgkmcnt(8)
    s_nop 0
    v_mfma_f32_32x32x16_bf16 v[32:47], v[68:71], v[184:187], v[32:47]
    ds_read_b64_tr_b16 v[176:177], v4 offset:8192
    ds_read_b64_tr_b16 v[178:179], v7 offset:8192
    v_mfma_f32_32x32x16_bf16 v[48:63], v[68:71], v[188:191], v[48:63]
    ds_read_b64_tr_b16 v[180:181], v4 offset:9216
    ds_read_b64_tr_b16 v[182:183], v7 offset:9216
    s_add_u32 m0, s67, 69632
    s_add_u32 s58, s64, 775040
    buffer_load_dwordx4 v1, s[8:11], s58 offen lds
    s_waitcnt lgkmcnt(8)
    s_nop 0
    v_mfma_f32_32x32x16_bf16 v[32:47], v[72:75], v[192:195], v[32:47]
    ds_read_b64_tr_b16 v[184:185], v4 offset:10240
    ds_read_b64_tr_b16 v[186:187], v7 offset:10240
    v_mfma_f32_32x32x16_bf16 v[48:63], v[72:75], v[196:199], v[48:63]
    ds_read_b64_tr_b16 v[188:189], v4 offset:11264
    ds_read_b64_tr_b16 v[190:191], v7 offset:11264
    s_add_u32 m0, s67, 73728
    s_add_u32 s58, s64, 861056
    buffer_load_dwordx4 v1, s[8:11], s58 offen lds
    s_waitcnt lgkmcnt(8)
    s_nop 0
    v_mfma_f32_32x32x16_bf16 v[32:47], v[76:79], v[200:203], v[32:47]
    ds_read_b64_tr_b16 v[192:193], v4 offset:12288
    ds_read_b64_tr_b16 v[194:195], v7 offset:12288
    v_mfma_f32_32x32x16_bf16 v[48:63], v[76:79], v[204:207], v[48:63]
    ds_read_b64_tr_b16 v[196:197], v4 offset:13312
    ds_read_b64_tr_b16 v[198:199], v7 offset:13312
    s_add_u32 m0, s67, 77824
    s_add_u32 s58, s64, 947072
    buffer_load_dwordx4 v1, s[8:11], s58 offen lds
    s_waitcnt lgkmcnt(8)
    s_nop 0
    v_mfma_f32_32x32x16_bf16 v[32:47], v[80:83], v[176:179], v[32:47]
    ds_read_b64_tr_b16 v[200:201], v4 offset:14336
    ds_read_b64_tr_b16 v[202:203], v7 offset:14336
    v_mfma_f32_32x32x16_bf16 v[48:63], v[80:83], v[180:183], v[48:63]
    ds_read_b64_tr_b16 v[204:205], v4 offset:15360
    ds_read_b64_tr_b16 v[206:207], v7 offset:15360
    s_add_u32 m0, s67, 81920
    s_add_u32 s58, s64, 1033088
    buffer_load_dwordx4 v1, s[8:11], s58 offen lds
    s_waitcnt lgkmcnt(8)
    s_nop 0
    v_mfma_f32_32x32x16_bf16 v[32:47], v[84:87], v[184:187], v[32:47]
    ds_read_b64_tr_b16 v[176:177], v4 offset:16384
    ds_read_b64_tr_b16 v[178:179], v7 offset:16384
    v_mfma_f32_32x32x16_bf16 v[48:63], v[84:87], v[188:191], v[48:63]
    ds_read_b64_tr_b16 v[180:181], v4 offset:17408
    ds_read_b64_tr_b16 v[182:183], v7 offset:17408
    s_add_u32 m0, s67, 86016
    s_add_u32 s58, s64, 1119104
    buffer_load_dwordx4 v1, s[8:11], s58 offen lds
    s_waitcnt lgkmcnt(8)
    s_nop 0
    v_mfma_f32_32x32x16_bf16 v[32:47], v[88:91], v[192:195], v[32:47]
    ds_read_b64_tr_b16 v[184:185], v4 offset:18432
    ds_read_b64_tr_b16 v[186:187], v7 offset:18432
    v_mfma_f32_32x32x16_bf16 v[48:63], v[88:91], v[196:199], v[48:63]
    ds_read_b64_tr_b16 v[188:189], v4 offset:19456
    ds_read_b64_tr_b16 v[190:191], v7 offset:19456
    s_add_u32 m0, s67, 90112
    s_add_u32 s58, s65, 0
    buffer_load_dwordx4 v1, s[8:11], s58 offen lds
    s_waitcnt lgkmcnt(8)
    v_mfma_f32_32x32x16_bf16 v[32:47], v[92:95], v[200:203], v[32:47]
    ds_read_b64_tr_b16 v[192:193], v4 offset:20480
    ds_read_b64_tr_b16 v[194:195], v7 offset:20480
    v_mfma_f32_32x32x16_bf16 v[48:63], v[92:95], v[204:207], v[48:63]
    ds_read_b64_tr_b16 v[196:197], v4 offset:21504
    ds_read_b64_tr_b16 v[198:199], v7 offset:21504
    s_add_u32 m0, s67, 94208
    s_add_u32 s58, s65, 172032
    buffer_load_dwordx4 v1, s[8:11], s58 offen lds
    s_waitcnt lgkmcnt(8)
    s_nop 0
    v_mfma_f32_32x32x16_bf16 v[32:47], v[96:99], v[176:179], v[32:47]
    ds_read_b64_tr_b16 v[200:201], v4 offset:22528
    ds_read_b64_tr_b16 v[202:203], v7 offset:22528
    v_mfma_f32_32x32x16_bf16 v[48:63], v[96:99], v[180:183], v[48:63]
    ds_read_b64_tr_b16 v[204:205], v4 offset:23552
    ds_read_b64_tr_b16 v[206:207], v7 offset:23552
    s_add_u32 m0, s67, 131072
    s_add_u32 s58, s65, 344064
    buffer_load_dwordx4 v1, s[8:11], s58 offen lds
    s_waitcnt lgkmcnt(8)
    s_nop 0
    v_mfma_f32_32x32x16_bf16 v[32:47], v[100:103], v[184:187], v[32:47]
    ds_read_b64_tr_b16 v[176:177], v4 offset:24576
    ds_read_b64_tr_b16 v[178:179], v7 offset:24576
    v_mfma_f32_32x32x16_bf16 v[48:63], v[100:103], v[188:191], v[48:63]
    ds_read_b64_tr_b16 v[180:181], v4 offset:25600
    ds_read_b64_tr_b16 v[182:183], v7 offset:25600
    s_add_u32 m0, s67, 135168
    s_add_u32 s58, s65, 516096
    buffer_load_dwordx4 v1, s[8:11], s58 offen lds
    s_waitcnt lgkmcnt(8)
    s_nop 0
    v_mfma_f32_32x32x16_bf16 v[32:47], v[104:107], v[192:195], v[32:47]
    ds_read_b64_tr_b16 v[184:185], v4 offset:26624
    ds_read_b64_tr_b16 v[186:187], v7 offset:26624
    v_mfma_f32_32x32x16_bf16 v[48:63], v[104:107], v[196:199], v[48:63]
    ds_read_b64_tr_b16 v[188:189], v4 offset:27648
    ds_read_b64_tr_b16 v[190:191], v7 offset:27648
    s_add_u32 m0, s67, 139264
    s_add_u32 s58, s65, 688128
    buffer_load_dwordx4 v1, s[8:11], s58 offen lds
    s_waitcnt lgkmcnt(8)
    s_nop 0
    v_mfma_f32_32x32x16_bf16 v[32:47], v[108:111], v[200:203], v[32:47]
    ds_read_b64_tr_b16 v[192:193], v4 offset:28672
    ds_read_b64_tr_b16 v[194:195], v7 offset:28672
    v_mfma_f32_32x32x16_bf16 v[48:63], v[108:111], v[204:207], v[48:63]
    ds_read_b64_tr_b16 v[196:197], v4 offset:29696
    ds_read_b64_tr_b16 v[198:199], v7 offset:29696
    s_add_u32 m0, s67, 143360
    s_add_u32 s58, s65, 860160
    buffer_load_dwordx4 v1, s[8:11], s58 offen lds
    s_waitcnt lgkmcnt(8)
    s_nop 0
    v_mfma_f32_32x32x16_bf16 v[32:47], v[112:115], v[176:179], v[32:47]
    ds_read_b64_tr_b16 v[200:201], v4 offset:30720
    ds_read_b64_tr_b16 v[202:203], v7 offset:30720
    v_mfma_f32_32x32x16_bf16 v[48:63], v[112:115], v[180:183], v[48:63]
    ds_read_b64_tr_b16 v[204:205], v4 offset:31744
    ds_read_b64_tr_b16 v[206:207], v7 offset:31744
    s_add_u32 m0, s67, 147456
    s_add_u32 s58, s65, 1032192
    buffer_load_dwordx4 v1, s[8:11], s58 offen lds
    s_waitcnt lgkmcnt(8)
    v_mfma_f32_32x32x16_bf16 v[32:47], v[116:119], v[184:187], v[32:47]
    v_mfma_f32_32x32x16_bf16 v[48:63], v[116:119], v[188:191], v[48:63]
    s_lshl_b32 s56, s2, 2
    s_add_u32 s56, s56, s3
    s_add_u32 s56, s56, 0
    s_mul_i32 s57, s56, 9363
    s_lshr_b32 s57, s57, 22
    s_mul_i32 s58, s57, 448
    s_sub_u32 s56, s56, s58
    s_lshl_b32 s56, s56, 11
    s_lshl_b32 s58, s57, 1
    s_add_u32 s71, s58, 1
    s_sub_u32 s58, s58, 8
    s_cmp_lt_u32 s57, 4
    s_cselect_b32 s57, s71, s58
    s_mul_i32 s57, s57, 917504
    s_add_u32 s56, s56, s57
    buffer_load_dword v234, v254, s[16:19], s56 offen
    s_waitcnt lgkmcnt(4)
    v_mfma_f32_32x32x16_bf16 v[32:47], v[120:123], v[192:195], v[32:47]
    v_mfma_f32_32x32x16_bf16 v[48:63], v[120:123], v[196:199], v[48:63]
    s_lshl_b32 s56, s2, 2
    s_add_u32 s56, s56, s3
    s_add_u32 s56, s56, 1024
    s_mul_i32 s57, s56, 9363
    s_lshr_b32 s57, s57, 22
    s_mul_i32 s58, s57, 448
    s_sub_u32 s56, s56, s58
    s_lshl_b32 s56, s56, 11
    s_lshl_b32 s58, s57, 1
    s_add_u32 s71, s58, 1
    s_sub_u32 s58, s58, 8
    s_cmp_lt_u32 s57, 4
    s_cselect_b32 s57, s71, s58
    s_mul_i32 s57, s57, 917504
    s_add_u32 s56, s56, s57
    buffer_load_dword v234, v254, s[16:19], s56 offen
    s_waitcnt lgkmcnt(0)
    v_mfma_f32_32x32x16_bf16 v[32:47], v[124:127], v[200:203], v[32:47]
    v_mfma_f32_32x32x16_bf16 v[48:63], v[124:127], v[204:207], v[48:63]
    s_lshl_b32 s56, s3, 11
    v_add_u32 v2, s56, v4
    v_add_u32_e64 v3, s56, v7
    ds_read_b64_tr_b16 v[16:17], v2 offset:0
    ds_read_b64_tr_b16 v[18:19], v3 offset:0
    ds_read_b64_tr_b16 v[20:21], v2 offset:1024
    ds_read_b64_tr_b16 v[22:23], v3 offset:1024
    ds_read_b64_tr_b16 v[24:25], v2 offset:8192
    ds_read_b64_tr_b16 v[26:27], v3 offset:8192
    ds_read_b64_tr_b16 v[28:29], v2 offset:9216
    ds_read_b64_tr_b16 v[30:31], v3 offset:9216
    ds_read_b64_tr_b16 v[208:209], v2 offset:16384
    ds_read_b64_tr_b16 v[210:211], v3 offset:16384
    ds_read_b64_tr_b16 v[212:213], v2 offset:17408
    ds_read_b64_tr_b16 v[214:215], v3 offset:17408
    ds_read_b64_tr_b16 v[216:217], v2 offset:24576
    ds_read_b64_tr_b16 v[218:219], v3 offset:24576
    ds_read_b64_tr_b16 v[220:221], v2 offset:25600
    ds_read_b64_tr_b16 v[222:223], v3 offset:25600
    s_waitcnt lgkmcnt(0)
    v_dot2c_f32_bf16 v248, v16, v14
    v_dot2c_f32_bf16 v249, v20, v14
    v_dot2c_f32_bf16 v248, v17, v14
    v_dot2c_f32_bf16 v249, v21, v14
    v_dot2c_f32_bf16 v248, v18, v14
    v_dot2c_f32_bf16 v249, v22, v14
    v_dot2c_f32_bf16 v248, v19, v14
    v_dot2c_f32_bf16 v249, v23, v14
    v_dot2c_f32_bf16 v248, v24, v14
    v_dot2c_f32_bf16 v249, v28, v14
    v_dot2c_f32_bf16 v248, v25, v14
    v_dot2c_f32_bf16 v249, v29, v14
    v_dot2c_f32_bf16 v248, v26, v14
    v_dot2c_f32_bf16 v249, v30, v14
    v_dot2c_f32_bf16 v248, v27, v14
    v_dot2c_f32_bf16 v249, v31, v14
    v_dot2c_f32_bf16 v248, v208, v14
    v_dot2c_f32_bf16 v249, v212, v14
    v_dot2c_f32_bf16 v248, v209, v14
    v_dot2c_f32_bf16 v249, v213, v14
    v_dot2c_f32_bf16 v248, v210, v14
    v_dot2c_f32_bf16 v249, v214, v14
    v_dot2c_f32_bf16 v248, v211, v14
    v_dot2c_f32_bf16 v249, v215, v14
    v_dot2c_f32_bf16 v248, v216, v14
    v_dot2c_f32_bf16 v249, v220, v14
    v_dot2c_f32_bf16 v248, v217, v14
    v_dot2c_f32_bf16 v249, v221, v14
    v_dot2c_f32_bf16 v248, v218, v14
    v_dot2c_f32_bf16 v249, v222, v14
    v_dot2c_f32_bf16 v248, v219, v14
    v_dot2c_f32_bf16 v249, v223, v14
    s_waitcnt vmcnt(15)
    ds_read_b128 v[128:131], v224 offset:32768
    ds_read_b128 v[132:135], v225 offset:32768
    ds_read_b128 v[136:139], v226 offset:32768
    ds_read_b128 v[140:143], v227 offset:32768
    ds_read_b128 v[144:147], v224 offset:33792
    ds_read_b128 v[148:151], v225 offset:33792
    ds_read_b128 v[152:155], v226 offset:33792
    ds_read_b128 v[156:159], v227 offset:33792
    ds_read_b128 v[160:163], v224 offset:34816
    ds_read_b128 v[164:167], v225 offset:34816
    ds_read_b128 v[168:171], v226 offset:34816
    ds_read_b128 v[172:175], v227 offset:34816
    s_waitcnt lgkmcnt(4)
    s_waitcnt lgkmcnt(0)
    s_add_u32 m0, s55, 32768
    s_add_u32 s58, s72, 917504
    buffer_load_dwordx4 v246, s[16:19], s58 offen lds
    v_dot2c_f32_bf16 v230, v128, v14
    v_dot2c_f32_bf16 v232, v128, v128
    v_dot2c_f32_bf16 v231, v129, v14
    v_dot2c_f32_bf16 v233, v129, v129
    v_dot2c_f32_bf16 v230, v130, v14
    v_dot2c_f32_bf16 v232, v130, v130
    v_dot2c_f32_bf16 v231, v131, v14
    v_dot2c_f32_bf16 v233, v131, v131
    v_dot2c_f32_bf16 v230, v132, v14
    v_dot2c_f32_bf16 v232, v132, v132
    v_dot2c_f32_bf16 v231, v133, v14
    v_dot2c_f32_bf16 v233, v133, v133
    v_dot2c_f32_bf16 v230, v134, v14
    v_dot2c_f32_bf16 v232, v134, v134
    v_dot2c_f32_bf16 v231, v135, v14
    v_dot2c_f32_bf16 v233, v135, v135
    v_dot2c_f32_bf16 v230, v136, v14
    v_dot2c_f32_bf16 v232, v136, v136
    v_dot2c_f32_bf16 v231, v137, v14
    v_dot2c_f32_bf16 v233, v137, v137
    v_dot2c_f32_bf16 v230, v138, v14
    v_dot2c_f32_bf16 v232, v138, v138
    v_dot2c_f32_bf16 v231, v139, v14
    v_dot2c_f32_bf16 v233, v139, v139
    s_add_u32 m0, s55, 33792
    s_add_u32 s58, s72, 946176
    buffer_load_dwordx4 v246, s[16:19], s58 offen lds
    v_dot2c_f32_bf16 v230, v140, v14
    v_dot2c_f32_bf16 v232, v140, v140
    v_dot2c_f32_bf16 v231, v141, v14
    v_dot2c_f32_bf16 v233, v141, v141
    v_dot2c_f32_bf16 v230, v142, v14
    v_dot2c_f32_bf16 v232, v142, v142
    v_dot2c_f32_bf16 v231, v143, v14
    v_dot2c_f32_bf16 v233, v143, v143
    v_dot2c_f32_bf16 v230, v144, v14
    v_dot2c_f32_bf16 v232, v144, v144
    v_dot2c_f32_bf16 v231, v145, v14
    v_dot2c_f32_bf16 v233, v145, v145
    v_dot2c_f32_bf16 v230, v146, v14
    v_dot2c_f32_bf16 v232, v146, v146
    v_dot2c_f32_bf16 v231, v147, v14
    v_dot2c_f32_bf16 v233, v147, v147
    v_dot2c_f32_bf16 v230, v148, v14
    v_dot2c_f32_bf16 v232, v148, v148
    v_dot2c_f32_bf16 v231, v149, v14
    v_dot2c_f32_bf16 v233, v149, v149
    v_dot2c_f32_bf16 v230, v150, v14
    v_dot2c_f32_bf16 v232, v150, v150
    v_dot2c_f32_bf16 v231, v151, v14
    v_dot2c_f32_bf16 v233, v151, v151
    s_add_u32 m0, s55, 34816
    s_add_u32 s58, s72, 974848
    buffer_load_dwordx4 v246, s[16:19], s58 offen lds
    v_dot2c_f32_bf16 v230, v152, v14
    v_dot2c_f32_bf16 v232, v152, v152
    v_dot2c_f32_bf16 v231, v153, v14
    v_dot2c_f32_bf16 v233, v153, v153
    v_dot2c_f32_bf16 v230, v154, v14
    v_dot2c_f32_bf16 v232, v154, v154
    v_dot2c_f32_bf16 v231, v155, v14
    v_dot2c_f32_bf16 v233, v155, v155
    v_dot2c_f32_bf16 v230, v156, v14
    v_dot2c_f32_bf16 v232, v156, v156
    v_dot2c_f32_bf16 v231, v157, v14
    v_dot2c_f32_bf16 v233, v157, v157
    v_dot2c_f32_bf16 v230, v158, v14
    v_dot2c_f32_bf16 v232, v158, v158
    v_dot2c_f32_bf16 v231, v159, v14
    v_dot2c_f32_bf16 v233, v159, v159
    v_dot2c_f32_bf16 v230, v160, v14
    v_dot2c_f32_bf16 v232, v160, v160
    v_dot2c_f32_bf16 v231, v161, v14
    v_dot2c_f32_bf16 v233, v161, v161
    v_dot2c_f32_bf16 v230, v162, v14
    v_dot2c_f32_bf16 v232, v162, v162
    v_dot2c_f32_bf16 v231, v163, v14
    v_dot2c_f32_bf16 v233, v163, v163
    s_add_u32 m0, s55, 35840
    s_add_u32 s58, s72, 1003520
    buffer_load_dwordx4 v246, s[16:19], s58 offen lds
    v_dot2c_f32_bf16 v230, v164, v14
    v_dot2c_f32_bf16 v232, v164, v164
    v_dot2c_f32_bf16 v231, v165, v14
    v_dot2c_f32_bf16 v233, v165, v165
    v_dot2c_f32_bf16 v230, v166, v14
    v_dot2c_f32_bf16 v232, v166, v166
    v_dot2c_f32_bf16 v231, v167, v14
    v_dot2c_f32_bf16 v233, v167, v167
    v_dot2c_f32_bf16 v230, v168, v14
    v_dot2c_f32_bf16 v232, v168, v168
    v_dot2c_f32_bf16 v231, v169, v14
    v_dot2c_f32_bf16 v233, v169, v169
    v_dot2c_f32_bf16 v230, v170, v14
    v_dot2c_f32_bf16 v232, v170, v170
    v_dot2c_f32_bf16 v231, v171, v14
    v_dot2c_f32_bf16 v233, v171, v171
    v_dot2c_f32_bf16 v230, v172, v14
    v_dot2c_f32_bf16 v232, v172, v172
    v_dot2c_f32_bf16 v231, v173, v14
    v_dot2c_f32_bf16 v233, v173, v173
    v_dot2c_f32_bf16 v230, v174, v14
    v_dot2c_f32_bf16 v232, v174, v174
    v_dot2c_f32_bf16 v231, v175, v14
    v_dot2c_f32_bf16 v233, v175, v175
    s_nop 1
    v_add_f32 v12, v230, v231
    v_add_f32 v13, v232, v233
    v_mov_b32 v230, v12
    s_nop 1
    v_permlane32_swap_b32 v12, v230
    v_add_f32 v12, v12, v230
    v_mov_b32 v231, v13
    s_nop 1
    v_permlane32_swap_b32 v13, v231
    v_add_f32_e64 v13, v13, v231

    v_mul_f32 v12, 0x3b124925, v12
    v_mul_f32 v13, 0x3b124925, v13
    v_fma_f32 v13, -v12, v12, v13
    v_max_f32_e64 v13, 0, v13

    v_add_f32 v13, 0x3727c5ac, v13
    v_rsq_f32 v13, v13
    v_cmp_eq_u32 vcc, 0, v242
    s_nop 1
    v_cndmask_b32 v3, v12, v13, vcc
    ds_write_b32 v11, v3
    s_waitcnt vmcnt(13)
    s_barrier
    s_lshl_b32 s56, s3, 11
    v_add_u32 v2, s56, v5
    v_add_u32_e64 v3, s56, v8
    ds_read_b64_tr_b16 v[16:17], v2 offset:0
    ds_read_b64_tr_b16 v[18:19], v3 offset:0
    ds_read_b64_tr_b16 v[20:21], v2 offset:1024
    ds_read_b64_tr_b16 v[22:23], v3 offset:1024
    ds_read_b64_tr_b16 v[24:25], v2 offset:8192
    ds_read_b64_tr_b16 v[26:27], v3 offset:8192
    ds_read_b64_tr_b16 v[28:29], v2 offset:9216
    ds_read_b64_tr_b16 v[30:31], v3 offset:9216
    ds_read_b64_tr_b16 v[208:209], v2 offset:16384
    ds_read_b64_tr_b16 v[210:211], v3 offset:16384
    ds_read_b64_tr_b16 v[212:213], v2 offset:17408
    ds_read_b64_tr_b16 v[214:215], v3 offset:17408
    s_waitcnt lgkmcnt(0)
    v_dot2c_f32_bf16 v248, v16, v14
    v_dot2c_f32_bf16 v249, v20, v14
    v_dot2c_f32_bf16 v248, v17, v14
    v_dot2c_f32_bf16 v249, v21, v14
    v_dot2c_f32_bf16 v248, v18, v14
    v_dot2c_f32_bf16 v249, v22, v14
    v_dot2c_f32_bf16 v248, v19, v14
    v_dot2c_f32_bf16 v249, v23, v14
    v_dot2c_f32_bf16 v248, v24, v14
    v_dot2c_f32_bf16 v249, v28, v14
    v_dot2c_f32_bf16 v248, v25, v14
    v_dot2c_f32_bf16 v249, v29, v14
    v_dot2c_f32_bf16 v248, v26, v14
    v_dot2c_f32_bf16 v249, v30, v14
    v_dot2c_f32_bf16 v248, v27, v14
    v_dot2c_f32_bf16 v249, v31, v14
    v_dot2c_f32_bf16 v248, v208, v14
    v_dot2c_f32_bf16 v249, v212, v14
    v_dot2c_f32_bf16 v248, v209, v14
    v_dot2c_f32_bf16 v249, v213, v14
    v_dot2c_f32_bf16 v248, v210, v14
    v_dot2c_f32_bf16 v249, v214, v14
    v_dot2c_f32_bf16 v248, v211, v14
    v_dot2c_f32_bf16 v249, v215, v14

    s_nop 1
    v_mov_b32 v22, v248
    v_mov_b32 v23, v249
    s_nop 0
    v_permlane32_swap_b32 v248, v22
    v_permlane32_swap_b32 v249, v23
    v_add_f32 v22, v248, v22
    v_add_f32 v23, v249, v23
    s_lshl_b32 s56, s3, 2
    v_lshlrev_b32_e64 v10, 4, v243
    v_add_u32 v10, 0x27800, v10
    v_add_u32_e64 v11, s56, v10
    ds_write_b32 v11, v22 offset:512
    ds_write_b32 v11, v23 offset:1024

    ds_read_b64_tr_b16 v[176:177], v5 offset:0
    ds_read_b64_tr_b16 v[178:179], v8 offset:0
    ds_read_b64_tr_b16 v[180:181], v5 offset:1024
    ds_read_b64_tr_b16 v[182:183], v8 offset:1024
    ds_read_b64_tr_b16 v[184:185], v5 offset:2048
    ds_read_b64_tr_b16 v[186:187], v8 offset:2048
    ds_read_b64_tr_b16 v[188:189], v5 offset:3072
    ds_read_b64_tr_b16 v[190:191], v8 offset:3072
    ds_read_b64_tr_b16 v[192:193], v5 offset:4096
    ds_read_b64_tr_b16 v[194:195], v8 offset:4096
    ds_read_b64_tr_b16 v[196:197], v5 offset:5120
    ds_read_b64_tr_b16 v[198:199], v8 offset:5120
    s_waitcnt lgkmcnt(8)
    s_nop 0
    v_mfma_f32_32x32x16_bf16 v[32:47], v[128:131], v[176:179], v[32:47]
    ds_read_b64_tr_b16 v[200:201], v5 offset:6144
    ds_read_b64_tr_b16 v[202:203], v8 offset:6144
    v_mfma_f32_32x32x16_bf16 v[48:63], v[128:131], v[180:183], v[48:63]
    ds_read_b64_tr_b16 v[204:205], v5 offset:7168
    ds_read_b64_tr_b16 v[206:207], v8 offset:7168
    s_add_u32 m0, s55, 36864
    s_add_u32 s58, s72, 1032192
    buffer_load_dwordx4 v246, s[16:19], s58 offen lds
    s_waitcnt lgkmcnt(8)
    s_nop 0
    v_mfma_f32_32x32x16_bf16 v[32:47], v[132:135], v[184:187], v[32:47]
    ds_read_b64_tr_b16 v[176:177], v5 offset:8192
    ds_read_b64_tr_b16 v[178:179], v8 offset:8192
    v_mfma_f32_32x32x16_bf16 v[48:63], v[132:135], v[188:191], v[48:63]
    ds_read_b64_tr_b16 v[180:181], v5 offset:9216
    ds_read_b64_tr_b16 v[182:183], v8 offset:9216
    s_add_u32 m0, s55, 37888
    s_add_u32 s58, s72, 1060864
    buffer_load_dwordx4 v246, s[16:19], s58 offen lds
    s_waitcnt lgkmcnt(8)
    s_nop 0
    v_mfma_f32_32x32x16_bf16 v[32:47], v[136:139], v[192:195], v[32:47]
    ds_read_b64_tr_b16 v[184:185], v5 offset:10240
    ds_read_b64_tr_b16 v[186:187], v8 offset:10240
    v_mfma_f32_32x32x16_bf16 v[48:63], v[136:139], v[196:199], v[48:63]
    ds_read_b64_tr_b16 v[188:189], v5 offset:11264
    ds_read_b64_tr_b16 v[190:191], v8 offset:11264
    s_add_u32 m0, s55, 38912
    s_add_u32 s58, s72, 1089536
    buffer_load_dwordx4 v246, s[16:19], s58 offen lds
    s_waitcnt lgkmcnt(8)
    s_nop 0
    v_mfma_f32_32x32x16_bf16 v[32:47], v[140:143], v[200:203], v[32:47]
    ds_read_b64_tr_b16 v[192:193], v5 offset:12288
    ds_read_b64_tr_b16 v[194:195], v8 offset:12288
    v_mfma_f32_32x32x16_bf16 v[48:63], v[140:143], v[204:207], v[48:63]
    ds_read_b64_tr_b16 v[196:197], v5 offset:13312
    ds_read_b64_tr_b16 v[198:199], v8 offset:13312
    s_add_u32 m0, s55, 39936
    s_add_u32 s58, s72, 1118208
    buffer_load_dwordx4 v246, s[16:19], s58 offen lds
    s_waitcnt lgkmcnt(8)
    s_nop 0
    v_mfma_f32_32x32x16_bf16 v[32:47], v[144:147], v[176:179], v[32:47]
    ds_read_b64_tr_b16 v[200:201], v5 offset:14336
    ds_read_b64_tr_b16 v[202:203], v8 offset:14336
    v_mfma_f32_32x32x16_bf16 v[48:63], v[144:147], v[180:183], v[48:63]
    ds_read_b64_tr_b16 v[204:205], v5 offset:15360
    ds_read_b64_tr_b16 v[206:207], v8 offset:15360
    s_add_u32 m0, s55, 40960
    s_add_u32 s58, s72, 1146880
    buffer_load_dwordx4 v246, s[16:19], s58 offen lds
    s_waitcnt lgkmcnt(8)
    s_nop 0
    v_mfma_f32_32x32x16_bf16 v[32:47], v[148:151], v[184:187], v[32:47]
    ds_read_b64_tr_b16 v[176:177], v5 offset:16384
    ds_read_b64_tr_b16 v[178:179], v8 offset:16384
    v_mfma_f32_32x32x16_bf16 v[48:63], v[148:151], v[188:191], v[48:63]
    ds_read_b64_tr_b16 v[180:181], v5 offset:17408
    ds_read_b64_tr_b16 v[182:183], v8 offset:17408
    s_add_u32 m0, s55, 41984
    s_add_u32 s58, s72, 1175552
    buffer_load_dwordx4 v246, s[16:19], s58 offen lds
    s_waitcnt lgkmcnt(8)
    s_nop 0
    v_mfma_f32_32x32x16_bf16 v[32:47], v[152:155], v[192:195], v[32:47]
    ds_read_b64_tr_b16 v[184:185], v5 offset:18432
    ds_read_b64_tr_b16 v[186:187], v8 offset:18432
    v_mfma_f32_32x32x16_bf16 v[48:63], v[152:155], v[196:199], v[48:63]
    ds_read_b64_tr_b16 v[188:189], v5 offset:19456
    ds_read_b64_tr_b16 v[190:191], v8 offset:19456
    s_add_u32 m0, s55, 43008
    s_add_u32 s58, s72, 1204224
    buffer_load_dwordx4 v246, s[16:19], s58 offen lds
    s_waitcnt lgkmcnt(8)
    s_nop 0
    v_mfma_f32_32x32x16_bf16 v[32:47], v[156:159], v[200:203], v[32:47]
    ds_read_b64_tr_b16 v[192:193], v5 offset:20480
    ds_read_b64_tr_b16 v[194:195], v8 offset:20480
    v_mfma_f32_32x32x16_bf16 v[48:63], v[156:159], v[204:207], v[48:63]
    ds_read_b64_tr_b16 v[196:197], v5 offset:21504
    ds_read_b64_tr_b16 v[198:199], v8 offset:21504
    s_add_u32 m0, s55, 44032
    s_add_u32 s58, s72, 1232896
    buffer_load_dwordx4 v246, s[16:19], s58 offen lds
    s_waitcnt lgkmcnt(8)
    s_nop 0
    v_mfma_f32_32x32x16_bf16 v[32:47], v[160:163], v[176:179], v[32:47]
    ds_read_b64_tr_b16 v[200:201], v5 offset:22528
    ds_read_b64_tr_b16 v[202:203], v8 offset:22528
    v_mfma_f32_32x32x16_bf16 v[48:63], v[160:163], v[180:183], v[48:63]
    ds_read_b64_tr_b16 v[204:205], v5 offset:23552
    ds_read_b64_tr_b16 v[206:207], v8 offset:23552
    s_add_u32 m0, s55, 45056
    s_add_u32 s58, s72, 1261568
    buffer_load_dwordx4 v246, s[16:19], s58 offen lds
    s_waitcnt lgkmcnt(8)
    s_nop 0
    v_mfma_f32_32x32x16_bf16 v[32:47], v[164:167], v[184:187], v[32:47]
    v_mfma_f32_32x32x16_bf16 v[48:63], v[164:167], v[188:191], v[48:63]
    s_add_u32 m0, s55, 46080
    s_add_u32 s58, s72, 1290240
    buffer_load_dwordx4 v246, s[16:19], s58 offen lds
    s_waitcnt lgkmcnt(4)
    s_nop 0
    v_mfma_f32_32x32x16_bf16 v[32:47], v[168:171], v[192:195], v[32:47]
    v_mfma_f32_32x32x16_bf16 v[48:63], v[168:171], v[196:199], v[48:63]
    s_add_u32 m0, s55, 47104
    s_add_u32 s58, s72, 1318912
    buffer_load_dwordx4 v246, s[16:19], s58 offen lds
    s_waitcnt lgkmcnt(0)
    s_nop 0
    v_mfma_f32_32x32x16_bf16 v[32:47], v[172:175], v[200:203], v[32:47]
    v_mfma_f32_32x32x16_bf16 v[48:63], v[172:175], v[204:207], v[48:63]
    s_add_u32 m0, s55, 48128
    s_add_u32 s58, s72, 1347584
    buffer_load_dwordx4 v246, s[16:19], s58 offen lds

    v_and_b32 v230, 3, v244
    v_lshlrev_b32 v230, 6, v230
    v_bfe_u32 v231, v244, 2, 1
    v_lshl_add_u32 v230, v231, 3, v230
    s_lshl_b32 s56, s3, 12
    buffer_load_dwordx2 v[228:229], v230, s[40:43], s56 offen offset:16 sc1

    s_lshl_b32 s56, s2, 2
    s_add_u32 s56, s56, s3
    s_add_u32 s56, s56, 2048
    s_mul_i32 s57, s56, 9363
    s_lshr_b32 s57, s57, 22
    s_mul_i32 s58, s57, 448
    s_sub_u32 s56, s56, s58
    s_lshl_b32 s56, s56, 11
    s_lshl_b32 s58, s57, 1
    s_add_u32 s71, s58, 1
    s_sub_u32 s58, s58, 8
    s_cmp_lt_u32 s57, 4
    s_cselect_b32 s57, s71, s58
    s_mul_i32 s57, s57, 917504
    s_add_u32 s56, s56, s57
    buffer_load_dword v234, v254, s[16:19], s56 offen
    s_lshl_b32 s56, s2, 2
    s_add_u32 s56, s56, s3
    s_add_u32 s56, s56, 3072
    s_mul_i32 s57, s56, 9363
    s_lshr_b32 s57, s57, 22
    s_mul_i32 s58, s57, 448
    s_sub_u32 s56, s56, s58
    s_lshl_b32 s56, s56, 11
    s_lshl_b32 s58, s57, 1
    s_add_u32 s71, s58, 1
    s_sub_u32 s58, s58, 8
    s_cmp_lt_u32 s57, 4
    s_cselect_b32 s57, s71, s58
    s_mul_i32 s57, s57, 917504
    s_add_u32 s56, s56, s57
    buffer_load_dword v234, v254, s[16:19], s56 offen
    buffer_load_dword v234, v235, s[24:27], 0 offen
    buffer_load_dword v234, v235, s[28:31], 0 offen
    s_lshl_b32 s69, s3, 13
    s_barrier
    ds_read_b128 v[20:23], v10 offset:512
    ds_read_b128 v[24:27], v10 offset:1024

    s_waitcnt lgkmcnt(0)
    v_add_f32 v20, v20, v21
    v_add_f32 v22, v22, v23
    v_add_f32 v24, v24, v25
    v_add_f32 v26, v26, v27
    v_add_f32 v248, v20, v22
    v_add_f32 v249, v24, v26

    s_branch A1_2_epi
A1_2_it1:

    v_lshrrev_b32 v2, 2, v244
    v_and_b32 v2, 3, v2
    v_lshrrev_b32 v3, 4, v244
    v_and_b32 v3, 1, v3
    v_lshlrev_b32 v3, 2, v3
    v_and_b32 v10, 3, v244
    v_add_u32 v3, v3, v10
    s_and_b32 s56, s45, 1
    v_add_u32 v3, s56, v3
    v_and_b32 v3, 7, v3
    v_lshlrev_b32 v3, 3, v3
    v_lshl_add_u32 v4, v2, 6, v3
    v_lshl_add_u32 v4, v242, 8, v4
    v_add_u32 v5, 0x10000, v4
    v_add_u32 v6, 0x20000, v4
    v_add_u32 v7, 512, v4
    v_add_u32 v8, 512, v5
    v_add_u32 v9, 512, v6
    s_lshl_b32 s56, s3, 8
    s_add_u32 s56, s56, 160768
    v_lshlrev_b32 v11, 2, v244
    v_add_u32 v11, s56, v11
    v_lshlrev_b32 v15, 4, v242
    v_add_u32_e64 v15, s56, v15

    ds_read_b64_tr_b16 v[176:177], v4 offset:0
    ds_read_b64_tr_b16 v[178:179], v7 offset:0
    ds_read_b64_tr_b16 v[180:181], v4 offset:1024
    ds_read_b64_tr_b16 v[182:183], v7 offset:1024
    ds_read_b64_tr_b16 v[184:185], v5 offset:24576
    ds_read_b64_tr_b16 v[186:187], v8 offset:24576
    ds_read_b64_tr_b16 v[188:189], v4 offset:2048
    ds_read_b64_tr_b16 v[190:191], v7 offset:2048
    ds_read_b64_tr_b16 v[192:193], v4 offset:3072
    ds_read_b64_tr_b16 v[194:195], v7 offset:3072
    ds_read_b64_tr_b16 v[196:197], v5 offset:25600
    ds_read_b64_tr_b16 v[198:199], v8 offset:25600
    s_waitcnt vmcnt(10)
    v_max_u32 v251, v75, v79
    v_max3_u32 v251, v251, v83, v87
    v_cmp_eq_u32 vcc, -1, v251
    s_nop 0
    s_cbranch_vccnz CK_4_r
CK_4_k:
    s_waitcnt lgkmcnt(6)
    v_mfma_f32_32x32x16_bf16 v[32:47], v[72:75], v[176:179], 0
    ds_read_b64_tr_b16 v[200:201], v4 offset:8192
    ds_read_b64_tr_b16 v[202:203], v7 offset:8192
    v_mfma_f32_32x32x16_bf16 v[48:63], v[72:75], v[180:183], 0
    ds_read_b64_tr_b16 v[204:205], v4 offset:9216
    ds_read_b64_tr_b16 v[206:207], v7 offset:9216
    v_mfma_f32_32x32x16_bf16 v[16:31], v[184:187], v[72:75], 0
    ds_read_b64_tr_b16 v[208:209], v5 offset:28672
    ds_read_b64_tr_b16 v[210:211], v8 offset:28672
    s_waitcnt lgkmcnt(6)
    s_nop 0
    v_mfma_f32_32x32x16_bf16 v[32:47], v[76:79], v[188:191], v[32:47]
    ds_read_b64_tr_b16 v[176:177], v4 offset:10240
    ds_read_b64_tr_b16 v[178:179], v7 offset:10240
    v_mfma_f32_32x32x16_bf16 v[48:63], v[76:79], v[192:195], v[48:63]
    ds_read_b64_tr_b16 v[180:181], v4 offset:11264
    ds_read_b64_tr_b16 v[182:183], v7 offset:11264
    v_mfma_f32_32x32x16_bf16 v[16:31], v[196:199], v[76:79], v[16:31]
    ds_read_b64_tr_b16 v[184:185], v5 offset:29696
    ds_read_b64_tr_b16 v[186:187], v8 offset:29696
    s_waitcnt lgkmcnt(6)
    s_nop 0
    v_mfma_f32_32x32x16_bf16 v[32:47], v[80:83], v[200:203], v[32:47]
    ds_read_b64_tr_b16 v[188:189], v4 offset:16384
    ds_read_b64_tr_b16 v[190:191], v7 offset:16384
    v_mfma_f32_32x32x16_bf16 v[48:63], v[80:83], v[204:207], v[48:63]
    ds_read_b64_tr_b16 v[192:193], v4 offset:17408
    ds_read_b64_tr_b16 v[194:195], v7 offset:17408
    v_mfma_f32_32x32x16_bf16 v[16:31], v[208:211], v[80:83], v[16:31]
    ds_read_b64_tr_b16 v[196:197], v6 offset:0
    ds_read_b64_tr_b16 v[198:199], v9 offset:0
    s_waitcnt lgkmcnt(6)
    s_nop 0
    v_mfma_f32_32x32x16_bf16 v[32:47], v[84:87], v[176:179], v[32:47]
    ds_read_b64_tr_b16 v[200:201], v4 offset:18432
    ds_read_b64_tr_b16 v[202:203], v7 offset:18432
    v_mfma_f32_32x32x16_bf16 v[48:63], v[84:87], v[180:183], v[48:63]
    ds_read_b64_tr_b16 v[204:205], v4 offset:19456
    ds_read_b64_tr_b16 v[206:207], v7 offset:19456
    s_waitcnt vmcnt(6)
    v_max_u32 v251, v91, v95
    v_max3_u32 v251, v251, v99, v103
    v_cmp_eq_u32 vcc, -1, v251
    s_nop 0
    s_cbranch_vccnz CK_5_r
CK_5_k:
    v_mfma_f32_32x32x16_bf16 v[16:31], v[184:187], v[84:87], v[16:31]
    ds_read_b64_tr_b16 v[208:209], v6 offset:1024
    ds_read_b64_tr_b16 v[210:211], v9 offset:1024
    s_waitcnt lgkmcnt(6)
    v_mfma_f32_32x32x16_bf16 v[32:47], v[88:91], v[188:191], v[32:47]
    ds_read_b64_tr_b16 v[176:177], v4 offset:24576
    ds_read_b64_tr_b16 v[178:179], v7 offset:24576
    v_mfma_f32_32x32x16_bf16 v[48:63], v[88:91], v[192:195], v[48:63]
    ds_read_b64_tr_b16 v[180:181], v4 offset:25600
    ds_read_b64_tr_b16 v[182:183], v7 offset:25600
    v_mfma_f32_32x32x16_bf16 v[16:31], v[196:199], v[88:91], v[16:31]
    ds_read_b64_tr_b16 v[184:185], v6 offset:4096
    ds_read_b64_tr_b16 v[186:187], v9 offset:4096
    s_barrier
    s_waitcnt lgkmcnt(6)
    v_mfma_f32_32x32x16_bf16 v[32:47], v[92:95], v[200:203], v[32:47]
    ds_read_b64_tr_b16 v[188:189], v4 offset:26624
    ds_read_b64_tr_b16 v[190:191], v7 offset:26624
    buffer_load_dwordx4 v[128:131], v240, s[36:39], s80 offen offset:2048 sc1
    v_mfma_f32_32x32x16_bf16 v[48:63], v[92:95], v[204:207], v[48:63]
    ds_read_b64_tr_b16 v[192:193], v4 offset:27648
    ds_read_b64_tr_b16 v[194:195], v7 offset:27648
    buffer_load_dwordx4 v[132:135], v240, s[36:39], s80 offen offset:3072 sc1
    v_mfma_f32_32x32x16_bf16 v[16:31], v[208:211], v[92:95], v[16:31]
    ds_read_b64_tr_b16 v[196:197], v6 offset:5120
    ds_read_b64_tr_b16 v[198:199], v9 offset:5120
    s_waitcnt lgkmcnt(6)
    s_nop 0
    v_mfma_f32_32x32x16_bf16 v[32:47], v[96:99], v[176:179], v[32:47]
    ds_read_b64_tr_b16 v[200:201], v5 offset:0
    ds_read_b64_tr_b16 v[202:203], v8 offset:0
    buffer_load_dwordx4 v[136:139], v241, s[36:39], s80 offen offset:2048 sc1
    v_mfma_f32_32x32x16_bf16 v[48:63], v[96:99], v[180:183], v[48:63]
    ds_read_b64_tr_b16 v[204:205], v5 offset:1024
    ds_read_b64_tr_b16 v[206:207], v8 offset:1024
    buffer_load_dwordx4 v[140:143], v241, s[36:39], s80 offen offset:3072 sc1
    v_mfma_f32_32x32x16_bf16 v[16:31], v[184:187], v[96:99], v[16:31]
    ds_read_b64_tr_b16 v[208:209], v6 offset:8192
    ds_read_b64_tr_b16 v[210:211], v9 offset:8192
    s_waitcnt lgkmcnt(6)
    s_nop 0
    v_mfma_f32_32x32x16_bf16 v[32:47], v[100:103], v[188:191], v[32:47]
    ds_read_b64_tr_b16 v[176:177], v5 offset:2048
    ds_read_b64_tr_b16 v[178:179], v8 offset:2048
    buffer_load_dwordx4 v[144:147], v240, s[36:39], s81 offen offset:2048 sc1
    v_mfma_f32_32x32x16_bf16 v[48:63], v[100:103], v[192:195], v[48:63]
    ds_read_b64_tr_b16 v[180:181], v5 offset:3072
    ds_read_b64_tr_b16 v[182:183], v8 offset:3072
    buffer_load_dwordx4 v[148:151], v240, s[36:39], s81 offen offset:3072 sc1
    s_waitcnt vmcnt(6)
    v_max_u32 v251, v107, v111
    v_max3_u32 v251, v251, v115, v119
    v_max3_u32 v251, v251, v123, v127
    v_cmp_eq_u32 vcc, -1, v251
    s_nop 0
    s_cbranch_vccnz CK_6_r
CK_6_k:
    v_mfma_f32_32x32x16_bf16 v[16:31], v[196:199], v[100:103], v[16:31]
    ds_read_b64_tr_b16 v[184:185], v6 offset:9216
    ds_read_b64_tr_b16 v[186:187], v9 offset:9216
    s_waitcnt lgkmcnt(6)
    v_mfma_f32_32x32x16_bf16 v[32:47], v[104:107], v[200:203], v[32:47]
    ds_read_b64_tr_b16 v[188:189], v5 offset:8192
    ds_read_b64_tr_b16 v[190:191], v8 offset:8192
    buffer_load_dwordx4 v[152:155], v241, s[36:39], s81 offen offset:2048 sc1
    v_mfma_f32_32x32x16_bf16 v[48:63], v[104:107], v[204:207], v[48:63]
    ds_read_b64_tr_b16 v[192:193], v5 offset:9216
    ds_read_b64_tr_b16 v[194:195], v8 offset:9216
    buffer_load_dwordx4 v[156:159], v241, s[36:39], s81 offen offset:3072 sc1
    v_mfma_f32_32x32x16_bf16 v[16:31], v[208:211], v[104:107], v[16:31]
    ds_read_b64_tr_b16 v[196:197], v6 offset:12288
    ds_read_b64_tr_b16 v[198:199], v9 offset:12288
    s_waitcnt lgkmcnt(6)
    s_nop 0
    v_mfma_f32_32x32x16_bf16 v[32:47], v[108:111], v[176:179], v[32:47]
    ds_read_b64_tr_b16 v[200:201], v5 offset:10240
    ds_read_b64_tr_b16 v[202:203], v8 offset:10240
    buffer_load_dwordx4 v[160:163], v240, s[36:39], s82 offen offset:2048 sc1
    v_mfma_f32_32x32x16_bf16 v[48:63], v[108:111], v[180:183], v[48:63]
    ds_read_b64_tr_b16 v[204:205], v5 offset:11264
    ds_read_b64_tr_b16 v[206:207], v8 offset:11264
    buffer_load_dwordx4 v[164:167], v240, s[36:39], s82 offen offset:3072 sc1
    v_mfma_f32_32x32x16_bf16 v[16:31], v[184:187], v[108:111], v[16:31]
    ds_read_b64_tr_b16 v[208:209], v6 offset:13312
    ds_read_b64_tr_b16 v[210:211], v9 offset:13312
    s_waitcnt lgkmcnt(6)
    s_nop 0
    v_mfma_f32_32x32x16_bf16 v[32:47], v[112:115], v[188:191], v[32:47]
    ds_read_b64_tr_b16 v[176:177], v5 offset:16384
    ds_read_b64_tr_b16 v[178:179], v8 offset:16384
    buffer_load_dwordx4 v[168:171], v241, s[36:39], s82 offen offset:2048 sc1
    v_mfma_f32_32x32x16_bf16 v[48:63], v[112:115], v[192:195], v[48:63]
    ds_read_b64_tr_b16 v[180:181], v5 offset:17408
    ds_read_b64_tr_b16 v[182:183], v8 offset:17408
    buffer_load_dwordx4 v[172:175], v241, s[36:39], s82 offen offset:3072 sc1
    v_mfma_f32_32x32x16_bf16 v[16:31], v[196:199], v[112:115], v[16:31]
    ds_read_b64_tr_b16 v[184:185], v6 offset:16384
    ds_read_b64_tr_b16 v[186:187], v9 offset:16384
    s_waitcnt lgkmcnt(6)
    s_nop 0
    v_mfma_f32_32x32x16_bf16 v[32:47], v[116:119], v[200:203], v[32:47]
    ds_read_b64_tr_b16 v[188:189], v5 offset:18432
    ds_read_b64_tr_b16 v[190:191], v8 offset:18432
    buffer_load_dwordx4 v[64:67], v240, s[36:39], s83 offen offset:2048 sc1
    v_mfma_f32_32x32x16_bf16 v[48:63], v[116:119], v[204:207], v[48:63]
    ds_read_b64_tr_b16 v[192:193], v5 offset:19456
    ds_read_b64_tr_b16 v[194:195], v8 offset:19456
    buffer_load_dwordx4 v[68:71], v240, s[36:39], s83 offen offset:3072 sc1
    v_mfma_f32_32x32x16_bf16 v[16:31], v[208:211], v[116:119], v[16:31]
    ds_read_b64_tr_b16 v[196:197], v6 offset:17408
    ds_read_b64_tr_b16 v[198:199], v9 offset:17408
    s_waitcnt lgkmcnt(6)
    s_nop 0
    v_mfma_f32_32x32x16_bf16 v[32:47], v[120:123], v[176:179], v[32:47]
    ds_read_b64_tr_b16 v[200:201], v4 offset:4096
    ds_read_b64_tr_b16 v[202:203], v7 offset:4096
    buffer_load_dwordx2 v[72:73], v245, s[36:39], s84 offen offset:0 sc1
    buffer_load_dwordx2 v[74:75], v245, s[36:39], s84 offen offset:512 sc1
    buffer_load_dwordx2 v[76:77], v245, s[36:39], s84 offen offset:1024 sc1
    buffer_load_dwordx2 v[78:79], v245, s[36:39], s84 offen offset:1536 sc1
    buffer_load_dwordx2 v[80:81], v245, s[36:39], s84 offen offset:2048 sc1
    buffer_load_dwordx2 v[82:83], v245, s[36:39], s84 offen offset:2560 sc1
    buffer_load_dwordx2 v[84:85], v245, s[36:39], s84 offen offset:3072 sc1
    v_min_u32 v253, 0, v244
    v_lshlrev_b32 v253, 6, v253
    buffer_load_dword v252, v253, s[40:43], 0 offen offset:132 sc1
    v_mfma_f32_32x32x16_bf16 v[48:63], v[120:123], v[180:183], v[48:63]
    ds_read_b64_tr_b16 v[204:205], v4 offset:5120
    ds_read_b64_tr_b16 v[206:207], v7 offset:5120
    s_add_u32 m0, s75, 32768
    s_add_u32 s58, s74, 0
    buffer_load_dwordx4 v250, s[12:15], s58 offen lds
    v_mfma_f32_32x32x16_bf16 v[16:31], v[184:187], v[120:123], v[16:31]
    s_waitcnt lgkmcnt(4)
    v_mfma_f32_32x32x16_bf16 v[32:47], v[124:127], v[188:191], v[32:47]
    ds_read_b64_tr_b16 v[176:177], v4 offset:6144
    ds_read_b64_tr_b16 v[178:179], v7 offset:6144
    s_add_u32 m0, s75, 34816
    s_add_u32 s58, s74, 14336
    buffer_load_dwordx4 v250, s[12:15], s58 offen lds
    v_mfma_f32_32x32x16_bf16 v[48:63], v[124:127], v[192:195], v[48:63]
    ds_read_b64_tr_b16 v[180:181], v4 offset:7168
    ds_read_b64_tr_b16 v[182:183], v7 offset:7168
    s_add_u32 m0, s75, 36864
    s_add_u32 s58, s74, 28672
    buffer_load_dwordx4 v250, s[12:15], s58 offen lds
    s_waitcnt vmcnt(21)
    v_max_u32 v251, v131, v135
    v_max3_u32 v251, v251, v139, v143
    v_cmp_eq_u32 vcc, -1, v251
    s_nop 0
    s_cbranch_vccnz CK_7_r
CK_7_k:
    v_mfma_f32_32x32x16_bf16 v[16:31], v[196:199], v[124:127], v[16:31]
    s_waitcnt lgkmcnt(4)
    v_mfma_f32_32x32x16_bf16 v[32:47], v[128:131], v[200:203], v[32:47]
    ds_read_b64_tr_b16 v[188:189], v4 offset:12288
    ds_read_b64_tr_b16 v[190:191], v7 offset:12288
    s_add_u32 m0, s75, 38912
    s_add_u32 s58, s74, 43008
    buffer_load_dwordx4 v250, s[12:15], s58 offen lds
    v_mfma_f32_32x32x16_bf16 v[48:63], v[128:131], v[204:207], v[48:63]
    ds_read_b64_tr_b16 v[192:193], v4 offset:13312
    ds_read_b64_tr_b16 v[194:195], v7 offset:13312
    s_add_u32 m0, s75, 40960
    s_add_u32 s58, s74, 57344
    buffer_load_dwordx4 v250, s[12:15], s58 offen lds
    s_waitcnt lgkmcnt(4)
    s_nop 0
    v_mfma_f32_32x32x16_bf16 v[32:47], v[132:135], v[176:179], v[32:47]
    ds_read_b64_tr_b16 v[200:201], v4 offset:14336
    ds_read_b64_tr_b16 v[202:203], v7 offset:14336
    s_add_u32 m0, s75, 43008
    s_add_u32 s58, s74, 71680
    buffer_load_dwordx4 v250, s[12:15], s58 offen lds
    v_mfma_f32_32x32x16_bf16 v[48:63], v[132:135], v[180:183], v[48:63]
    ds_read_b64_tr_b16 v[204:205], v4 offset:15360
    ds_read_b64_tr_b16 v[206:207], v7 offset:15360
    s_add_u32 m0, s75, 45056
    s_add_u32 s58, s74, 86016
    buffer_load_dwordx4 v250, s[12:15], s58 offen lds
    s_waitcnt lgkmcnt(4)
    s_nop 0
    v_mfma_f32_32x32x16_bf16 v[32:47], v[136:139], v[188:191], v[32:47]
    ds_read_b64_tr_b16 v[176:177], v4 offset:20480
    ds_read_b64_tr_b16 v[178:179], v7 offset:20480
    v_mfma_f32_32x32x16_bf16 v[48:63], v[136:139], v[192:195], v[48:63]
    ds_read_b64_tr_b16 v[180:181], v4 offset:21504
    ds_read_b64_tr_b16 v[182:183], v7 offset:21504
    s_waitcnt lgkmcnt(4)
    s_nop 0
    v_mfma_f32_32x32x16_bf16 v[32:47], v[140:143], v[200:203], v[32:47]
    ds_read_b64_tr_b16 v[188:189], v4 offset:22528
    ds_read_b64_tr_b16 v[190:191], v7 offset:22528
    v_mfma_f32_32x32x16_bf16 v[48:63], v[140:143], v[204:207], v[48:63]
    ds_read_b64_tr_b16 v[192:193], v4 offset:23552
    ds_read_b64_tr_b16 v[194:195], v7 offset:23552
    s_waitcnt vmcnt(21)
    v_max_u32 v251, v147, v151
    v_max3_u32 v251, v251, v155, v159
    v_cmp_eq_u32 vcc, -1, v251
    s_nop 0
    s_cbranch_vccnz CK_8_r
CK_8_k:
    s_waitcnt lgkmcnt(4)
    v_mfma_f32_32x32x16_bf16 v[32:47], v[144:147], v[176:179], v[32:47]
    ds_read_b64_tr_b16 v[200:201], v4 offset:28672
    ds_read_b64_tr_b16 v[202:203], v7 offset:28672
    v_mfma_f32_32x32x16_bf16 v[48:63], v[144:147], v[180:183], v[48:63]
    ds_read_b64_tr_b16 v[204:205], v4 offset:29696
    ds_read_b64_tr_b16 v[206:207], v7 offset:29696
    s_waitcnt lgkmcnt(4)
    s_nop 0
    v_mfma_f32_32x32x16_bf16 v[32:47], v[148:151], v[188:191], v[32:47]
    ds_read_b64_tr_b16 v[176:177], v4 offset:30720
    ds_read_b64_tr_b16 v[178:179], v7 offset:30720
    v_mfma_f32_32x32x16_bf16 v[48:63], v[148:151], v[192:195], v[48:63]
    ds_read_b64_tr_b16 v[180:181], v4 offset:31744
    ds_read_b64_tr_b16 v[182:183], v7 offset:31744
    s_waitcnt vmcnt(7)
    v_max3_u32 v251, v73, v75, v77
    v_max3_u32 v251, v251, v79, v81
    v_max3_u32 v251, v251, v83, v85
    v_cmp_eq_u32 vcc, -1, v251
    s_nop 0
    s_cbranch_vccnz CK_9_r
CK_9_k:
    v_cmp_gt_u32 vcc, 32, v252
    s_nop 0
    s_cbranch_vccnz CC_10_r
CC_10_k:
    v_add_f32 v86, v72, v74
    v_add_f32 v87, v73, v75
    v_add_f32 v86, v86, v76
    v_add_f32 v87, v87, v77
    s_waitcnt lgkmcnt(4)
    v_mfma_f32_32x32x16_bf16 v[32:47], v[152:155], v[200:203], v[32:47]
    ds_read_b64_tr_b16 v[188:189], v5 offset:4096
    ds_read_b64_tr_b16 v[190:191], v8 offset:4096
    v_add_f32 v86, v86, v78
    v_add_f32 v87, v87, v79
    v_add_f32_e64 v86, v86, v80
    v_mfma_f32_32x32x16_bf16 v[48:63], v[152:155], v[204:207], v[48:63]
    ds_read_b64_tr_b16 v[192:193], v5 offset:5120
    ds_read_b64_tr_b16 v[194:195], v8 offset:5120
    v_add_f32 v87, v87, v81
    v_add_f32 v86, v86, v82
    v_add_f32 v87, v87, v83
    v_add_f32 v86, v86, v84
    s_waitcnt lgkmcnt(4)
    v_mfma_f32_32x32x16_bf16 v[32:47], v[156:159], v[176:179], v[32:47]
    ds_read_b64_tr_b16 v[200:201], v5 offset:6144
    ds_read_b64_tr_b16 v[202:203], v8 offset:6144
    v_add_f32 v87, v87, v85
    v_mov_b32 v12, v86
    s_nop 1
    v_permlane32_swap_b32 v12, v86
    v_mfma_f32_32x32x16_bf16 v[48:63], v[156:159], v[180:183], v[48:63]
    ds_read_b64_tr_b16 v[204:205], v5 offset:7168
    ds_read_b64_tr_b16 v[206:207], v8 offset:7168
    s_waitcnt vmcnt(15)
    v_max_u32_e64 v251, v163, v167
    v_max3_u32 v251, v251, v171, v175
    v_max3_u32 v251, v251, v67, v71
    v_cmp_eq_u32 vcc, -1, v251
    s_nop 0
    s_cbranch_vccnz CK_11_r
CK_11_k:
    v_add_f32 v12, v12, v86
    v_mul_f32 v88, 0x3d924925, v12
    v_mul_f32 v12, 0x3b124925, v12
    v_sub_f32 v72, v72, v88
    s_waitcnt lgkmcnt(4)
    v_mfma_f32_32x32x16_bf16 v[32:47], v[160:163], v[188:191], v[32:47]
    ds_read_b64_tr_b16 v[176:177], v5 offset:12288
    ds_read_b64_tr_b16 v[178:179], v8 offset:12288
    v_sub_f32 v74, v74, v88
    v_sub_f32 v76, v76, v88
    v_sub_f32_e64 v78, v78, v88
    v_mfma_f32_32x32x16_bf16 v[48:63], v[160:163], v[192:195], v[48:63]
    ds_read_b64_tr_b16 v[180:181], v5 offset:13312
    ds_read_b64_tr_b16 v[182:183], v8 offset:13312
    v_sub_f32 v80, v80, v88
    v_sub_f32 v82, v82, v88
    v_sub_f32 v84, v84, v88
    v_mul_f32 v89, v72, v72
    s_waitcnt lgkmcnt(4)
    v_mfma_f32_32x32x16_bf16 v[32:47], v[164:167], v[200:203], v[32:47]
    ds_read_b64_tr_b16 v[188:189], v5 offset:14336
    ds_read_b64_tr_b16 v[190:191], v8 offset:14336
    v_mul_f32 v90, v74, v74
    v_fmac_f32 v89, v76, v76
    v_fmac_f32 v90, v78, v78
    v_mfma_f32_32x32x16_bf16 v[48:63], v[164:167], v[204:207], v[48:63]
    ds_read_b64_tr_b16 v[192:193], v5 offset:15360
    ds_read_b64_tr_b16 v[194:195], v8 offset:15360
    v_fmac_f32 v89, v80, v80
    v_fmac_f32 v90, v82, v82
    v_fmac_f32 v89, v84, v84
    v_add_f32 v89, v89, v90
    s_waitcnt lgkmcnt(4)
    v_mfma_f32_32x32x16_bf16 v[32:47], v[168:171], v[176:179], v[32:47]
    ds_read_b64_tr_b16 v[200:201], v5 offset:20480
    ds_read_b64_tr_b16 v[202:203], v8 offset:20480
    v_fmac_f32 v87, 0x3d000000, v89
    v_mov_b32 v13, v87
    s_nop 1
    v_permlane32_swap_b32 v13, v87
    v_mfma_f32_32x32x16_bf16 v[48:63], v[168:171], v[180:183], v[48:63]
    ds_read_b64_tr_b16 v[204:205], v5 offset:21504
    ds_read_b64_tr_b16 v[206:207], v8 offset:21504
    v_add_f32_e64 v13, v13, v87
    v_mul_f32 v13, 0x3b124925, v13
    v_add_f32 v13, 0x3727c5ac, v13
    v_rsq_f32 v13, v13
    s_waitcnt lgkmcnt(4)
    v_mfma_f32_32x32x16_bf16 v[32:47], v[172:175], v[188:191], v[32:47]
    ds_read_b64_tr_b16 v[176:177], v5 offset:22528
    ds_read_b64_tr_b16 v[178:179], v8 offset:22528
    v_cmp_eq_u32 vcc, 0, v242
    s_nop 1
    v_cndmask_b32_e64 v3, v12, v13, vcc
    v_mfma_f32_32x32x16_bf16 v[48:63], v[172:175], v[192:195], v[48:63]
    ds_read_b64_tr_b16 v[180:181], v5 offset:23552
    ds_read_b64_tr_b16 v[182:183], v8 offset:23552
    s_waitcnt lgkmcnt(4)
    v_mfma_f32_32x32x16_bf16 v[32:47], v[64:67], v[200:203], v[32:47]
    v_mfma_f32_32x32x16_bf16 v[48:63], v[64:67], v[204:207], v[48:63]
    s_waitcnt lgkmcnt(0)
    v_mfma_f32_32x32x16_bf16 v[32:47], v[68:71], v[176:179], v[32:47]
    v_mfma_f32_32x32x16_bf16 v[48:63], v[68:71], v[180:183], v[48:63]
    ds_write_b32 v11, v3
    s_barrier

A1_2_epi:

    s_nop 0
    ds_read_b128 v[192:195], v15 offset:128
    ds_read_b128 v[176:179], v15 offset:0
    ds_read_b128 v[196:199], v15 offset:160
    ds_read_b128 v[180:183], v15 offset:32
    ds_read_b128 v[200:203], v15 offset:192
    ds_read_b128 v[184:187], v15 offset:64
    ds_read_b128 v[204:207], v15 offset:224
    ds_read_b128 v[188:191], v15 offset:96

    s_mov_b32 s59, 0x358637bd
    v_mov_b32 v0, 0x358637bd
    v_mov_b32 v1, 0x3fb8aa3b
    s_lshl_b32 s56, s3, 12
    s_add_u32 s56, s56, 0x10000
    v_add_u32 v2, s56, v240
    s_lshl_b32 s61, s3, 10
    s_add_u32 s56, s61, 0x10000
    v_add_u32 v3, s56, v240
    s_lshl_b32 s62, s45, 4
    s_add_u32 s62, s62, s44
    s_lshl_b32 s62, s62, 12
    s_add_u32 s62, s62, s61
    s_lshr_b32 s62, s62, 1
    s_add_u32 s62, s62, s51
    s_add_u32 s62, s62, 2097152
    s_waitcnt lgkmcnt(0)

    s_nop 0
    v_pk_fma_f32 v[32:33], v[192:193], v[248:249], v[32:33] op_sel_hi:[1,0,1] neg_lo:[1,0,0] neg_hi:[1,0,0]
    v_pk_fma_f32 v[34:35], v[194:195], v[248:249], v[34:35] op_sel_hi:[1,0,1] neg_lo:[1,0,0] neg_hi:[1,0,0]
    v_pk_fma_f32 v[36:37], v[196:197], v[248:249], v[36:37] op_sel_hi:[1,0,1] neg_lo:[1,0,0] neg_hi:[1,0,0]
    v_pk_fma_f32 v[38:39], v[198:199], v[248:249], v[38:39] op_sel_hi:[1,0,1] neg_lo:[1,0,0] neg_hi:[1,0,0]
    v_pk_fma_f32 v[40:41], v[200:201], v[248:249], v[40:41] op_sel_hi:[1,0,1] neg_lo:[1,0,0] neg_hi:[1,0,0]
    v_pk_fma_f32 v[42:43], v[202:203], v[248:249], v[42:43] op_sel_hi:[1,0,1] neg_lo:[1,0,0] neg_hi:[1,0,0]
    v_pk_fma_f32 v[44:45], v[204:205], v[248:249], v[44:45] op_sel_hi:[1,0,1] neg_lo:[1,0,0] neg_hi:[1,0,0]
    v_pk_fma_f32 v[46:47], v[206:207], v[248:249], v[46:47] op_sel_hi:[1,0,1] neg_lo:[1,0,0] neg_hi:[1,0,0]
    v_pk_fma_f32 v[32:33], v[32:33], v[176:177], v[0:1] op_sel_hi:[1,1,0]
    v_pk_fma_f32 v[34:35], v[34:35], v[178:179], v[0:1] op_sel_hi:[1,1,0]
    v_pk_fma_f32 v[36:37], v[36:37], v[180:181], v[0:1] op_sel_hi:[1,1,0]
    v_pk_fma_f32 v[38:39], v[38:39], v[182:183], v[0:1] op_sel_hi:[1,1,0]
    v_pk_fma_f32 v[40:41], v[40:41], v[184:185], v[0:1] op_sel_hi:[1,1,0]
    v_pk_fma_f32 v[42:43], v[42:43], v[186:187], v[0:1] op_sel_hi:[1,1,0]
    v_pk_fma_f32 v[44:45], v[44:45], v[188:189], v[0:1] op_sel_hi:[1,1,0]
    v_pk_fma_f32 v[46:47], v[46:47], v[190:191], v[0:1] op_sel_hi:[1,1,0]
    v_pk_mul_f32 v[208:209], v[32:33], v[0:1] op_sel:[0,1] op_sel_hi:[1,1]
    v_pk_mul_f32 v[210:211], v[34:35], v[0:1] op_sel:[0,1] op_sel_hi:[1,1]
    v_pk_mul_f32 v[212:213], v[36:37], v[0:1] op_sel:[0,1] op_sel_hi:[1,1]
    v_pk_mul_f32 v[214:215], v[38:39], v[0:1] op_sel:[0,1] op_sel_hi:[1,1]
    v_pk_mul_f32 v[216:217], v[40:41], v[0:1] op_sel:[0,1] op_sel_hi:[1,1]
    v_pk_mul_f32 v[218:219], v[42:43], v[0:1] op_sel:[0,1] op_sel_hi:[1,1]
    v_pk_mul_f32 v[220:221], v[44:45], v[0:1] op_sel:[0,1] op_sel_hi:[1,1]
    v_pk_mul_f32 v[222:223], v[46:47], v[0:1] op_sel:[0,1] op_sel_hi:[1,1]
    v_exp_f32_e64 v208, v208 clamp
    v_max_f32_e64 v32, s59, v32
    v_exp_f32_e64 v209, v209 clamp
    v_max_f32_e64 v33, s59, v33
    v_pk_fma_f32 v[48:49], v[192:193], v[248:249], v[48:49] op_sel:[0,1,0] op_sel_hi:[1,1,1] neg_lo:[1,0,0] neg_hi:[1,0,0]
    v_exp_f32_e64 v210, v210 clamp
    v_max_f32_e64 v34, s59, v34
    v_exp_f32_e64 v211, v211 clamp
    v_max_f32_e64 v35, s59, v35
    v_pk_fma_f32 v[50:51], v[194:195], v[248:249], v[50:51] op_sel:[0,1,0] op_sel_hi:[1,1,1] neg_lo:[1,0,0] neg_hi:[1,0,0]
    v_exp_f32_e64 v212, v212 clamp
    v_max_f32_e64 v36, s59, v36
    v_exp_f32_e64 v213, v213 clamp
    v_max_f32_e64 v37, s59, v37
    v_pk_fma_f32 v[52:53], v[196:197], v[248:249], v[52:53] op_sel:[0,1,0] op_sel_hi:[1,1,1] neg_lo:[1,0,0] neg_hi:[1,0,0]
    v_exp_f32_e64 v214, v214 clamp
    v_max_f32_e64 v38, s59, v38
    v_exp_f32_e64 v215, v215 clamp
    v_max_f32_e64 v39, s59, v39
    v_pk_fma_f32 v[54:55], v[198:199], v[248:249], v[54:55] op_sel:[0,1,0] op_sel_hi:[1,1,1] neg_lo:[1,0,0] neg_hi:[1,0,0]
    v_exp_f32_e64 v216, v216 clamp
    v_max_f32_e64 v40, s59, v40
    v_exp_f32_e64 v217, v217 clamp
    v_max_f32_e64 v41, s59, v41
    v_pk_fma_f32 v[56:57], v[200:201], v[248:249], v[56:57] op_sel:[0,1,0] op_sel_hi:[1,1,1] neg_lo:[1,0,0] neg_hi:[1,0,0]
    v_exp_f32_e64 v218, v218 clamp
    v_max_f32_e64 v42, s59, v42
    v_exp_f32_e64 v219, v219 clamp
    v_max_f32_e64 v43, s59, v43
    v_pk_fma_f32 v[58:59], v[202:203], v[248:249], v[58:59] op_sel:[0,1,0] op_sel_hi:[1,1,1] neg_lo:[1,0,0] neg_hi:[1,0,0]
    v_exp_f32_e64 v220, v220 clamp
    v_max_f32_e64 v44, s59, v44
    v_exp_f32_e64 v221, v221 clamp
    v_max_f32_e64 v45, s59, v45
    v_pk_fma_f32 v[60:61], v[204:205], v[248:249], v[60:61] op_sel:[0,1,0] op_sel_hi:[1,1,1] neg_lo:[1,0,0] neg_hi:[1,0,0]
    v_exp_f32_e64 v222, v222 clamp
    v_max_f32_e64 v46, s59, v46
    v_exp_f32_e64 v223, v223 clamp
    v_max_f32_e64 v47, s59, v47
    v_pk_fma_f32 v[62:63], v[206:207], v[248:249], v[62:63] op_sel:[0,1,0] op_sel_hi:[1,1,1] neg_lo:[1,0,0] neg_hi:[1,0,0]
    v_pk_mul_f32 v[48:49], v[48:49], v[176:177]
    v_pk_mul_f32 v[50:51], v[50:51], v[178:179]
    v_pk_mul_f32 v[52:53], v[52:53], v[180:181]
    v_pk_mul_f32 v[54:55], v[54:55], v[182:183]
    v_pk_mul_f32 v[56:57], v[56:57], v[184:185]
    v_pk_mul_f32 v[58:59], v[58:59], v[186:187]
    v_pk_mul_f32 v[60:61], v[60:61], v[188:189]
    v_pk_mul_f32 v[62:63], v[62:63], v[190:191]
    v_pk_add_f32 v[32:33], v[32:33], v[208:209]
    v_pk_add_f32 v[34:35], v[34:35], v[210:211]
    v_pk_add_f32 v[36:37], v[36:37], v[212:213]
    v_pk_add_f32 v[38:39], v[38:39], v[214:215]
    v_pk_add_f32 v[40:41], v[40:41], v[216:217]
    v_pk_add_f32 v[42:43], v[42:43], v[218:219]
    v_pk_add_f32 v[44:45], v[44:45], v[220:221]
    v_pk_add_f32 v[46:47], v[46:47], v[222:223]
    v_cvt_pk_bf16_f32 v48, v48, v49
    v_cvt_pk_bf16_f32 v49, v50, v51
    v_cvt_pk_bf16_f32 v50, v52, v53
    v_cvt_pk_bf16_f32 v51, v54, v55
    v_cvt_pk_bf16_f32 v52, v56, v57
    v_cvt_pk_bf16_f32 v53, v58, v59
    v_cvt_pk_bf16_f32 v54, v60, v61
    v_cvt_pk_bf16_f32 v55, v62, v63
    s_mov_b32 exec_lo, 0xf0000000
    s_mov_b32 exec_hi, 0xf0000000
    v_mov_b32 v48, 0x3f803f80
    v_mov_b32 v49, 0x3f803f80
    v_mov_b32 v50, 0x3f803f80
    v_mov_b32 v51, 0x3f803f80
    v_mov_b32 v52, 0x3f803f80
    v_mov_b32 v53, 0x3f803f80
    v_mov_b32 v54, 0x3f803f80
    v_mov_b32 v55, 0x3f803f80
    s_mov_b64 exec, -1
    s_nop 0
    v_cvt_pk_bf16_f32 v32, v32, v33
    v_cvt_pk_bf16_f32 v33, v34, v35
    v_cvt_pk_bf16_f32 v34, v36, v37
    v_cvt_pk_bf16_f32 v35, v38, v39
    v_cvt_pk_bf16_f32 v36, v40, v41
    v_cvt_pk_bf16_f32 v37, v42, v43
    v_cvt_pk_bf16_f32 v38, v44, v45
    v_cvt_pk_bf16_f32 v39, v46, v47
    v_mfma_f32_32x32x16_bf16 v[176:191], v[32:35], v[48:51], 0
    s_nop 0
    v_mfma_f32_32x32x16_bf16 v[176:191], v[36:39], v[52:55], v[176:191]
    s_nop 11
    ds_write_b128 v2, v[176:179] offset:0
    ds_write_b128 v2, v[180:183] offset:1024
    ds_write_b128 v2, v[184:187] offset:2048
    ds_write_b128 v2, v[188:191] offset:3072
    s_cmp_eq_u32 s50, 0
    s_cbranch_scc1 A1_2_le
A1_2_ler:
    s_waitcnt lgkmcnt(0)
    s_barrier
    ds_read_b128 v[192:195], v3 offset:0
    ds_read_b128 v[196:199], v3 offset:4096
    ds_read_b128 v[200:203], v3 offset:8192
    ds_read_b128 v[204:207], v3 offset:12288

    s_waitcnt lgkmcnt(0)
    s_nop 0
    v_pk_add_f32 v[192:193], v[192:193], v[196:197]
    v_pk_add_f32 v[194:195], v[194:195], v[198:199]
    v_pk_add_f32 v[200:201], v[200:201], v[204:205]
    v_pk_add_f32 v[202:203], v[202:203], v[206:207]
    v_pk_add_f32 v[192:193], v[192:193], v[200:201]
    v_pk_add_f32 v[194:195], v[194:195], v[202:203]
    v_cvt_pk_bf16_f32 v192, v192, v193
    v_cvt_pk_bf16_f32 v193, v194, v195
    buffer_store_dwordx2 v[192:193], v245, s[36:39], s62 offen sc1

    s_lshl_b32 s62, s45, 15
    s_lshl_b32 s60, s3, 9
    s_add_u32 s62, s62, s60
    s_add_u32 s62, s62, s51
    s_add_u32 s62, s62, 2097152
    v_cmp_le_u32 vcc, 14, v243
    s_nop 1
    v_cndmask_b32 v186, 0, 1, vcc
    v_mul_u32_u24 v187, 14, v186
    v_sub_u32 v187, v243, v187
    v_cmp_le_u32 vcc, 28, v243
    v_and_b32 v184, 1, v243
    v_add_u32 v184, 14, v184
    v_cndmask_b32 v187, v187, v184, vcc
    v_bfe_u32 v184, v243, 1, 1
    v_cndmask_b32 v186, v186, v184, vcc
    v_and_b32 v184, 3, v187
    v_lshrrev_b32_e64 v187, 2, v187
    v_lshl_add_u32 v184, v187, 3, v184
    v_lshl_add_u32 v184, v186, 2, v184
    v_lshl_add_u32 v184, v242, 5, v184
    s_lshl_b32 s60, s53, 10
    s_lshl_b32 s57, s54, 3
    s_add_u32 s60, s60, s57
    s_add_u32 s60, s60, 155648
    v_lshlrev_b32 v195, 4, v184
    v_add_u32 v195, s60, v195
    s_cmp_eq_u32 s3, 3
    s_cselect_b32 s66, 0, -1

    s_cmp_eq_u32 s50, 0
    s_cbranch_scc1 A1_2_cq
    s_nop 0
    ds_read_b64_tr_b16 v[56:57], v5 offset:26624
    ds_read_b64_tr_b16 v[58:59], v8 offset:26624
    ds_read_b64_tr_b16 v[60:61], v5 offset:27648
    ds_read_b64_tr_b16 v[62:63], v8 offset:27648
    ds_read_b64_tr_b16 v[32:33], v5 offset:30720
    ds_read_b64_tr_b16 v[34:35], v8 offset:30720
    ds_read_b64_tr_b16 v[36:37], v5 offset:31744
    ds_read_b64_tr_b16 v[38:39], v8 offset:31744
    ds_read_b64_tr_b16 v[40:41], v6 offset:2048
    ds_read_b64_tr_b16 v[42:43], v9 offset:2048
    ds_read_b64_tr_b16 v[44:45], v6 offset:3072
    ds_read_b64_tr_b16 v[46:47], v9 offset:3072
    s_waitcnt lgkmcnt(10)
    s_nop 0
    v_mfma_f32_32x32x16_bf16 v[16:31], v[56:59], v[128:131], v[16:31]
    s_add_u32 m0, s75, 47104
    s_add_u32 s58, s74, 100352
    buffer_load_dwordx4 v250, s[12:15], s58 offen lds
    ds_read_b64_tr_b16 v[48:49], v6 offset:6144
    ds_read_b64_tr_b16 v[50:51], v9 offset:6144
    s_waitcnt lgkmcnt(10)
    s_nop 0
    v_mfma_f32_32x32x16_bf16 v[16:31], v[60:63], v[132:135], v[16:31]
    s_add_u32 m0, s75, 49152
    s_add_u32 s58, s74, 114688
    buffer_load_dwordx4 v250, s[12:15], s58 offen lds
    ds_read_b64_tr_b16 v[52:53], v6 offset:7168
    ds_read_b64_tr_b16 v[54:55], v9 offset:7168
    s_waitcnt lgkmcnt(10)
    s_nop 0
    v_mfma_f32_32x32x16_bf16 v[16:31], v[32:35], v[136:139], v[16:31]
    s_add_u32 m0, s75, 51200
    s_add_u32 s58, s74, 129024
    buffer_load_dwordx4 v250, s[12:15], s58 offen lds
    ds_read_b64_tr_b16 v[56:57], v6 offset:10240
    ds_read_b64_tr_b16 v[58:59], v9 offset:10240
    s_waitcnt lgkmcnt(10)
    s_nop 0
    v_mfma_f32_32x32x16_bf16 v[16:31], v[36:39], v[140:143], v[16:31]
    s_add_u32 m0, s75, 53248
    s_add_u32 s58, s74, 143360
    buffer_load_dwordx4 v250, s[12:15], s58 offen lds
    ds_read_b64_tr_b16 v[60:61], v6 offset:11264
    ds_read_b64_tr_b16 v[62:63], v9 offset:11264
    s_waitcnt lgkmcnt(10)
    s_nop 0
    v_mfma_f32_32x32x16_bf16 v[16:31], v[40:43], v[144:147], v[16:31]
    s_add_u32 m0, s75, 55296
    s_add_u32 s58, s74, 157696
    buffer_load_dwordx4 v250, s[12:15], s58 offen lds
    ds_read_b64_tr_b16 v[32:33], v6 offset:14336
    ds_read_b64_tr_b16 v[34:35], v9 offset:14336
    s_waitcnt lgkmcnt(10)
    s_nop 0
    v_mfma_f32_32x32x16_bf16 v[16:31], v[44:47], v[148:151], v[16:31]
    s_add_u32 m0, s75, 57344
    s_add_u32 s58, s74, 172032
    buffer_load_dwordx4 v250, s[12:15], s58 offen lds
    ds_read_b64_tr_b16 v[36:37], v6 offset:15360
    ds_read_b64_tr_b16 v[38:39], v9 offset:15360
    s_waitcnt lgkmcnt(10)
    s_nop 0
    v_mfma_f32_32x32x16_bf16 v[16:31], v[48:51], v[152:155], v[16:31]
    s_add_u32 m0, s75, 59392
    s_add_u32 s58, s74, 186368
    buffer_load_dwordx4 v250, s[12:15], s58 offen lds
    ds_read_b64_tr_b16 v[40:41], v6 offset:18432
    ds_read_b64_tr_b16 v[42:43], v9 offset:18432
    s_waitcnt lgkmcnt(10)
    s_nop 0
    v_mfma_f32_32x32x16_bf16 v[16:31], v[52:55], v[156:159], v[16:31]
    s_add_u32 m0, s75, 61440
    s_add_u32 s58, s74, 200704
    buffer_load_dwordx4 v250, s[12:15], s58 offen lds
    ds_read_b64_tr_b16 v[44:45], v6 offset:19456
    ds_read_b64_tr_b16 v[46:47], v9 offset:19456
    s_waitcnt lgkmcnt(10)
    v_mfma_f32_32x32x16_bf16 v[16:31], v[56:59], v[160:163], v[16:31]
    s_waitcnt lgkmcnt(8)
    v_mfma_f32_32x32x16_bf16 v[16:31], v[60:63], v[164:167], v[16:31]
    s_waitcnt lgkmcnt(6)
    v_mfma_f32_32x32x16_bf16 v[16:31], v[32:35], v[168:171], v[16:31]
    s_waitcnt lgkmcnt(4)
    v_mfma_f32_32x32x16_bf16 v[16:31], v[36:39], v[172:175], v[16:31]
    s_waitcnt lgkmcnt(2)
    v_mfma_f32_32x32x16_bf16 v[16:31], v[40:43], v[64:67], v[16:31]
    s_waitcnt lgkmcnt(0)
    v_mfma_f32_32x32x16_bf16 v[16:31], v[44:47], v[68:71], v[16:31]
A1_2_cqr:
    v_lshlrev_b32_e64 v2, 4, v242
    v_add_u32 v2, 159744, v2
    ds_read_b128 v[208:211], v2 offset:0
    ds_read_b128 v[212:215], v2 offset:32
    ds_read_b128 v[216:219], v2 offset:64
    ds_read_b128 v[220:223], v2 offset:96

    s_lshl_b32 s61, s44, 2
    s_add_u32 s61, s61, s3
    s_lshl_b32 s61, s61, 4
    s_add_u32 s61, s61, s45
    s_lshl_b32 s61, s61, 11
    s_add_u32 s61, s61, s51
    s_waitcnt lgkmcnt(0)

    s_nop 0
    v_pk_fma_f32 v[16:17], v[208:209], v[12:13], v[16:17] op_sel_hi:[1,0,1] neg_lo:[1,0,0] neg_hi:[1,0,0]
    v_pk_fma_f32 v[18:19], v[210:211], v[12:13], v[18:19] op_sel_hi:[1,0,1] neg_lo:[1,0,0] neg_hi:[1,0,0]
    v_pk_fma_f32 v[20:21], v[212:213], v[12:13], v[20:21] op_sel_hi:[1,0,1] neg_lo:[1,0,0] neg_hi:[1,0,0]
    v_pk_fma_f32 v[22:23], v[214:215], v[12:13], v[22:23] op_sel_hi:[1,0,1] neg_lo:[1,0,0] neg_hi:[1,0,0]
    v_pk_fma_f32 v[24:25], v[216:217], v[12:13], v[24:25] op_sel_hi:[1,0,1] neg_lo:[1,0,0] neg_hi:[1,0,0]
    v_pk_fma_f32 v[26:27], v[218:219], v[12:13], v[26:27] op_sel_hi:[1,0,1] neg_lo:[1,0,0] neg_hi:[1,0,0]
    v_pk_fma_f32 v[28:29], v[220:221], v[12:13], v[28:29] op_sel_hi:[1,0,1] neg_lo:[1,0,0] neg_hi:[1,0,0]
    v_pk_fma_f32 v[30:31], v[222:223], v[12:13], v[30:31] op_sel_hi:[1,0,1] neg_lo:[1,0,0] neg_hi:[1,0,0]
    v_pk_fma_f32 v[16:17], v[16:17], v[12:13], v[0:1] op_sel:[0,1,0] op_sel_hi:[1,1,0]
    v_pk_fma_f32 v[18:19], v[18:19], v[12:13], v[0:1] op_sel:[0,1,0] op_sel_hi:[1,1,0]
    v_pk_fma_f32 v[20:21], v[20:21], v[12:13], v[0:1] op_sel:[0,1,0] op_sel_hi:[1,1,0]
    v_pk_fma_f32 v[22:23], v[22:23], v[12:13], v[0:1] op_sel:[0,1,0] op_sel_hi:[1,1,0]
    v_pk_fma_f32 v[24:25], v[24:25], v[12:13], v[0:1] op_sel:[0,1,0] op_sel_hi:[1,1,0]
    v_pk_fma_f32 v[26:27], v[26:27], v[12:13], v[0:1] op_sel:[0,1,0] op_sel_hi:[1,1,0]
    v_pk_fma_f32 v[28:29], v[28:29], v[12:13], v[0:1] op_sel:[0,1,0] op_sel_hi:[1,1,0]
    v_pk_fma_f32 v[30:31], v[30:31], v[12:13], v[0:1] op_sel:[0,1,0] op_sel_hi:[1,1,0]
    v_pk_mul_f32 v[208:209], v[16:17], v[0:1] op_sel:[0,1] op_sel_hi:[1,1]
    v_pk_mul_f32 v[210:211], v[18:19], v[0:1] op_sel:[0,1] op_sel_hi:[1,1]
    v_pk_mul_f32 v[212:213], v[20:21], v[0:1] op_sel:[0,1] op_sel_hi:[1,1]
    v_pk_mul_f32 v[214:215], v[22:23], v[0:1] op_sel:[0,1] op_sel_hi:[1,1]
    v_pk_mul_f32 v[216:217], v[24:25], v[0:1] op_sel:[0,1] op_sel_hi:[1,1]
    v_pk_mul_f32 v[218:219], v[26:27], v[0:1] op_sel:[0,1] op_sel_hi:[1,1]
    v_pk_mul_f32 v[220:221], v[28:29], v[0:1] op_sel:[0,1] op_sel_hi:[1,1]
    v_pk_mul_f32 v[222:223], v[30:31], v[0:1] op_sel:[0,1] op_sel_hi:[1,1]
    v_exp_f32_e64 v208, v208 clamp
    v_max_f32_e64 v16, s59, v16
    v_exp_f32_e64 v209, v209 clamp
    v_max_f32_e64 v17, s59, v17
    v_exp_f32_e64 v210, v210 clamp
    v_max_f32_e64 v18, s59, v18
    v_exp_f32_e64 v211, v211 clamp
    v_max_f32_e64 v19, s59, v19
    v_exp_f32_e64 v212, v212 clamp
    v_max_f32_e64 v20, s59, v20
    v_exp_f32_e64 v213, v213 clamp
    v_max_f32_e64 v21, s59, v21
    v_exp_f32_e64 v214, v214 clamp
    v_max_f32_e64 v22, s59, v22
    v_exp_f32_e64 v215, v215 clamp
    v_max_f32_e64 v23, s59, v23
    v_exp_f32_e64 v216, v216 clamp
    v_max_f32_e64 v24, s59, v24
    v_exp_f32_e64 v217, v217 clamp
    v_max_f32_e64 v25, s59, v25
    v_exp_f32_e64 v218, v218 clamp
    v_max_f32_e64 v26, s59, v26
    v_exp_f32_e64 v219, v219 clamp
    v_max_f32_e64 v27, s59, v27
    v_exp_f32_e64 v220, v220 clamp
    v_max_f32_e64 v28, s59, v28
    v_exp_f32_e64 v221, v221 clamp
    v_max_f32_e64 v29, s59, v29
    v_exp_f32_e64 v222, v222 clamp
    v_max_f32_e64 v30, s59, v30
    v_exp_f32_e64 v223, v223 clamp
    v_max_f32_e64 v31, s59, v31
    v_pk_add_f32 v[16:17], v[16:17], v[208:209]
    v_pk_add_f32 v[18:19], v[18:19], v[210:211]
    v_pk_add_f32 v[20:21], v[20:21], v[212:213]
    v_pk_add_f32 v[22:23], v[22:23], v[214:215]
    v_pk_add_f32 v[24:25], v[24:25], v[216:217]
    v_pk_add_f32 v[26:27], v[26:27], v[218:219]
    v_pk_add_f32 v[28:29], v[28:29], v[220:221]
    v_pk_add_f32 v[30:31], v[30:31], v[222:223]
    v_cvt_pk_bf16_f32 v208, v16, v17
    v_cvt_pk_bf16_f32 v209, v18, v19
    v_cvt_pk_bf16_f32 v210, v20, v21
    v_cvt_pk_bf16_f32 v211, v22, v23
    v_cvt_pk_bf16_f32 v212, v24, v25
    v_cvt_pk_bf16_f32 v213, v26, v27
    v_cvt_pk_bf16_f32 v214, v28, v29
    v_cvt_pk_bf16_f32 v215, v30, v31
    s_mov_b32 s63, s61
    s_cmp_ge_u32 s49, 8
    s_cbranch_scc1 L_helper

    s_lshl_b32 s61, s47, 1
    s_add_u32 s61, s61, s54
    s_lshl_b32 s88, s61, 15
    s_lshl_b32 s57, s53, 14
    s_add_u32 s88, s88, s57
    s_add_u32 s88, s88, s51
    s_add_u32 s89, s88, 0x2000
    s_lshl_b32 s67, s53, 16
    s_add_u32 s67, s67, 0x8000

    v_lshrrev_b32 v2, 2, v244
    v_and_b32 v2, 3, v2
    v_mul_u32_u24 v3, 14, v242
    v_add_u32 v2, v2, v3
    v_bfe_u32 v3, v2, 1, 1
    v_xor_b32 v3, s53, v3
    v_lshlrev_b32 v2, 7, v2
    v_lshl_add_u32 v2, v3, 6, v2
    v_lshrrev_b32 v3, 4, v244
    v_and_b32 v3, 1, v3
    v_lshl_add_u32 v2, v3, 5, v2
    v_and_b32_e64 v3, 3, v244
    v_lshl_add_u32 v6, v3, 3, v2
    v_add_u32 v6, s67, v6
    v_xor_b32 v7, 64, v6

    s_lshl_b32 s56, s3, 13
    s_add_u32 s56, s56, 131072
    v_add_u32 v8, s56, v240
    v_xor_b32 v9, 16384, v8

    s_mul_i32 s64, s61, 3584
    s_add_u32 s64, s64, s51
    s_add_u32 s64, s64, 2621440
    s_lshl_b32 s57, s46, 1
    s_add_u32 s57, s57, s53
    s_lshl_b32 s65, s57, 8
    s_add_u32 s65, s65, s64
    s_lshl_b32 s68, s57, 17
    s_lshl_b32 s56, s61, 11
    s_add_u32 s68, s68, s56
    s_add_u32 s68, s68, s51
    s_add_u32 s68, s68, 2850816

    s_cmp_eq_u32 s50, 0
    s_cbranch_scc1 A2_13_s0
    v_mov_b32 v16, v224
    v_mov_b32 v17, v225
    v_mov_b32 v18, v226
    v_mov_b32 v19, v227
    v_mov_b32 v20, v228
    v_mov_b32 v21, v229
    v_mov_b32 v22, v230
    v_mov_b32 v23, v231
    v_mov_b32 v24, v232
    v_mov_b32 v25, v233
    v_mov_b32 v26, v234
    v_mov_b32 v27, v235
    v_mov_b32 v28, v236
    v_mov_b32 v29, v237
    v_mov_b32 v30, v238
    v_mov_b32 v31, v239
    s_add_u32 s58, s62, 0
    buffer_load_dwordx2 v[160:161], v245, s[36:39], s58 offen offset:0 sc1
    buffer_load_dwordx2 v[162:163], v245, s[36:39], s58 offen offset:2048 sc1
    s_add_u32 s58, s62, 4096
    buffer_load_dwordx2 v[164:165], v245, s[36:39], s58 offen offset:0 sc1
    buffer_load_dwordx2 v[166:167], v245, s[36:39], s58 offen offset:2048 sc1
    s_add_u32 s58, s62, 8192
    buffer_load_dwordx2 v[168:169], v245, s[36:39], s58 offen offset:0 sc1
    buffer_load_dwordx2 v[170:171], v245, s[36:39], s58 offen offset:2048 sc1
    s_add_u32 s58, s62, 12288
    buffer_load_dwordx2 v[172:173], v245, s[36:39], s58 offen offset:0 sc1
    buffer_load_dwordx2 v[174:175], v245, s[36:39], s58 offen offset:2048 sc1
    s_add_u32 s58, s62, 16384
    buffer_load_dwordx2 v[176:177], v245, s[36:39], s58 offen offset:0 sc1
    buffer_load_dwordx2 v[178:179], v245, s[36:39], s58 offen offset:2048 sc1
    s_add_u32 s58, s62, 20480
    buffer_load_dwordx2 v[180:181], v245, s[36:39], s58 offen offset:0 sc1
    buffer_load_dwordx2 v[182:183], v245, s[36:39], s58 offen offset:2048 sc1
    s_add_u32 s58, s62, 24576
    buffer_load_dwordx2 v[184:185], v245, s[36:39], s58 offen offset:0 sc1
    buffer_load_dwordx2 v[186:187], v245, s[36:39], s58 offen offset:2048 sc1
    s_add_u32 s58, s62, 28672
    buffer_load_dwordx2 v[188:189], v245, s[36:39], s58 offen offset:0 sc1
    buffer_load_dwordx2 v[190:191], v245, s[36:39], s58 offen offset:2048 sc1
    s_waitcnt vmcnt(0)
A2_13_s0r:
    v_mov_b32 v204, 0x3f80
    v_mov_b32 v205, 0x3f800000
    v_add_u32 v206, 155648, v240
    v_max_u32_e64 v251, v161, v163
    v_max3_u32 v251, v251, v165, v167
    v_max3_u32 v251, v251, v169, v171
    v_max3_u32 v251, v251, v173, v175
    v_max3_u32 v251, v251, v177, v179
    v_max3_u32 v251, v251, v181, v183
    v_max3_u32 v251, v251, v185, v187
    v_max3_u32 v251, v251, v189, v191
    v_cmp_eq_u32 vcc, -1, v251
    s_nop 0
    s_cbranch_vccnz CK_14_r
CK_14_k:
    s_nop 0
    v_dot2_f32_bf16 v200, v160, v204, 0
    v_dot2_f32_bf16 v201, v160, v205, 0
    v_dot2_f32_bf16 v202, v161, v204, 0
    v_dot2_f32_bf16 v203, v161, v205, 0
    v_dot2_f32_bf16 v200, v162, v204, v200
    v_dot2_f32_bf16 v201, v162, v205, v201
    v_dot2_f32_bf16 v202, v163, v204, v202
    v_dot2_f32_bf16 v203, v163, v205, v203
    v_dot2_f32_bf16 v200, v164, v204, v200
    v_dot2_f32_bf16 v201, v164, v205, v201
    v_dot2_f32_bf16 v202, v165, v204, v202
    v_dot2_f32_bf16 v203, v165, v205, v203
    v_dot2_f32_bf16 v200, v166, v204, v200
    v_dot2_f32_bf16 v201, v166, v205, v201
    v_dot2_f32_bf16 v202, v167, v204, v202
    v_dot2_f32_bf16 v203, v167, v205, v203
    v_dot2_f32_bf16 v200, v168, v204, v200
    v_dot2_f32_bf16 v201, v168, v205, v201
    v_dot2_f32_bf16 v202, v169, v204, v202
    v_dot2_f32_bf16 v203, v169, v205, v203
    v_dot2_f32_bf16 v200, v170, v204, v200
    v_dot2_f32_bf16 v201, v170, v205, v201
    v_dot2_f32_bf16 v202, v171, v204, v202
    v_dot2_f32_bf16 v203, v171, v205, v203
    v_dot2_f32_bf16 v200, v172, v204, v200
    v_dot2_f32_bf16 v201, v172, v205, v201
    v_dot2_f32_bf16 v202, v173, v204, v202
    v_dot2_f32_bf16 v203, v173, v205, v203
    v_dot2_f32_bf16 v200, v174, v204, v200
    v_dot2_f32_bf16 v201, v174, v205, v201
    v_dot2_f32_bf16 v202, v175, v204, v202
    v_dot2_f32_bf16 v203, v175, v205, v203
    v_dot2_f32_bf16 v200, v176, v204, v200
    v_dot2_f32_bf16 v201, v176, v205, v201
    v_dot2_f32_bf16 v202, v177, v204, v202
    v_dot2_f32_bf16 v203, v177, v205, v203
    v_dot2_f32_bf16 v200, v178, v204, v200
    v_dot2_f32_bf16 v201, v178, v205, v201
    v_dot2_f32_bf16 v202, v179, v204, v202
    v_dot2_f32_bf16 v203, v179, v205, v203
    v_dot2_f32_bf16 v200, v180, v204, v200
    v_dot2_f32_bf16 v201, v180, v205, v201
    v_dot2_f32_bf16 v202, v181, v204, v202
    v_dot2_f32_bf16 v203, v181, v205, v203
    v_dot2_f32_bf16 v200, v182, v204, v200
    v_dot2_f32_bf16 v201, v182, v205, v201
    v_dot2_f32_bf16 v202, v183, v204, v202
    v_dot2_f32_bf16 v203, v183, v205, v203
    v_dot2_f32_bf16 v200, v184, v204, v200
    v_dot2_f32_bf16 v201, v184, v205, v201
    v_dot2_f32_bf16 v202, v185, v204, v202
    v_dot2_f32_bf16 v203, v185, v205, v203
    v_dot2_f32_bf16 v200, v186, v204, v200
    v_dot2_f32_bf16 v201, v186, v205, v201
    v_dot2_f32_bf16 v202, v187, v204, v202
    v_dot2_f32_bf16 v203, v187, v205, v203
    v_dot2_f32_bf16 v200, v188, v204, v200
    v_dot2_f32_bf16 v201, v188, v205, v201
    v_dot2_f32_bf16 v202, v189, v204, v202
    v_dot2_f32_bf16 v203, v189, v205, v203
    v_dot2_f32_bf16 v200, v190, v204, v200
    v_dot2_f32_bf16 v201, v190, v205, v201
    v_dot2_f32_bf16 v202, v191, v204, v202
    v_dot2_f32_bf16 v203, v191, v205, v203

    v_mov_b32 v196, 0
    v_mov_b32 v197, 0
    s_mov_b32 exec_hi, s66
    v_cvt_pk_bf16_f32 v196, v200, v201
    v_cvt_pk_bf16_f32 v197, v202, v203
    s_mov_b64 exec, -1
    ds_write_b64 v195, v[196:197]
    s_waitcnt lgkmcnt(0)
    s_barrier
    ds_read_b128 v[216:219], v206
    ds_read_b128 v[220:223], v206 offset:1024
    s_waitcnt lgkmcnt(1)
    v_mfma_f32_32x32x16_bf16 v[160:175], v[216:219], v[208:211], 0
    s_waitcnt lgkmcnt(0)
    v_mfma_f32_32x32x16_bf16 v[160:175], v[220:223], v[212:215], v[160:175]
    v_mov_b32 v183, 0
    s_nop 10
    v_add_f32 v196, 0x358637bd, v175
    v_rcp_f32 v196, v196

    s_nop 0
    v_pk_mul_f32 v[160:161], v[160:161], v[196:197] op_sel_hi:[1,0]
    v_pk_mul_f32 v[162:163], v[162:163], v[196:197] op_sel_hi:[1,0]
    v_pk_mul_f32 v[164:165], v[164:165], v[196:197] op_sel_hi:[1,0]
    v_pk_mul_f32 v[166:167], v[166:167], v[196:197] op_sel_hi:[1,0]
    v_pk_mul_f32 v[168:169], v[168:169], v[196:197] op_sel_hi:[1,0]
    v_pk_mul_f32 v[170:171], v[170:171], v[196:197] op_sel_hi:[1,0]
    v_pk_mul_f32 v[172:173], v[172:173], v[196:197] op_sel_hi:[1,0]
    v_cvt_pk_bf16_f32 v176, v160, v161
    v_cvt_pk_bf16_f32 v177, v162, v163
    v_cvt_pk_bf16_f32 v178, v164, v165
    v_cvt_pk_bf16_f32 v179, v166, v167
    v_cvt_pk_bf16_f32 v180, v168, v169
    v_cvt_pk_bf16_f32 v181, v170, v171
    v_cvt_pk_bf16_f32 v182, v172, v173
    s_cmp_eq_u32 s100, 0
    s_cbranch_scc1 LS_15_g
    buffer_store_dwordx4 v[176:179], v240, s[36:39], s63 offen
    buffer_store_dwordx4 v[180:183], v240, s[36:39], s63 offen offset:1024
LS_15_r:
    s_add_u32 m0, s55, 0
    s_add_u32 s58, s72, 0
    buffer_load_dwordx4 v246, s[16:19], s58 offen lds
    s_add_u32 m0, s55, 1024
    s_add_u32 s58, s72, 28672
    buffer_load_dwordx4 v246, s[16:19], s58 offen lds
    s_add_u32 m0, s55, 2048
    s_add_u32 s58, s72, 57344
    buffer_load_dwordx4 v246, s[16:19], s58 offen lds
    s_add_u32 m0, s55, 3072
    s_add_u32 s58, s72, 86016
    buffer_load_dwordx4 v246, s[16:19], s58 offen lds
    s_add_u32 m0, s55, 4096
    s_add_u32 s58, s72, 114688
    buffer_load_dwordx4 v246, s[16:19], s58 offen lds
    s_add_u32 m0, s55, 5120
    s_add_u32 s58, s72, 143360
    buffer_load_dwordx4 v246, s[16:19], s58 offen lds
    s_add_u32 m0, s55, 6144
    s_add_u32 s58, s72, 172032
    buffer_load_dwordx4 v246, s[16:19], s58 offen lds
    s_add_u32 m0, s55, 7168
    s_add_u32 s58, s72, 200704
    buffer_load_dwordx4 v246, s[16:19], s58 offen lds
    buffer_load_dwordx4 v[160:163], v240, s[36:39], s88 offen offset:0 sc1
    buffer_load_dwordx4 v[164:167], v240, s[36:39], s88 offen offset:1024 sc1
    buffer_load_dwordx4 v[168:171], v240, s[36:39], s88 offen offset:2048 sc1
    buffer_load_dwordx4 v[172:175], v240, s[36:39], s88 offen offset:3072 sc1
    buffer_load_dwordx4 v[176:179], v241, s[36:39], s88 offen offset:0 sc1
    buffer_load_dwordx4 v[180:183], v241, s[36:39], s88 offen offset:1024 sc1
    buffer_load_dwordx4 v[184:187], v241, s[36:39], s88 offen offset:2048 sc1
    buffer_load_dwordx4 v[188:191], v241, s[36:39], s88 offen offset:3072 sc1
    buffer_load_dwordx4 v[192:195], v240, s[36:39], s89 offen offset:0 sc1
    buffer_load_dwordx4 v[196:199], v240, s[36:39], s89 offen offset:1024 sc1
    buffer_load_dwordx4 v[200:203], v240, s[36:39], s89 offen offset:2048 sc1
    buffer_load_dwordx4 v[204:207], v240, s[36:39], s89 offen offset:3072 sc1
    buffer_load_dwordx4 v[208:211], v241, s[36:39], s89 offen offset:0 sc1
    buffer_load_dwordx4 v[212:215], v241, s[36:39], s89 offen offset:1024 sc1
    buffer_load_dwordx4 v[216:219], v241, s[36:39], s89 offen offset:2048 sc1
    buffer_load_dwordx4 v[220:223], v241, s[36:39], s89 offen offset:3072 sc1
    s_cmp_eq_u32 s50, 0
    s_cbranch_scc1 A2_13_s1
    ds_read_b64_tr_b16 v[48:49], v6 offset:0
    ds_read_b64_tr_b16 v[50:51], v6 offset:512
    ds_read_b64_tr_b16 v[52:53], v7 offset:0
    ds_read_b64_tr_b16 v[54:55], v7 offset:512
    ds_read_b64_tr_b16 v[56:57], v6 offset:1024
    ds_read_b64_tr_b16 v[58:59], v6 offset:1536
    ds_read_b64_tr_b16 v[60:61], v7 offset:1024
    ds_read_b64_tr_b16 v[62:63], v7 offset:1536
    ds_read_b64_tr_b16 v[64:65], v6 offset:3584
    ds_read_b64_tr_b16 v[66:67], v6 offset:4096
    ds_read_b64_tr_b16 v[68:69], v7 offset:3584
    ds_read_b64_tr_b16 v[70:71], v7 offset:4096
    ds_read_b64_tr_b16 v[72:73], v6 offset:4608
    ds_read_b64_tr_b16 v[74:75], v6 offset:5120
    ds_read_b64_tr_b16 v[76:77], v7 offset:4608
    ds_read_b64_tr_b16 v[78:79], v7 offset:5120
    ds_read_b64_tr_b16 v[80:81], v6 offset:7168
    ds_read_b64_tr_b16 v[82:83], v6 offset:7680
    ds_read_b64_tr_b16 v[84:85], v7 offset:7168
    ds_read_b64_tr_b16 v[86:87], v7 offset:7680
    ds_read_b64_tr_b16 v[88:89], v6 offset:8192
    ds_read_b64_tr_b16 v[90:91], v6 offset:8704
    ds_read_b64_tr_b16 v[92:93], v7 offset:8192
    ds_read_b64_tr_b16 v[94:95], v7 offset:8704
    ds_read_b64_tr_b16 v[96:97], v6 offset:10752
    ds_read_b64_tr_b16 v[98:99], v6 offset:11264
    ds_read_b64_tr_b16 v[100:101], v7 offset:10752
    ds_read_b64_tr_b16 v[102:103], v7 offset:11264
    ds_read_b64_tr_b16 v[104:105], v6 offset:11776
    ds_read_b64_tr_b16 v[106:107], v6 offset:12288
    ds_read_b64_tr_b16 v[108:109], v7 offset:11776
    ds_read_b64_tr_b16 v[110:111], v7 offset:12288
    ds_read_b64_tr_b16 v[112:113], v6 offset:14336
    ds_read_b64_tr_b16 v[114:115], v6 offset:14848
    ds_read_b64_tr_b16 v[116:117], v7 offset:14336
    ds_read_b64_tr_b16 v[118:119], v7 offset:14848
    ds_read_b64_tr_b16 v[120:121], v6 offset:15360
    ds_read_b64_tr_b16 v[122:123], v6 offset:15872
    ds_read_b64_tr_b16 v[124:125], v7 offset:15360
    ds_read_b64_tr_b16 v[126:127], v7 offset:15872
    ds_read_b64_tr_b16 v[128:129], v6 offset:17920
    ds_read_b64_tr_b16 v[130:131], v6 offset:18432
    ds_read_b64_tr_b16 v[132:133], v7 offset:17920
    ds_read_b64_tr_b16 v[134:135], v7 offset:18432
    ds_read_b64_tr_b16 v[136:137], v6 offset:18944
    ds_read_b64_tr_b16 v[138:139], v6 offset:19456
    ds_read_b64_tr_b16 v[140:141], v7 offset:18944
    ds_read_b64_tr_b16 v[142:143], v7 offset:19456
    ds_read_b64_tr_b16 v[144:145], v6 offset:21504
    ds_read_b64_tr_b16 v[146:147], v6 offset:22016
    ds_read_b64_tr_b16 v[148:149], v7 offset:21504
    ds_read_b64_tr_b16 v[150:151], v7 offset:22016
    ds_read_b64_tr_b16 v[152:153], v6 offset:22528
    ds_read_b64_tr_b16 v[154:155], v6 offset:23040
    ds_read_b64_tr_b16 v[156:157], v7 offset:22528
    ds_read_b64_tr_b16 v[158:159], v7 offset:23040
    ds_read_b64_tr_b16 v[224:225], v6 offset:25088
    ds_read_b64_tr_b16 v[226:227], v6 offset:25600
    ds_read_b64_tr_b16 v[228:229], v7 offset:25088
    ds_read_b64_tr_b16 v[230:231], v7 offset:25600
    ds_read_b64_tr_b16 v[232:233], v6 offset:26112
    ds_read_b64_tr_b16 v[234:235], v6 offset:26624
    ds_read_b64_tr_b16 v[236:237], v7 offset:26112
    ds_read_b64_tr_b16 v[238:239], v7 offset:26624
    s_waitcnt lgkmcnt(0)
    s_barrier
A2_13_s1r:
    s_waitcnt vmcnt(12)
    v_max_u32 v251, v163, v167
    v_max3_u32 v251, v251, v171, v175
    v_cmp_eq_u32 vcc, -1, v251
    s_nop 0
    s_cbranch_vccnz CK_16_r
CK_16_k:
    s_nop 0
    v_mfma_f32_32x32x16_bf16 v[16:31], v[48:51], v[160:163], v[16:31]
    s_add_u32 m0, s55, 8192
    s_add_u32 s58, s72, 229376
    buffer_load_dwordx4 v246, s[16:19], s58 offen lds
    v_mfma_f32_32x32x16_bf16 v[32:47], v[52:55], v[160:163], 0
    v_mfma_f32_32x32x16_bf16 v[16:31], v[56:59], v[164:167], v[16:31]
    s_add_u32 m0, s55, 9216
    s_add_u32 s58, s72, 258048
    buffer_load_dwordx4 v246, s[16:19], s58 offen lds
    v_mfma_f32_32x32x16_bf16 v[32:47], v[60:63], v[164:167], v[32:47]
    v_mfma_f32_32x32x16_bf16 v[16:31], v[64:67], v[168:171], v[16:31]
    s_add_u32 m0, s55, 10240
    s_add_u32 s58, s72, 286720
    buffer_load_dwordx4 v246, s[16:19], s58 offen lds
    v_mfma_f32_32x32x16_bf16 v[32:47], v[68:71], v[168:171], v[32:47]
    v_mfma_f32_32x32x16_bf16 v[16:31], v[72:75], v[172:175], v[16:31]
    s_add_u32 m0, s55, 11264
    s_add_u32 s58, s72, 315392
    buffer_load_dwordx4 v246, s[16:19], s58 offen lds
    v_mfma_f32_32x32x16_bf16 v[32:47], v[76:79], v[172:175], v[32:47]
    s_waitcnt vmcnt(12)
    v_max_u32 v251, v179, v183
    v_max3_u32 v251, v251, v187, v191
    v_cmp_eq_u32 vcc, -1, v251
    s_nop 0
    s_cbranch_vccnz CK_17_r
CK_17_k:
    s_nop 0
    v_mfma_f32_32x32x16_bf16 v[16:31], v[80:83], v[176:179], v[16:31]
    s_add_u32 m0, s55, 12288
    s_add_u32 s58, s72, 344064
    buffer_load_dwordx4 v246, s[16:19], s58 offen lds
    v_mfma_f32_32x32x16_bf16 v[32:47], v[84:87], v[176:179], v[32:47]
    v_mfma_f32_32x32x16_bf16 v[16:31], v[88:91], v[180:183], v[16:31]
    s_add_u32 m0, s55, 13312
    s_add_u32 s58, s72, 372736
    buffer_load_dwordx4 v246, s[16:19], s58 offen lds
    v_mfma_f32_32x32x16_bf16 v[32:47], v[92:95], v[180:183], v[32:47]
    v_mfma_f32_32x32x16_bf16 v[16:31], v[96:99], v[184:187], v[16:31]
    s_add_u32 m0, s55, 14336
    s_add_u32 s58, s72, 401408
    buffer_load_dwordx4 v246, s[16:19], s58 offen lds
    v_mfma_f32_32x32x16_bf16 v[32:47], v[100:103], v[184:187], v[32:47]
    v_mfma_f32_32x32x16_bf16 v[16:31], v[104:107], v[188:191], v[16:31]
    s_add_u32 m0, s55, 15360
    s_add_u32 s58, s72, 430080
    buffer_load_dwordx4 v246, s[16:19], s58 offen lds
    v_mfma_f32_32x32x16_bf16 v[32:47], v[108:111], v[188:191], v[32:47]
    s_waitcnt vmcnt(12)
    v_max_u32 v251, v195, v199
    v_max3_u32 v251, v251, v203, v207
    v_cmp_eq_u32 vcc, -1, v251
    s_nop 0
    s_cbranch_vccnz CK_18_r
CK_18_k:
    s_nop 0
    v_mfma_f32_32x32x16_bf16 v[16:31], v[112:115], v[192:195], v[16:31]
    s_add_u32 m0, s55, 32768
    s_add_u32 s58, s72, 458752
    buffer_load_dwordx4 v246, s[16:19], s58 offen lds
    v_mfma_f32_32x32x16_bf16 v[32:47], v[116:119], v[192:195], v[32:47]
    v_mfma_f32_32x32x16_bf16 v[16:31], v[120:123], v[196:199], v[16:31]
    s_add_u32 m0, s55, 33792
    s_add_u32 s58, s72, 487424
    buffer_load_dwordx4 v246, s[16:19], s58 offen lds
    v_mfma_f32_32x32x16_bf16 v[32:47], v[124:127], v[196:199], v[32:47]
    v_mfma_f32_32x32x16_bf16 v[16:31], v[128:131], v[200:203], v[16:31]
    s_add_u32 m0, s55, 34816
    s_add_u32 s58, s72, 516096
    buffer_load_dwordx4 v246, s[16:19], s58 offen lds
    v_mfma_f32_32x32x16_bf16 v[32:47], v[132:135], v[200:203], v[32:47]
    v_mfma_f32_32x32x16_bf16 v[16:31], v[136:139], v[204:207], v[16:31]
    s_add_u32 m0, s55, 35840
    s_add_u32 s58, s72, 544768
    buffer_load_dwordx4 v246, s[16:19], s58 offen lds
    v_mfma_f32_32x32x16_bf16 v[32:47], v[140:143], v[204:207], v[32:47]
    s_waitcnt vmcnt(12)
    v_max_u32 v251, v211, v215
    v_max3_u32 v251, v251, v219, v223
    v_cmp_eq_u32 vcc, -1, v251
    s_nop 0
    s_cbranch_vccnz CK_19_r
CK_19_k:
    s_nop 0
    v_mfma_f32_32x32x16_bf16 v[16:31], v[144:147], v[208:211], v[16:31]
    s_add_u32 m0, s55, 36864
    s_add_u32 s58, s72, 573440
    buffer_load_dwordx4 v246, s[16:19], s58 offen lds
    v_mfma_f32_32x32x16_bf16 v[32:47], v[148:151], v[208:211], v[32:47]
    v_mfma_f32_32x32x16_bf16 v[16:31], v[152:155], v[212:215], v[16:31]
    s_add_u32 m0, s55, 37888
    s_add_u32 s58, s72, 602112
    buffer_load_dwordx4 v246, s[16:19], s58 offen lds
    v_mfma_f32_32x32x16_bf16 v[32:47], v[156:159], v[212:215], v[32:47]
    v_mfma_f32_32x32x16_bf16 v[16:31], v[224:227], v[216:219], v[16:31]
    s_add_u32 m0, s55, 38912
    s_add_u32 s58, s72, 630784
    buffer_load_dwordx4 v246, s[16:19], s58 offen lds
    v_mfma_f32_32x32x16_bf16 v[32:47], v[228:231], v[216:219], v[32:47]
    v_mfma_f32_32x32x16_bf16 v[16:31], v[232:235], v[220:223], v[16:31]
    s_add_u32 m0, s55, 39936
    s_add_u32 s58, s72, 659456
    buffer_load_dwordx4 v246, s[16:19], s58 offen lds
    v_mfma_f32_32x32x16_bf16 v[32:47], v[236:239], v[220:223], v[32:47]
    s_nop 11
    ds_write_b128 v8, v[32:35] offset:0
    ds_write_b128 v8, v[36:39] offset:1024
    ds_write_b128 v8, v[40:43] offset:2048
    ds_write_b128 v8, v[44:47] offset:3072
    s_waitcnt lgkmcnt(0)
    s_barrier
    ds_read_b128 v[32:35], v9 offset:0
    ds_read_b128 v[36:39], v9 offset:1024
    ds_read_b128 v[40:43], v9 offset:2048
    ds_read_b128 v[44:47], v9 offset:3072
    s_waitcnt lgkmcnt(3)
    v_pk_add_f32 v[16:17], v[16:17], v[32:33]
    v_pk_add_f32 v[18:19], v[18:19], v[34:35]
    s_waitcnt lgkmcnt(2)
    v_pk_add_f32 v[20:21], v[20:21], v[36:37]
    v_pk_add_f32 v[22:23], v[22:23], v[38:39]
    s_waitcnt lgkmcnt(1)
    v_pk_add_f32 v[24:25], v[24:25], v[40:41]
    v_pk_add_f32 v[26:27], v[26:27], v[42:43]
    s_waitcnt lgkmcnt(0)
    s_nop 0
    v_pk_add_f32 v[28:29], v[28:29], v[44:45]
    v_pk_add_f32 v[30:31], v[30:31], v[46:47]
    v_pk_add_f32 v[64:65], v[16:17], v[18:19]
    v_pk_add_f32 v[66:67], v[20:21], v[22:23]
    v_pk_add_f32 v[68:69], v[24:25], v[26:27]
    v_pk_add_f32 v[70:71], v[28:29], v[30:31]
    v_pk_add_f32 v[64:65], v[64:65], v[66:67]
    v_pk_add_f32 v[68:69], v[68:69], v[70:71]
    v_pk_add_f32 v[64:65], v[64:65], v[68:69]
    v_add_f32 v80, v64, v65
    v_mov_b32 v81, v80
    s_nop 1
    v_permlane32_swap_b32 v80, v81
    v_add_f32_e64 v80, v80, v81
    v_mul_f32 v82, 0xbd000000, v80
    v_pk_add_f32 v[64:65], v[16:17], v[82:83] op_sel_hi:[1,0]
    v_pk_add_f32 v[66:67], v[18:19], v[82:83] op_sel_hi:[1,0]
    v_pk_add_f32 v[68:69], v[20:21], v[82:83] op_sel_hi:[1,0]
    v_pk_add_f32 v[70:71], v[22:23], v[82:83] op_sel_hi:[1,0]
    v_pk_add_f32 v[72:73], v[24:25], v[82:83] op_sel_hi:[1,0]
    v_pk_add_f32 v[74:75], v[26:27], v[82:83] op_sel_hi:[1,0]
    v_pk_add_f32 v[76:77], v[28:29], v[82:83] op_sel_hi:[1,0]
    v_pk_add_f32 v[78:79], v[30:31], v[82:83] op_sel_hi:[1,0]
    v_pk_mul_f32 v[82:83], v[64:65], v[64:65]
    v_pk_mul_f32 v[84:85], v[66:67], v[66:67]
    v_pk_fma_f32 v[82:83], v[68:69], v[68:69], v[82:83]
    v_pk_fma_f32 v[84:85], v[70:71], v[70:71], v[84:85]
    v_pk_fma_f32 v[82:83], v[72:73], v[72:73], v[82:83]
    v_pk_fma_f32 v[84:85], v[74:75], v[74:75], v[84:85]
    v_pk_fma_f32 v[82:83], v[76:77], v[76:77], v[82:83]
    v_pk_fma_f32 v[84:85], v[78:79], v[78:79], v[84:85]
    v_pk_add_f32 v[82:83], v[82:83], v[84:85]
    v_add_f32 v81, v82, v83
    v_mov_b32 v82, v81
    s_nop 1
    v_permlane32_swap_b32 v81, v82
    v_add_f32 v81, v81, v82
    s_mov_b32 exec_hi, 0
    s_cmp_eq_u32 s100, 0
    s_cbranch_scc1 LS_20_g
    buffer_store_dwordx2 v[80:81], v245, s[36:39], s65 offen
LS_20_r:
    s_mov_b64 exec, -1
    s_nop 0
    buffer_load_dwordx2 v[96:97], v245, s[36:39], s64 offen offset:0 sc1
    buffer_load_dwordx2 v[98:99], v245, s[36:39], s64 offen offset:512 sc1
    buffer_load_dwordx2 v[100:101], v245, s[36:39], s64 offen offset:1024 sc1
    buffer_load_dwordx2 v[102:103], v245, s[36:39], s64 offen offset:1536 sc1
    buffer_load_dwordx2 v[104:105], v245, s[36:39], s64 offen offset:2048 sc1
    buffer_load_dwordx2 v[106:107], v245, s[36:39], s64 offen offset:2560 sc1
    buffer_load_dwordx2 v[108:109], v245, s[36:39], s64 offen offset:3072 sc1
    v_mov_b32 v224, v16
    v_mov_b32 v225, v17
    v_mov_b32 v226, v18
    v_mov_b32 v227, v19
    v_mov_b32 v228, v20
    v_mov_b32 v229, v21
    v_mov_b32 v230, v22
    v_mov_b32 v231, v23
    v_mov_b32 v232, v24
    v_mov_b32 v233, v25
    v_mov_b32 v234, v26
    v_mov_b32 v235, v27
    v_mov_b32 v236, v28
    v_mov_b32 v237, v29
    v_mov_b32 v238, v30
    v_mov_b32 v239, v31

    s_lshl_b32 s56, s53, 13
    s_lshl_b32 s57, s54, 11
    s_add_u32 s56, s56, s57
    s_add_u32 s56, s56, 0x21000
    v_lshrrev_b32 v2, 1, v243
    v_and_b32 v2, 7, v2
    v_xor_b32 v2, v2, v242
    v_lshlrev_b32 v3, 6, v243
    v_add_u32 v3, s56, v3

    v_xor_b32_e64 v4, 0, v2
    v_lshl_add_u32 v128, v4, 3, v3
    v_xor_b32_e64 v4, 2, v2
    v_lshl_add_u32 v129, v4, 3, v3
    v_xor_b32_e64 v4, 4, v2
    v_lshl_add_u32 v130, v4, 3, v3
    v_xor_b32_e64 v4, 6, v2
    v_lshl_add_u32 v131, v4, 3, v3

    v_lshrrev_b32 v2, 2, v244
    v_and_b32 v2, 3, v2
    v_lshl_add_u32 v2, v242, 3, v2
    v_lshrrev_b32 v3, 4, v244
    v_and_b32 v3, 1, v3
    v_lshlrev_b32 v3, 2, v3
    v_and_b32 v4, 3, v244
    v_add_u32 v3, v3, v4
    v_lshrrev_b32 v4, 1, v2
    v_xor_b32 v3, v3, v4
    v_lshlrev_b32 v2, 6, v2
    v_add_u32_e64 v2, s56, v2
    v_lshl_add_u32 v132, v3, 3, v2
    v_xor_b32_e64 v3, 2, v3
    v_lshl_add_u32 v133, v3, 3, v2
    s_waitcnt vmcnt(0)

    v_max3_u32 v251, v97, v99, v101
    v_max3_u32 v251, v251, v103, v105
    v_max3_u32 v251, v251, v107, v109
    v_cmp_eq_u32 vcc, -1, v251
    s_nop 0
    s_cbranch_vccnz CK_21_r
CK_21_k:
    v_pk_add_f32 v[112:113], v[96:97], v[98:99]
    v_pk_add_f32 v[114:115], v[100:101], v[102:103]
    v_pk_add_f32 v[116:117], v[104:105], v[106:107]
    v_pk_add_f32 v[112:113], v[112:113], v[114:115]
    v_pk_add_f32 v[116:117], v[116:117], v[108:109]
    v_pk_add_f32 v[112:113], v[112:113], v[116:117]
    v_mov_b32 v80, v112
    s_nop 1
    v_permlane32_swap_b32 v80, v112
    v_add_f32 v80, v80, v112
    v_mul_f32 v114, 0x3d924925, v80
    v_mul_f32 v80, 0x3b124925, v80
    v_sub_f32 v96, v96, v114
    v_sub_f32 v98, v98, v114
    v_sub_f32 v100, v100, v114
    v_sub_f32 v102, v102, v114
    v_sub_f32 v104, v104, v114
    v_sub_f32 v106, v106, v114
    v_sub_f32 v108, v108, v114
    v_mul_f32 v115, v96, v96
    v_mul_f32 v116, v98, v98
    v_fmac_f32 v115, v100, v100
    v_fmac_f32 v116, v102, v102
    v_fmac_f32 v115, v104, v104
    v_fmac_f32 v116, v106, v106
    v_fmac_f32 v115, v108, v108
    v_add_f32_e64 v115, v115, v116
    v_fmac_f32 v113, 0x3d000000, v115
    v_mov_b32 v82, v113
    s_nop 1
    v_permlane32_swap_b32 v82, v113
    v_add_f32 v82, v82, v113
    v_mul_f32 v82, 0x3b124925, v82

    v_add_f32 v84, 0x3727c5ac, v82
    v_rsq_f32_e64 v84, v84
    v_mov_b32 v86, 0x3727c5ac
    v_mul_f32 v85, v82, v84
    v_fmac_f32 v86, v85, v84
    v_rsq_f32 v86, v86
    s_nop 0
    v_mul_f32_e64 v84, v84, v86
    v_mul_f32 v86, -v80, v84

    v_pk_fma_f32 v[32:33], v[16:17], v[84:85], v[86:87] op_sel_hi:[1,0,0]
    v_pk_fma_f32 v[34:35], v[18:19], v[84:85], v[86:87] op_sel_hi:[1,0,0]
    v_pk_fma_f32 v[36:37], v[20:21], v[84:85], v[86:87] op_sel_hi:[1,0,0]
    v_pk_fma_f32 v[38:39], v[22:23], v[84:85], v[86:87] op_sel_hi:[1,0,0]
    v_pk_fma_f32 v[40:41], v[24:25], v[84:85], v[86:87] op_sel_hi:[1,0,0]
    v_pk_fma_f32 v[42:43], v[26:27], v[84:85], v[86:87] op_sel_hi:[1,0,0]
    v_pk_fma_f32 v[44:45], v[28:29], v[84:85], v[86:87] op_sel_hi:[1,0,0]
    v_pk_fma_f32 v[46:47], v[30:31], v[84:85], v[86:87] op_sel_hi:[1,0,0]
    v_cvt_pk_bf16_f32 v112, v32, v33
    v_cvt_pk_bf16_f32 v113, v34, v35
    v_cvt_pk_bf16_f32 v114, v36, v37
    v_cvt_pk_bf16_f32 v115, v38, v39
    v_cvt_pk_bf16_f32 v116, v40, v41
    v_cvt_pk_bf16_f32 v117, v42, v43
    v_cvt_pk_bf16_f32 v118, v44, v45
    v_cvt_pk_bf16_f32 v119, v46, v47
    ds_write_b64 v128, v[112:113]
    ds_write_b64 v129, v[114:115]
    ds_write_b64 v130, v[116:117]
    ds_write_b64 v131, v[118:119]

    ds_read_b64_tr_b16 v[120:121], v132
    ds_read_b64_tr_b16 v[122:123], v133 offset:256
    ds_read_b64_tr_b16 v[124:125], v132 offset:1024
    ds_read_b64_tr_b16 v[126:127], v133 offset:1280
    s_waitcnt lgkmcnt(2)
    buffer_store_dwordx4 v[120:123], v240, s[36:39], s68 offen sc1
    s_waitcnt lgkmcnt(0)
    buffer_store_dwordx4 v[124:127], v240, s[36:39], s68 offen offset:1024 sc1
    s_barrier

    s_cmp_ge_u32 s49, 7
    s_cbranch_scc1 B_22_skip
    s_nop 0
    s_add_u32 m0, s55, 40960
    s_add_u32 s58, s72, 688128
    buffer_load_dwordx4 v246, s[16:19], s58 offen lds
    s_add_u32 m0, s55, 41984
    s_add_u32 s58, s72, 716800
    buffer_load_dwordx4 v246, s[16:19], s58 offen lds
    s_add_u32 m0, s55, 43008
    s_add_u32 s58, s72, 745472
    buffer_load_dwordx4 v246, s[16:19], s58 offen lds
    s_add_u32 m0, s55, 44032
    s_add_u32 s58, s72, 774144
    buffer_load_dwordx4 v246, s[16:19], s58 offen lds
    s_add_u32 m0, s55, 45056
    s_add_u32 s58, s72, 802816
    buffer_load_dwordx4 v246, s[16:19], s58 offen lds
    s_add_u32 m0, s55, 46080
    s_add_u32 s58, s72, 831488
    buffer_load_dwordx4 v246, s[16:19], s58 offen lds
    s_add_u32 m0, s55, 47104
    s_add_u32 s58, s72, 860160
    buffer_load_dwordx4 v246, s[16:19], s58 offen lds
    s_add_u32 m0, s55, 48128
    s_add_u32 s58, s72, 888832
    buffer_load_dwordx4 v246, s[16:19], s58 offen lds

    v_lshlrev_b32 v3, 3, v242
    s_lshl_b32 s56, s48, 7
    s_lshl_b32 s57, s3, 5
    s_add_u32 s56, s56, s57

    buffer_load_dwordx2 v[24:25], v3, s[24:27], s56 offen offset:0
    buffer_load_dwordx2 v[26:27], v3, s[24:27], s56 offen offset:16

    s_lshl_b32 s63, s47, 1
    s_add_u32 s63, s63, s54
    v_lshlrev_b32 v3, 1, v243
    s_lshl_b32 s56, s63, 6
    buffer_load_ushort v254, v3, s[28:31], s56 offen
    s_mul_i32 s62, s46, 229376
    s_mul_i32 s56, s3, 28672
    s_add_u32 s62, s62, s56
    s_add_u32 s62, s62, s51
    s_add_u32 s62, s62, 4685824
    s_cmp_eq_u32 s50, 0
    s_cselect_b32 s56, 1, s53
    s_mul_i32 s56, s56, 114688
    s_add_u32 s92, s62, s56
    s_sub_u32 s56, 114688, s56
    s_add_u32 s88, s62, s56

    s_add_u32 s89, s88, 8192
    s_add_u32 s93, s92, 8192
    s_add_u32 s90, s88, 16384
    s_add_u32 s94, s92, 16384
    s_add_u32 s91, s88, 24576
    s_add_u32 s95, s92, 24576

    v_lshrrev_b32 v2, 2, v244
    v_and_b32 v2, 3, v2
    v_mul_u32_u24 v3, 4, v242
    v_add_u32 v2, v2, v3
    v_bfe_u32 v3, v2, 1, 1
    v_xor_b32 v3, s54, v3
    v_lshlrev_b32 v2, 7, v2
    v_lshl_add_u32 v2, v3, 6, v2
    v_lshrrev_b32 v3, 4, v244
    v_and_b32 v3, 1, v3
    v_lshl_add_u32 v2, v3, 5, v2
    v_and_b32_e64 v3, 3, v244
    v_lshl_add_u32 v218, v3, 3, v2
    v_add_u32 v218, s55, v218
    v_xor_b32 v219, 64, v218

    s_mul_i32 s69, s45, 86016
    s_add_u32 s69, s69, 16777216
    s_lshl_b32 s71, s3, 10
    s_lshl_b32 s70, s3, 14
    s_add_u32 s70, s70, s69
    s_add_u32 s69, s69, s71

    s_lshl_b32 s61, s46, 1
    s_add_u32 s61, s61, s53
    s_mul_i32 s64, s63, 28672
    s_lshl_b32 s57, s61, 11
    s_add_u32 s64, s64, s57
    s_add_u32 s64, s64, 12582912
    s_mul_i32 s65, s63, 3584
    s_lshl_b32 s57, s61, 8
    s_add_u32 s65, s65, s57
    s_add_u32 s65, s65, 14417920
    s_mul_i32 s68, s63, 28672
    s_lshl_b32 s57, s61, 6
    s_add_u32 s68, s68, s57
    s_mul_i32 s78, s50, 1048576
    s_add_u32 s78, s78, s73

    s_cmp_lt_u32 s48, 14
    s_cselect_b32 s60, s50, 0
    s_lshl_b32 s66, s99, 18
    s_lshl_b32 s59, s3, 15
    s_add_u32 s66, s66, s59
    s_add_u32 s66, s66, s51
    s_add_u32 s66, s66, 2850816
    s_lshl_b32 s56, s60, 17
    s_add_u32 s80, s66, s56
    s_xor_b32 s56, s56, 0x20000
    s_add_u32 s84, s66, s56

    s_add_u32 s81, s80, 8192
    s_add_u32 s85, s84, 8192
    s_add_u32 s82, s80, 16384
    s_add_u32 s86, s84, 16384
    s_add_u32 s83, s80, 24576
    s_add_u32 s87, s84, 24576

    s_mul_i32 s67, s99, 229376
    s_lshl_b32 s57, s48, 12
    s_add_u32 s67, s67, s57
    s_lshl_b32 s57, s3, 10
    s_add_u32 s67, s67, s57
    s_add_u32 s67, s67, s51
    s_add_u32 s67, s67, 4685824
    s_mul_i32 s56, s60, 114688
    s_add_u32 s59, s67, s56
    s_sub_u32 s56, 114688, s56
    s_add_u32 s60, s67, s56
    v_lshlrev_b32 v4, 10, v243
    v_lshl_add_u32 v4, v242, 17, v4
    v_add_u32 v4, 1020, v4
    v_mov_b32 v216, 0xbdd2d3e8
    v_mov_b32 v217, 0xc0135761

    v_lshrrev_b32 v2, 2, v244
    v_and_b32 v2, 3, v2
    v_mul_u32_u24 v3, 8, v242
    v_add_u32 v2, v2, v3
    v_bfe_u32 v3, v2, 1, 1
    v_xor_b32 v3, s53, v3
    v_lshlrev_b32 v2, 7, v2
    v_lshl_add_u32 v2, v3, 6, v2
    v_lshrrev_b32 v3, 4, v244
    v_and_b32 v3, 1, v3
    v_lshl_add_u32 v2, v3, 5, v2
    v_and_b32_e64 v3, 3, v244
    v_lshl_add_u32 v6, v3, 3, v2
    v_add_u32 v6, s55, v6
    v_xor_b32 v7, 64, v6

    s_lshl_b32 s58, s54, 5
    v_xor_b32 v6, s58, v6
    v_xor_b32 v7, s58, v7
    s_xor_b32 s56, s3, 0
    s_mul_i32 s56, s56, 0x1800
    s_add_u32 s56, s56, 0x20000
    v_add_u32 v0, s56, v240
    s_xor_b32 s56, s3, 1
    s_mul_i32 s56, s56, 0x1800
    s_add_u32 s56, s56, 0x20000
    v_add_u32 v1, s56, v240
    s_xor_b32 s56, s3, 2
    s_mul_i32 s56, s56, 0x1800
    s_add_u32 s56, s56, 0x20000
    v_add_u32 v2, s56, v240
    s_xor_b32 s56, s3, 3
    s_mul_i32 s56, s56, 0x1800
    s_add_u32 s56, s56, 0x20000
    v_add_u32_e64 v3, s56, v240
PB_23_p:
    buffer_load_dword v5, v4, s[36:39], s66 offen sc1
    buffer_load_dwordx4 v[104:107], v240, s[36:39], s80 offen offset:0 sc1
    buffer_load_dwordx4 v[108:111], v240, s[36:39], s80 offen offset:1024 sc1
    buffer_load_dwordx4 v[112:115], v240, s[36:39], s80 offen offset:2048 sc1
    buffer_load_dwordx4 v[116:119], v240, s[36:39], s80 offen offset:3072 sc1
    buffer_load_dwordx4 v[120:123], v241, s[36:39], s80 offen offset:0 sc1
    buffer_load_dwordx4 v[124:127], v241, s[36:39], s80 offen offset:1024 sc1
    buffer_load_dwordx4 v[128:131], v241, s[36:39], s80 offen offset:2048 sc1
    buffer_load_dwordx4 v[132:135], v241, s[36:39], s80 offen offset:3072 sc1
    s_sub_u32 s52, s52, 1
PB_23_c:
    s_waitcnt vmcnt(8)
    v_cmp_eq_u32 vcc, -1, v5

    s_cmp_gt_i32 s52, 0
    s_cselect_b64 vcc, vcc, 0
    s_cbranch_vccnz PB_23_p

    buffer_load_dwordx4 v[136:139], v240, s[36:39], s81 offen offset:0 sc1
    buffer_load_dwordx4 v[140:143], v240, s[36:39], s81 offen offset:1024 sc1
    buffer_load_dwordx4 v[144:147], v240, s[36:39], s81 offen offset:2048 sc1
    buffer_load_dwordx4 v[148:151], v240, s[36:39], s81 offen offset:3072 sc1
    v_lshlrev_b32_e64 v40, 16, v24
    v_and_b32 v41, 0xffff0000, v24
    v_lshlrev_b32_e64 v8, 16, v24
    v_and_b32 v9, 0xffff0000, v24
    v_lshlrev_b32_e64 v42, 16, v25
    v_and_b32 v43, 0xffff0000, v25
    v_lshlrev_b32_e64 v10, 16, v25
    v_and_b32 v11, 0xffff0000, v25
    v_lshlrev_b32_e64 v44, 16, v26
    v_and_b32 v45, 0xffff0000, v26
    v_lshlrev_b32_e64 v12, 16, v26
    v_and_b32 v13, 0xffff0000, v26
    v_lshlrev_b32_e64 v46, 16, v27
    v_and_b32 v47, 0xffff0000, v27
    v_lshlrev_b32_e64 v14, 16, v27
    v_and_b32 v15, 0xffff0000, v27
    v_mov_b32 v16, 0
    v_mov_b32 v48, 0
    v_mov_b32 v17, 0
    v_mov_b32 v49, 0
    v_mov_b32 v18, 0
    v_mov_b32 v50, 0
    v_mov_b32 v19, 0
    v_mov_b32 v51, 0
    v_mov_b32 v20, 0
    v_mov_b32 v52, 0
    v_mov_b32 v21, 0
    v_mov_b32 v53, 0
    v_mov_b32 v22, 0
    v_mov_b32 v54, 0
    v_mov_b32 v23, 0
    v_mov_b32 v55, 0
    s_waitcnt vmcnt(8)
    v_max_u32 v251, v107, v111
    v_max3_u32 v251, v251, v115, v119
    v_cmp_eq_u32 vcc, -1, v251
    s_nop 0
    s_cbranch_vccnz CK_24_r
CK_24_k:
    s_nop 0
    ds_read_b64_tr_b16 v[72:73], v6 offset:0
    ds_read_b64_tr_b16 v[74:75], v6 offset:512
    ds_read_b64_tr_b16 v[76:77], v7 offset:0
    ds_read_b64_tr_b16 v[78:79], v7 offset:512
    ds_read_b64_tr_b16 v[80:81], v6 offset:2048
    ds_read_b64_tr_b16 v[82:83], v6 offset:2560
    ds_read_b64_tr_b16 v[84:85], v7 offset:2048
    ds_read_b64_tr_b16 v[86:87], v7 offset:2560
    ds_read_b64_tr_b16 v[88:89], v6 offset:4096
    ds_read_b64_tr_b16 v[90:91], v6 offset:4608
    ds_read_b64_tr_b16 v[92:93], v7 offset:4096
    ds_read_b64_tr_b16 v[94:95], v7 offset:4608
    s_waitcnt lgkmcnt(8)
    s_nop 0
    v_mfma_f32_32x32x16_bf16 v[8:23], v[72:75], v[104:107], v[8:23]
    ds_read_b64_tr_b16 v[96:97], v6 offset:6144
    ds_read_b64_tr_b16 v[98:99], v6 offset:6656
    buffer_load_dwordx4 v[152:155], v241, s[36:39], s81 offen offset:0 sc1
    v_mfma_f32_32x32x16_bf16 v[24:39], v[76:79], v[104:107], 0
    ds_read_b64_tr_b16 v[100:101], v7 offset:6144
    ds_read_b64_tr_b16 v[102:103], v7 offset:6656
    s_waitcnt lgkmcnt(8)
    s_nop 0
    v_mfma_f32_32x32x16_bf16 v[8:23], v[80:83], v[108:111], v[8:23]
    ds_read_b64_tr_b16 v[72:73], v6 offset:8192
    ds_read_b64_tr_b16 v[74:75], v6 offset:8704
    buffer_load_dwordx4 v[156:159], v241, s[36:39], s81 offen offset:1024 sc1
    v_mfma_f32_32x32x16_bf16 v[24:39], v[84:87], v[108:111], v[24:39]
    ds_read_b64_tr_b16 v[76:77], v7 offset:8192
    ds_read_b64_tr_b16 v[78:79], v7 offset:8704
    s_waitcnt lgkmcnt(8)
    s_nop 0
    v_mfma_f32_32x32x16_bf16 v[8:23], v[88:91], v[112:115], v[8:23]
    ds_read_b64_tr_b16 v[80:81], v6 offset:10240
    ds_read_b64_tr_b16 v[82:83], v6 offset:10752
    buffer_load_dwordx4 v[160:163], v241, s[36:39], s81 offen offset:2048 sc1
    v_mfma_f32_32x32x16_bf16 v[24:39], v[92:95], v[112:115], v[24:39]
    ds_read_b64_tr_b16 v[84:85], v7 offset:10240
    ds_read_b64_tr_b16 v[86:87], v7 offset:10752
    s_waitcnt lgkmcnt(8)
    s_nop 0
    v_mfma_f32_32x32x16_bf16 v[8:23], v[96:99], v[116:119], v[8:23]
    ds_read_b64_tr_b16 v[88:89], v6 offset:12288
    ds_read_b64_tr_b16 v[90:91], v6 offset:12800
    buffer_load_dwordx4 v[164:167], v241, s[36:39], s81 offen offset:3072 sc1
    v_mfma_f32_32x32x16_bf16 v[24:39], v[100:103], v[116:119], v[24:39]
    ds_read_b64_tr_b16 v[92:93], v7 offset:12288
    ds_read_b64_tr_b16 v[94:95], v7 offset:12800
    s_waitcnt vmcnt(8)
    v_max_u32 v251, v123, v127
    v_max3_u32 v251, v251, v131, v135
    v_cmp_eq_u32 vcc, -1, v251
    s_nop 0
    s_cbranch_vccnz CK_25_r
CK_25_k:
    s_waitcnt lgkmcnt(8)
    v_mfma_f32_32x32x16_bf16 v[8:23], v[72:75], v[120:123], v[8:23]
    ds_read_b64_tr_b16 v[96:97], v6 offset:14336
    ds_read_b64_tr_b16 v[98:99], v6 offset:14848
    buffer_load_dwordx4 v[168:171], v240, s[36:39], s82 offen offset:0 sc1
    v_mfma_f32_32x32x16_bf16 v[24:39], v[76:79], v[120:123], v[24:39]
    ds_read_b64_tr_b16 v[100:101], v7 offset:14336
    ds_read_b64_tr_b16 v[102:103], v7 offset:14848
    s_waitcnt lgkmcnt(8)
    s_nop 0
    v_mfma_f32_32x32x16_bf16 v[8:23], v[80:83], v[124:127], v[8:23]
    ds_read_b64_tr_b16 v[72:73], v6 offset:32768
    ds_read_b64_tr_b16 v[74:75], v6 offset:33280
    buffer_load_dwordx4 v[172:175], v240, s[36:39], s82 offen offset:1024 sc1
    v_mfma_f32_32x32x16_bf16 v[24:39], v[84:87], v[124:127], v[24:39]
    ds_read_b64_tr_b16 v[76:77], v7 offset:32768
    ds_read_b64_tr_b16 v[78:79], v7 offset:33280
    s_waitcnt lgkmcnt(8)
    s_nop 0
    v_mfma_f32_32x32x16_bf16 v[8:23], v[88:91], v[128:131], v[8:23]
    ds_read_b64_tr_b16 v[80:81], v6 offset:34816
    ds_read_b64_tr_b16 v[82:83], v6 offset:35328
    buffer_load_dwordx4 v[176:179], v240, s[36:39], s82 offen offset:2048 sc1
    v_mfma_f32_32x32x16_bf16 v[24:39], v[92:95], v[128:131], v[24:39]
    ds_read_b64_tr_b16 v[84:85], v7 offset:34816
    ds_read_b64_tr_b16 v[86:87], v7 offset:35328
    s_waitcnt lgkmcnt(8)
    s_nop 0
    v_mfma_f32_32x32x16_bf16 v[8:23], v[96:99], v[132:135], v[8:23]
    ds_read_b64_tr_b16 v[88:89], v6 offset:36864
    ds_read_b64_tr_b16 v[90:91], v6 offset:37376
    buffer_load_dwordx4 v[180:183], v240, s[36:39], s82 offen offset:3072 sc1
    v_mfma_f32_32x32x16_bf16 v[24:39], v[100:103], v[132:135], v[24:39]
    ds_read_b64_tr_b16 v[92:93], v7 offset:36864
    ds_read_b64_tr_b16 v[94:95], v7 offset:37376
    s_waitcnt vmcnt(8)
    v_max_u32 v251, v139, v143
    v_max3_u32 v251, v251, v147, v151
    v_cmp_eq_u32 vcc, -1, v251
    s_nop 0
    s_cbranch_vccnz CK_26_r
CK_26_k:
    s_waitcnt lgkmcnt(8)
    v_mfma_f32_32x32x16_bf16 v[8:23], v[72:75], v[136:139], v[8:23]
    ds_read_b64_tr_b16 v[96:97], v6 offset:38912
    ds_read_b64_tr_b16 v[98:99], v6 offset:39424
    buffer_load_dwordx4 v[184:187], v241, s[36:39], s82 offen offset:0 sc1
    v_mfma_f32_32x32x16_bf16 v[24:39], v[76:79], v[136:139], v[24:39]
    ds_read_b64_tr_b16 v[100:101], v7 offset:38912
    ds_read_b64_tr_b16 v[102:103], v7 offset:39424
    s_waitcnt lgkmcnt(8)
    s_nop 0
    v_mfma_f32_32x32x16_bf16 v[8:23], v[80:83], v[140:143], v[8:23]
    ds_read_b64_tr_b16 v[72:73], v6 offset:40960
    ds_read_b64_tr_b16 v[74:75], v6 offset:41472
    buffer_load_dwordx4 v[188:191], v241, s[36:39], s82 offen offset:1024 sc1
    v_mfma_f32_32x32x16_bf16 v[24:39], v[84:87], v[140:143], v[24:39]
    ds_read_b64_tr_b16 v[76:77], v7 offset:40960
    ds_read_b64_tr_b16 v[78:79], v7 offset:41472
    s_waitcnt lgkmcnt(8)
    s_nop 0
    v_mfma_f32_32x32x16_bf16 v[8:23], v[88:91], v[144:147], v[8:23]
    ds_read_b64_tr_b16 v[80:81], v6 offset:43008
    ds_read_b64_tr_b16 v[82:83], v6 offset:43520
    buffer_load_dwordx4 v[192:195], v241, s[36:39], s82 offen offset:2048 sc1
    v_mfma_f32_32x32x16_bf16 v[24:39], v[92:95], v[144:147], v[24:39]
    ds_read_b64_tr_b16 v[84:85], v7 offset:43008
    ds_read_b64_tr_b16 v[86:87], v7 offset:43520
    s_waitcnt lgkmcnt(8)
    s_nop 0
    v_mfma_f32_32x32x16_bf16 v[8:23], v[96:99], v[148:151], v[8:23]
    ds_read_b64_tr_b16 v[88:89], v6 offset:45056
    ds_read_b64_tr_b16 v[90:91], v6 offset:45568
    buffer_load_dwordx4 v[196:199], v241, s[36:39], s82 offen offset:3072 sc1
    v_mfma_f32_32x32x16_bf16 v[24:39], v[100:103], v[148:151], v[24:39]
    ds_read_b64_tr_b16 v[92:93], v7 offset:45056
    ds_read_b64_tr_b16 v[94:95], v7 offset:45568
    s_waitcnt vmcnt(8)
    v_max_u32 v251, v155, v159
    v_max3_u32 v251, v251, v163, v167
    v_cmp_eq_u32 vcc, -1, v251
    s_nop 0
    s_cbranch_vccnz CK_27_r
CK_27_k:
    s_waitcnt lgkmcnt(8)
    v_mfma_f32_32x32x16_bf16 v[8:23], v[72:75], v[152:155], v[8:23]
    ds_read_b64_tr_b16 v[96:97], v6 offset:47104
    ds_read_b64_tr_b16 v[98:99], v6 offset:47616
    buffer_load_dwordx4 v[200:203], v240, s[36:39], s83 offen offset:0 sc1
    v_mfma_f32_32x32x16_bf16 v[24:39], v[76:79], v[152:155], v[24:39]
    ds_read_b64_tr_b16 v[100:101], v7 offset:47104
    ds_read_b64_tr_b16 v[102:103], v7 offset:47616
    s_waitcnt lgkmcnt(8)
    v_mfma_f32_32x32x16_bf16 v[8:23], v[80:83], v[156:159], v[8:23]
    buffer_load_dwordx4 v[204:207], v240, s[36:39], s83 offen offset:1024 sc1
    v_mfma_f32_32x32x16_bf16 v[24:39], v[84:87], v[156:159], v[24:39]
    s_waitcnt lgkmcnt(4)
    v_mfma_f32_32x32x16_bf16 v[8:23], v[88:91], v[160:163], v[8:23]
    buffer_load_dwordx4 v[208:211], v240, s[36:39], s83 offen offset:2048 sc1
    v_mfma_f32_32x32x16_bf16 v[24:39], v[92:95], v[160:163], v[24:39]
    s_waitcnt lgkmcnt(0)
    v_mfma_f32_32x32x16_bf16 v[8:23], v[96:99], v[164:167], v[8:23]
    buffer_load_dwordx4 v[212:215], v240, s[36:39], s83 offen offset:3072 sc1
    v_mfma_f32_32x32x16_bf16 v[24:39], v[100:103], v[164:167], v[24:39]
    s_waitcnt vmcnt(8)
    v_max_u32_e64 v251, v171, v175
    v_max3_u32 v251, v251, v179, v183
    v_cmp_eq_u32 vcc, -1, v251
    s_nop 0
    s_cbranch_vccnz CK_28_r
CK_28_k:
    s_nop 0
    v_mfma_f32_32x32x16_bf16 v[8:23], a[0:3], v[168:171], v[8:23]
    buffer_load_dwordx4 v[104:107], v241, s[36:39], s83 offen offset:0 sc1
    v_mfma_f32_32x32x16_bf16 v[24:39], a[4:7], v[168:171], v[24:39]
    v_mfma_f32_32x32x16_bf16 v[8:23], a[8:11], v[172:175], v[8:23]
    buffer_load_dwordx4 v[108:111], v241, s[36:39], s83 offen offset:1024 sc1
    v_mfma_f32_32x32x16_bf16 v[24:39], a[12:15], v[172:175], v[24:39]
    v_min_u32 v253, 0, v244
    v_lshlrev_b32 v253, 6, v253
    buffer_load_dword v252, v253, s[40:43], 0 offen offset:4 sc1
    v_mfma_f32_32x32x16_bf16 v[8:23], a[16:19], v[176:179], v[8:23]
    buffer_load_dwordx4 v[112:115], v241, s[36:39], s83 offen offset:2048 sc1
    v_mfma_f32_32x32x16_bf16 v[24:39], a[20:23], v[176:179], v[24:39]
    v_mfma_f32_32x32x16_bf16 v[8:23], a[24:27], v[180:183], v[8:23]
    buffer_load_dwordx4 v[116:119], v241, s[36:39], s83 offen offset:3072 sc1
    v_mfma_f32_32x32x16_bf16 v[24:39], a[28:31], v[180:183], v[24:39]
    s_waitcnt vmcnt(9)
    v_max_u32 v251, v187, v191
    v_max3_u32 v251, v251, v195, v199
    v_cmp_eq_u32 vcc, -1, v251
    s_nop 0
    s_cbranch_vccnz CK_29_r
CK_29_k:
    s_nop 0
    v_mfma_f32_32x32x16_bf16 v[8:23], a[32:35], v[184:187], v[8:23]
    buffer_load_dwordx4 v[120:123], v240, s[36:39], s84 offen offset:0 sc1
    v_mfma_f32_32x32x16_bf16 v[24:39], a[36:39], v[184:187], v[24:39]
    v_mfma_f32_32x32x16_bf16 v[8:23], a[40:43], v[188:191], v[8:23]
    buffer_load_dwordx4 v[124:127], v240, s[36:39], s84 offen offset:1024 sc1
    v_mfma_f32_32x32x16_bf16 v[24:39], a[44:47], v[188:191], v[24:39]
    v_mfma_f32_32x32x16_bf16 v[8:23], a[48:51], v[192:195], v[8:23]
    buffer_load_dwordx4 v[128:131], v240, s[36:39], s84 offen offset:2048 sc1
    v_mfma_f32_32x32x16_bf16 v[24:39], a[52:55], v[192:195], v[24:39]
    v_mfma_f32_32x32x16_bf16 v[8:23], a[56:59], v[196:199], v[8:23]
    buffer_load_dwordx4 v[132:135], v240, s[36:39], s84 offen offset:3072 sc1
    v_mfma_f32_32x32x16_bf16 v[24:39], a[60:63], v[196:199], v[24:39]
    s_waitcnt vmcnt(9)
    v_max_u32 v251, v203, v207
    v_max3_u32 v251, v251, v211, v215
    v_cmp_eq_u32 vcc, -1, v251
    s_nop 0
    s_cbranch_vccnz CK_30_r
CK_30_k:
    s_nop 0
    v_mfma_f32_32x32x16_bf16 v[8:23], a[64:67], v[200:203], v[8:23]
    buffer_load_dwordx4 v[136:139], v241, s[36:39], s84 offen offset:0 sc1
    v_mfma_f32_32x32x16_bf16 v[24:39], a[68:71], v[200:203], v[24:39]
    v_mfma_f32_32x32x16_bf16 v[8:23], a[72:75], v[204:207], v[8:23]
    buffer_load_dwordx4 v[140:143], v241, s[36:39], s84 offen offset:1024 sc1
    v_mfma_f32_32x32x16_bf16 v[24:39], a[76:79], v[204:207], v[24:39]
    v_mfma_f32_32x32x16_bf16 v[8:23], a[80:83], v[208:211], v[8:23]
    buffer_load_dwordx4 v[144:147], v241, s[36:39], s84 offen offset:2048 sc1
    v_mfma_f32_32x32x16_bf16 v[24:39], a[84:87], v[208:211], v[24:39]
    v_mfma_f32_32x32x16_bf16 v[8:23], a[88:91], v[212:215], v[8:23]
    buffer_load_dwordx4 v[148:151], v241, s[36:39], s84 offen offset:3072 sc1
    v_mfma_f32_32x32x16_bf16 v[24:39], a[92:95], v[212:215], v[24:39]
    s_waitcnt vmcnt(8)
    v_max_u32 v251, v107, v111
    v_max3_u32 v251, v251, v115, v119
    v_cmp_eq_u32 vcc, -1, v251
    s_nop 0
    s_cbranch_vccnz CK_31_r
CK_31_k:
    s_nop 0
    v_mfma_f32_32x32x16_bf16 v[8:23], a[96:99], v[104:107], v[8:23]
    buffer_load_dwordx4 v[152:155], v240, s[36:39], s85 offen offset:0 sc1
    v_mfma_f32_32x32x16_bf16 v[24:39], a[100:103], v[104:107], v[24:39]
    v_mfma_f32_32x32x16_bf16 v[8:23], a[104:107], v[108:111], v[8:23]
    ds_read_b64_tr_b16 v[72:73], v6 offset:0
    ds_read_b64_tr_b16 v[74:75], v6 offset:512
    buffer_load_dwordx4 v[156:159], v240, s[36:39], s85 offen offset:1024 sc1
    v_mfma_f32_32x32x16_bf16 v[24:39], a[108:111], v[108:111], v[24:39]
    ds_read_b64_tr_b16 v[76:77], v7 offset:0
    ds_read_b64_tr_b16 v[78:79], v7 offset:512
    v_mfma_f32_32x32x16_bf16 v[8:23], a[112:115], v[112:115], v[8:23]
    ds_read_b64_tr_b16 v[80:81], v6 offset:2048
    ds_read_b64_tr_b16 v[82:83], v6 offset:2560
    buffer_load_dwordx4 v[160:163], v240, s[36:39], s85 offen offset:2048 sc1
    v_mfma_f32_32x32x16_bf16 v[24:39], a[116:119], v[112:115], v[24:39]
    ds_read_b64_tr_b16 v[84:85], v7 offset:2048
    ds_read_b64_tr_b16 v[86:87], v7 offset:2560
    v_mfma_f32_32x32x16_bf16 v[8:23], a[120:123], v[116:119], v[8:23]
    ds_read_b64_tr_b16 v[88:89], v6 offset:4096
    ds_read_b64_tr_b16 v[90:91], v6 offset:4608
    buffer_load_dwordx4 v[164:167], v240, s[36:39], s85 offen offset:3072 sc1
    v_mfma_f32_32x32x16_bf16 v[24:39], a[124:127], v[116:119], v[24:39]
    ds_read_b64_tr_b16 v[92:93], v7 offset:4096
    ds_read_b64_tr_b16 v[94:95], v7 offset:4608
    s_waitcnt vmcnt(14)
    s_waitcnt lgkmcnt(0)
    s_nop 7
    s_nop 0
    ds_write_b128 v0, v[32:35] offset:4096
    ds_write_b128 v0, v[36:39] offset:5120
    ds_write_b128 v0, v[24:27] offset:2048
    ds_write_b128 v0, v[28:31] offset:3072
    ds_write_b128 v0, v[16:19] offset:0
    ds_write_b128 v0, v[20:23] offset:1024
    buffer_load_dwordx4 v[168:171], v241, s[36:39], s85 offen offset:0 sc1
    buffer_load_dwordx4 v[172:175], v241, s[36:39], s85 offen offset:1024 sc1
    buffer_load_dwordx4 v[176:179], v241, s[36:39], s85 offen offset:2048 sc1
    buffer_load_dwordx4 v[180:183], v241, s[36:39], s85 offen offset:3072 sc1
    s_waitcnt lgkmcnt(0)
    s_barrier
    ds_read_b128 v[16:19], v1 offset:0
    ds_read_b128 v[20:23], v1 offset:1024
    ds_read_b128 v[24:27], v2 offset:2048
    ds_read_b128 v[28:31], v2 offset:3072
    ds_read_b128 v[32:35], v3 offset:4096
    ds_read_b128 v[36:39], v3 offset:5120
    buffer_load_dwordx4 v[184:187], v240, s[36:39], s86 offen offset:0 sc1
    buffer_load_dwordx4 v[188:191], v240, s[36:39], s86 offen offset:1024 sc1
    buffer_load_dwordx4 v[192:195], v240, s[36:39], s86 offen offset:2048 sc1
    buffer_load_dwordx4 v[196:199], v240, s[36:39], s86 offen offset:3072 sc1
    v_cmp_gt_u32 vcc, 32, v252
    s_nop 0
    s_cbranch_vccnz CC_32_r
CC_32_k:
    s_waitcnt lgkmcnt(4)
    v_pk_add_f32 v[8:9], v[8:9], v[16:17]
    v_pk_add_f32 v[10:11], v[10:11], v[18:19]
    v_pk_add_f32 v[12:13], v[12:13], v[20:21]
    v_pk_add_f32 v[14:15], v[14:15], v[22:23]
    s_waitcnt lgkmcnt(2)
    v_pk_add_f32 v[8:9], v[8:9], v[24:25]
    v_pk_add_f32 v[10:11], v[10:11], v[26:27]
    v_pk_add_f32 v[12:13], v[12:13], v[28:29]
    v_pk_add_f32 v[14:15], v[14:15], v[30:31]
    s_waitcnt lgkmcnt(0)
    v_pk_add_f32 v[8:9], v[8:9], v[32:33]
    v_pk_add_f32 v[10:11], v[10:11], v[34:35]
    v_pk_add_f32 v[12:13], v[12:13], v[36:37]
    v_pk_add_f32 v[14:15], v[14:15], v[38:39]
    v_pk_mul_f32 v[16:17], v[8:9], v[8:9]
    v_pk_mul_f32 v[18:19], v[10:11], v[10:11]
    v_pk_mul_f32 v[20:21], v[12:13], v[12:13]
    v_pk_mul_f32 v[22:23], v[14:15], v[14:15]
    v_pk_fma_f32 v[16:17], v[16:17], v[216:217], v[216:217] op_sel:[0,0,1] op_sel_hi:[1,0,1]
    v_pk_fma_f32 v[18:19], v[18:19], v[216:217], v[216:217] op_sel:[0,0,1] op_sel_hi:[1,0,1]
    v_pk_fma_f32 v[20:21], v[20:21], v[216:217], v[216:217] op_sel:[0,0,1] op_sel_hi:[1,0,1]
    v_pk_fma_f32 v[22:23], v[22:23], v[216:217], v[216:217] op_sel:[0,0,1] op_sel_hi:[1,0,1]
    v_pk_mul_f32 v[16:17], v[16:17], v[8:9]
    v_pk_mul_f32 v[18:19], v[18:19], v[10:11]
    v_pk_mul_f32 v[20:21], v[20:21], v[12:13]
    v_pk_mul_f32 v[22:23], v[22:23], v[14:15]
    v_exp_f32 v16, v16
    v_exp_f32 v17, v17
    v_exp_f32 v18, v18
    v_exp_f32 v19, v19
    v_exp_f32 v20, v20
    v_exp_f32 v21, v21
    v_exp_f32 v22, v22
    v_exp_f32 v23, v23
    v_pk_add_f32 v[16:17], v[16:17], 1.0 op_sel_hi:[1,0]
    v_pk_add_f32 v[18:19], v[18:19], 1.0 op_sel_hi:[1,0]
    v_pk_add_f32 v[20:21], v[20:21], 1.0 op_sel_hi:[1,0]
    v_pk_add_f32 v[22:23], v[22:23], 1.0 op_sel_hi:[1,0]
    v_rcp_f32 v16, v16
    v_rcp_f32 v17, v17
    v_rcp_f32 v18, v18
    v_rcp_f32 v19, v19
    v_rcp_f32 v20, v20
    v_rcp_f32 v21, v21
    v_rcp_f32 v22, v22
    v_rcp_f32 v23, v23
    v_pk_mul_f32 v[16:17], v[16:17], v[8:9]
    v_pk_mul_f32 v[18:19], v[18:19], v[10:11]
    v_pk_mul_f32 v[20:21], v[20:21], v[12:13]
    v_pk_mul_f32 v[22:23], v[22:23], v[14:15]
    v_cvt_pk_bf16_f32 v220, v16, v17
    v_cvt_pk_bf16_f32 v221, v18, v19
    v_cvt_pk_bf16_f32 v222, v20, v21
    v_cvt_pk_bf16_f32 v223, v22, v23
    buffer_store_dwordx4 v[220:223], v240, s[36:39], s59 offen sc1
    s_cmp_eq_u32 s50, 0
    s_cbranch_scc0 B_22_i1
    s_waitcnt vmcnt(17)
    v_max_u32 v251, v123, v127
    v_max3_u32 v251, v251, v131, v135
    v_cmp_eq_u32 vcc, -1, v251
    s_nop 0
    s_cbranch_vccnz CK_33_r
CK_33_k:
    s_waitcnt lgkmcnt(8)
    v_mfma_f32_32x32x16_bf16 v[40:55], v[72:75], v[120:123], v[40:55]
    ds_read_b64_tr_b16 v[96:97], v6 offset:6144
    ds_read_b64_tr_b16 v[98:99], v6 offset:6656
    v_mfma_f32_32x32x16_bf16 v[56:71], v[76:79], v[120:123], 0
    ds_read_b64_tr_b16 v[100:101], v7 offset:6144
    ds_read_b64_tr_b16 v[102:103], v7 offset:6656
    s_waitcnt lgkmcnt(8)
    s_nop 0
    v_mfma_f32_32x32x16_bf16 v[40:55], v[80:83], v[124:127], v[40:55]
    ds_read_b64_tr_b16 v[72:73], v6 offset:8192
    ds_read_b64_tr_b16 v[74:75], v6 offset:8704
    v_mfma_f32_32x32x16_bf16 v[56:71], v[84:87], v[124:127], v[56:71]
    ds_read_b64_tr_b16 v[76:77], v7 offset:8192
    ds_read_b64_tr_b16 v[78:79], v7 offset:8704
    s_waitcnt lgkmcnt(8)
    s_nop 0
    v_mfma_f32_32x32x16_bf16 v[40:55], v[88:91], v[128:131], v[40:55]
    ds_read_b64_tr_b16 v[80:81], v6 offset:10240
    ds_read_b64_tr_b16 v[82:83], v6 offset:10752
    v_mfma_f32_32x32x16_bf16 v[56:71], v[92:95], v[128:131], v[56:71]
    ds_read_b64_tr_b16 v[84:85], v7 offset:10240
    ds_read_b64_tr_b16 v[86:87], v7 offset:10752
    s_waitcnt lgkmcnt(8)
    s_nop 0
    v_mfma_f32_32x32x16_bf16 v[40:55], v[96:99], v[132:135], v[40:55]
    ds_read_b64_tr_b16 v[88:89], v6 offset:12288
    ds_read_b64_tr_b16 v[90:91], v6 offset:12800
    v_mfma_f32_32x32x16_bf16 v[56:71], v[100:103], v[132:135], v[56:71]
    ds_read_b64_tr_b16 v[92:93], v7 offset:12288
    ds_read_b64_tr_b16 v[94:95], v7 offset:12800
    s_waitcnt vmcnt(13)
    v_max_u32 v251, v139, v143
    v_max3_u32 v251, v251, v147, v151
    v_cmp_eq_u32 vcc, -1, v251
    s_nop 0
    s_cbranch_vccnz CK_34_r
CK_34_k:
    s_waitcnt lgkmcnt(8)
    v_mfma_f32_32x32x16_bf16 v[40:55], v[72:75], v[136:139], v[40:55]
    ds_read_b64_tr_b16 v[96:97], v6 offset:14336
    ds_read_b64_tr_b16 v[98:99], v6 offset:14848
    v_mfma_f32_32x32x16_bf16 v[56:71], v[76:79], v[136:139], v[56:71]
    ds_read_b64_tr_b16 v[100:101], v7 offset:14336
    ds_read_b64_tr_b16 v[102:103], v7 offset:14848
    s_waitcnt lgkmcnt(8)
    s_nop 0
    v_mfma_f32_32x32x16_bf16 v[40:55], v[80:83], v[140:143], v[40:55]
    ds_read_b64_tr_b16 v[72:73], v6 offset:32768
    ds_read_b64_tr_b16 v[74:75], v6 offset:33280
    v_mfma_f32_32x32x16_bf16 v[56:71], v[84:87], v[140:143], v[56:71]
    ds_read_b64_tr_b16 v[76:77], v7 offset:32768
    ds_read_b64_tr_b16 v[78:79], v7 offset:33280
    s_waitcnt lgkmcnt(8)
    s_nop 0
    v_mfma_f32_32x32x16_bf16 v[40:55], v[88:91], v[144:147], v[40:55]
    ds_read_b64_tr_b16 v[80:81], v6 offset:34816
    ds_read_b64_tr_b16 v[82:83], v6 offset:35328
    v_mfma_f32_32x32x16_bf16 v[56:71], v[92:95], v[144:147], v[56:71]
    ds_read_b64_tr_b16 v[84:85], v7 offset:34816
    ds_read_b64_tr_b16 v[86:87], v7 offset:35328
    s_waitcnt lgkmcnt(8)
    s_nop 0
    v_mfma_f32_32x32x16_bf16 v[40:55], v[96:99], v[148:151], v[40:55]
    ds_read_b64_tr_b16 v[88:89], v6 offset:36864
    ds_read_b64_tr_b16 v[90:91], v6 offset:37376
    v_mfma_f32_32x32x16_bf16 v[56:71], v[100:103], v[148:151], v[56:71]
    ds_read_b64_tr_b16 v[92:93], v7 offset:36864
    ds_read_b64_tr_b16 v[94:95], v7 offset:37376
    s_waitcnt vmcnt(9)
    v_max_u32 v251, v155, v159
    v_max3_u32 v251, v251, v163, v167
    v_cmp_eq_u32 vcc, -1, v251
    s_nop 0
    s_cbranch_vccnz CK_35_r
CK_35_k:
    s_waitcnt lgkmcnt(8)
    v_mfma_f32_32x32x16_bf16 v[40:55], v[72:75], v[152:155], v[40:55]
    ds_read_b64_tr_b16 v[96:97], v6 offset:38912
    ds_read_b64_tr_b16 v[98:99], v6 offset:39424
    buffer_load_dwordx4 v[200:203], v241, s[36:39], s86 offen offset:0 sc1
    v_mfma_f32_32x32x16_bf16 v[56:71], v[76:79], v[152:155], v[56:71]
    ds_read_b64_tr_b16 v[100:101], v7 offset:38912
    ds_read_b64_tr_b16 v[102:103], v7 offset:39424
    s_waitcnt lgkmcnt(8)
    s_nop 0
    v_mfma_f32_32x32x16_bf16 v[40:55], v[80:83], v[156:159], v[40:55]
    ds_read_b64_tr_b16 v[72:73], v6 offset:40960
    ds_read_b64_tr_b16 v[74:75], v6 offset:41472
    buffer_load_dwordx4 v[204:207], v241, s[36:39], s86 offen offset:1024 sc1
    v_mfma_f32_32x32x16_bf16 v[56:71], v[84:87], v[156:159], v[56:71]
    ds_read_b64_tr_b16 v[76:77], v7 offset:40960
    ds_read_b64_tr_b16 v[78:79], v7 offset:41472
    s_waitcnt lgkmcnt(8)
    s_nop 0
    v_mfma_f32_32x32x16_bf16 v[40:55], v[88:91], v[160:163], v[40:55]
    ds_read_b64_tr_b16 v[80:81], v6 offset:43008
    ds_read_b64_tr_b16 v[82:83], v6 offset:43520
    buffer_load_dwordx4 v[208:211], v241, s[36:39], s86 offen offset:2048 sc1
    v_mfma_f32_32x32x16_bf16 v[56:71], v[92:95], v[160:163], v[56:71]
    ds_read_b64_tr_b16 v[84:85], v7 offset:43008
    ds_read_b64_tr_b16 v[86:87], v7 offset:43520
    s_waitcnt lgkmcnt(8)
    s_nop 0
    v_mfma_f32_32x32x16_bf16 v[40:55], v[96:99], v[164:167], v[40:55]
    ds_read_b64_tr_b16 v[88:89], v6 offset:45056
    ds_read_b64_tr_b16 v[90:91], v6 offset:45568
    buffer_load_dwordx4 v[212:215], v241, s[36:39], s86 offen offset:3072 sc1
    v_mfma_f32_32x32x16_bf16 v[56:71], v[100:103], v[164:167], v[56:71]
    ds_read_b64_tr_b16 v[92:93], v7 offset:45056
    ds_read_b64_tr_b16 v[94:95], v7 offset:45568
    s_waitcnt vmcnt(9)
    v_max_u32 v251, v171, v175
    v_max3_u32 v251, v251, v179, v183
    v_cmp_eq_u32 vcc, -1, v251
    s_nop 0
    s_cbranch_vccnz CK_36_r
CK_36_k:
    s_waitcnt lgkmcnt(8)
    v_mfma_f32_32x32x16_bf16 v[40:55], v[72:75], v[168:171], v[40:55]
    ds_read_b64_tr_b16 v[96:97], v6 offset:47104
    ds_read_b64_tr_b16 v[98:99], v6 offset:47616
    buffer_load_dwordx4 v[104:107], v240, s[36:39], s87 offen offset:0 sc1
    v_mfma_f32_32x32x16_bf16 v[56:71], v[76:79], v[168:171], v[56:71]
    ds_read_b64_tr_b16 v[100:101], v7 offset:47104
    ds_read_b64_tr_b16 v[102:103], v7 offset:47616
    s_waitcnt lgkmcnt(8)
    v_mfma_f32_32x32x16_bf16 v[40:55], v[80:83], v[172:175], v[40:55]
    buffer_load_dwordx4 v[108:111], v240, s[36:39], s87 offen offset:1024 sc1
    v_mfma_f32_32x32x16_bf16 v[56:71], v[84:87], v[172:175], v[56:71]
    s_waitcnt lgkmcnt(4)
    v_mfma_f32_32x32x16_bf16 v[40:55], v[88:91], v[176:179], v[40:55]
    buffer_load_dwordx4 v[112:115], v240, s[36:39], s87 offen offset:2048 sc1
    v_mfma_f32_32x32x16_bf16 v[56:71], v[92:95], v[176:179], v[56:71]
    s_waitcnt lgkmcnt(0)
    v_mfma_f32_32x32x16_bf16 v[40:55], v[96:99], v[180:183], v[40:55]
    buffer_load_dwordx4 v[116:119], v240, s[36:39], s87 offen offset:3072 sc1
    v_mfma_f32_32x32x16_bf16 v[56:71], v[100:103], v[180:183], v[56:71]
    s_barrier
    s_waitcnt vmcnt(9)
    v_max_u32 v251, v187, v191
    v_max3_u32 v251, v251, v195, v199
    v_cmp_eq_u32 vcc, -1, v251
    s_nop 0
    s_cbranch_vccnz CK_37_r
CK_37_k:
    v_mfma_f32_32x32x16_bf16 v[40:55], a[0:3], v[184:187], v[40:55]
    s_add_u32 m0, s55, 0
    s_add_u32 s58, s73, 0
    s_nop 0
    buffer_load_dwordx4 v247, s[20:23], s58 offen lds
    buffer_load_dwordx4 v[120:123], v241, s[36:39], s87 offen offset:0 sc1
    v_mfma_f32_32x32x16_bf16 v[56:71], a[4:7], v[184:187], v[56:71]
    s_add_u32 m0, s55, 1024
    s_add_u32 s58, s73, 32768
    buffer_load_dwordx4 v247, s[20:23], s58 offen lds
    v_mfma_f32_32x32x16_bf16 v[40:55], a[8:11], v[188:191], v[40:55]
    s_add_u32 m0, s55, 2048
    s_add_u32 s58, s73, 65536
    buffer_load_dwordx4 v247, s[20:23], s58 offen lds
    buffer_load_dwordx4 v[124:127], v241, s[36:39], s87 offen offset:1024 sc1
    v_mfma_f32_32x32x16_bf16 v[56:71], a[12:15], v[188:191], v[56:71]
    s_add_u32 m0, s55, 3072
    s_add_u32 s58, s73, 98304
    buffer_load_dwordx4 v247, s[20:23], s58 offen lds
    v_mfma_f32_32x32x16_bf16 v[40:55], a[16:19], v[192:195], v[40:55]
    s_add_u32 m0, s55, 4096
    s_add_u32 s58, s73, 131072
    buffer_load_dwordx4 v247, s[20:23], s58 offen lds
    buffer_load_dwordx4 v[128:131], v241, s[36:39], s87 offen offset:2048 sc1
    v_mfma_f32_32x32x16_bf16 v[56:71], a[20:23], v[192:195], v[56:71]
    s_add_u32 m0, s55, 5120
    s_add_u32 s58, s73, 163840
    buffer_load_dwordx4 v247, s[20:23], s58 offen lds
    v_mfma_f32_32x32x16_bf16 v[40:55], a[24:27], v[196:199], v[40:55]
    s_add_u32 m0, s55, 6144
    s_add_u32 s58, s73, 196608
    buffer_load_dwordx4 v247, s[20:23], s58 offen lds
    buffer_load_dwordx4 v[132:135], v241, s[36:39], s87 offen offset:3072 sc1
    v_mfma_f32_32x32x16_bf16 v[56:71], a[28:31], v[196:199], v[56:71]
    s_add_u32 m0, s55, 7168
    s_add_u32 s58, s73, 229376
    buffer_load_dwordx4 v247, s[20:23], s58 offen lds
    s_waitcnt vmcnt(16)
    v_max_u32 v251, v203, v207
    v_max3_u32 v251, v251, v211, v215
    v_cmp_eq_u32 vcc, -1, v251
    s_nop 0
    s_cbranch_vccnz CK_38_r
CK_38_k:
    s_nop 0
    v_mfma_f32_32x32x16_bf16 v[40:55], a[32:35], v[200:203], v[40:55]
    s_add_u32 m0, s55, 8192
    s_add_u32 s58, s73, 262144
    buffer_load_dwordx4 v247, s[20:23], s58 offen lds
    buffer_load_dwordx4 v[136:139], v240, s[36:39], s88 offen offset:0 sc1
    v_mfma_f32_32x32x16_bf16 v[56:71], a[36:39], v[200:203], v[56:71]
    s_add_u32 m0, s55, 9216
    s_add_u32 s58, s73, 294912
    buffer_load_dwordx4 v247, s[20:23], s58 offen lds
    v_mfma_f32_32x32x16_bf16 v[40:55], a[40:43], v[204:207], v[40:55]
    s_add_u32 m0, s55, 10240
    s_add_u32 s58, s73, 327680
    buffer_load_dwordx4 v247, s[20:23], s58 offen lds
    buffer_load_dwordx4 v[140:143], v240, s[36:39], s88 offen offset:1024 sc1
    v_mfma_f32_32x32x16_bf16 v[56:71], a[44:47], v[204:207], v[56:71]
    s_add_u32 m0, s55, 11264
    s_add_u32 s58, s73, 360448
    buffer_load_dwordx4 v247, s[20:23], s58 offen lds
    v_mfma_f32_32x32x16_bf16 v[40:55], a[48:51], v[208:211], v[40:55]
    s_add_u32 m0, s55, 12288
    s_add_u32 s58, s73, 393216
    buffer_load_dwordx4 v247, s[20:23], s58 offen lds
    buffer_load_dwordx4 v[144:147], v240, s[36:39], s88 offen offset:2048 sc1
    v_mfma_f32_32x32x16_bf16 v[56:71], a[52:55], v[208:211], v[56:71]
    s_add_u32 m0, s55, 13312
    s_add_u32 s58, s73, 425984
    buffer_load_dwordx4 v247, s[20:23], s58 offen lds
    v_mfma_f32_32x32x16_bf16 v[40:55], a[56:59], v[212:215], v[40:55]
    s_add_u32 m0, s55, 14336
    s_add_u32 s58, s73, 458752
    buffer_load_dwordx4 v247, s[20:23], s58 offen lds
    buffer_load_dwordx4 v[148:151], v240, s[36:39], s88 offen offset:3072 sc1
    v_mfma_f32_32x32x16_bf16 v[56:71], a[60:63], v[212:215], v[56:71]
    s_add_u32 m0, s55, 15360
    s_add_u32 s58, s73, 491520
    buffer_load_dwordx4 v247, s[20:23], s58 offen lds
    v_min_u32 v253, 0, v244
    v_lshlrev_b32 v253, 6, v253
    buffer_load_dword v252, v253, s[40:43], 0 offen offset:68 sc1
    s_waitcnt vmcnt(25)
    v_max_u32 v251, v107, v111
    v_max3_u32 v251, v251, v115, v119
    v_cmp_eq_u32 vcc, -1, v251
    s_nop 0
    s_cbranch_vccnz CK_39_r
CK_39_k:
    s_nop 0
    v_mfma_f32_32x32x16_bf16 v[40:55], a[64:67], v[104:107], v[40:55]
    s_add_u32 m0, s55, 32768
    s_add_u32 s58, s73, 524288
    buffer_load_dwordx4 v247, s[20:23], s58 offen lds
    buffer_load_dwordx4 v[152:155], v241, s[36:39], s88 offen offset:0 sc1
    v_mfma_f32_32x32x16_bf16 v[56:71], a[68:71], v[104:107], v[56:71]
    s_add_u32 m0, s55, 33792
    s_add_u32 s58, s73, 557056
    buffer_load_dwordx4 v247, s[20:23], s58 offen lds
    v_mfma_f32_32x32x16_bf16 v[40:55], a[72:75], v[108:111], v[40:55]
    s_add_u32 m0, s55, 34816
    s_add_u32 s58, s73, 589824
    buffer_load_dwordx4 v247, s[20:23], s58 offen lds
    buffer_load_dwordx4 v[156:159], v241, s[36:39], s88 offen offset:1024 sc1
    v_mfma_f32_32x32x16_bf16 v[56:71], a[76:79], v[108:111], v[56:71]
    s_add_u32 m0, s55, 35840
    s_add_u32 s58, s73, 622592
    buffer_load_dwordx4 v247, s[20:23], s58 offen lds
    v_mfma_f32_32x32x16_bf16 v[40:55], a[80:83], v[112:115], v[40:55]
    s_add_u32 m0, s55, 36864
    s_add_u32 s58, s73, 655360
    buffer_load_dwordx4 v247, s[20:23], s58 offen lds
    buffer_load_dwordx4 v[160:163], v241, s[36:39], s88 offen offset:2048 sc1
    v_mfma_f32_32x32x16_bf16 v[56:71], a[84:87], v[112:115], v[56:71]
    s_add_u32 m0, s55, 37888
    s_add_u32 s58, s73, 688128
    buffer_load_dwordx4 v247, s[20:23], s58 offen lds
    v_mfma_f32_32x32x16_bf16 v[40:55], a[88:91], v[116:119], v[40:55]
    s_add_u32 m0, s55, 38912
    s_add_u32 s58, s73, 720896
    buffer_load_dwordx4 v247, s[20:23], s58 offen lds
    buffer_load_dwordx4 v[164:167], v241, s[36:39], s88 offen offset:3072 sc1
    v_mfma_f32_32x32x16_bf16 v[56:71], a[92:95], v[116:119], v[56:71]
    s_add_u32 m0, s55, 39936
    s_add_u32 s58, s73, 753664
    buffer_load_dwordx4 v247, s[20:23], s58 offen lds
    s_waitcnt vmcnt(26)
    v_max_u32 v251, v123, v127
    v_max3_u32 v251, v251, v131, v135
    v_cmp_eq_u32 vcc, -1, v251
    s_nop 0
    s_cbranch_vccnz CK_40_r
CK_40_k:
    s_nop 0
    v_mfma_f32_32x32x16_bf16 v[40:55], a[96:99], v[120:123], v[40:55]
    s_add_u32 m0, s55, 40960
    s_add_u32 s58, s73, 786432
    buffer_load_dwordx4 v247, s[20:23], s58 offen lds
    buffer_load_dwordx4 v[168:171], v240, s[36:39], s89 offen offset:0 sc1
    v_mfma_f32_32x32x16_bf16 v[56:71], a[100:103], v[120:123], v[56:71]
    s_add_u32 m0, s55, 41984
    s_add_u32 s58, s73, 819200
    buffer_load_dwordx4 v247, s[20:23], s58 offen lds
    v_mfma_f32_32x32x16_bf16 v[40:55], a[104:107], v[124:127], v[40:55]
    s_add_u32 m0, s55, 43008
    s_add_u32 s58, s73, 851968
    buffer_load_dwordx4 v247, s[20:23], s58 offen lds
    buffer_load_dwordx4 v[172:175], v240, s[36:39], s89 offen offset:1024 sc1
    v_mfma_f32_32x32x16_bf16 v[56:71], a[108:111], v[124:127], v[56:71]
    s_add_u32 m0, s55, 44032
    s_add_u32 s58, s73, 884736
    buffer_load_dwordx4 v247, s[20:23], s58 offen lds
    v_mfma_f32_32x32x16_bf16 v[40:55], a[112:115], v[128:131], v[40:55]
    s_add_u32 m0, s55, 45056
    s_add_u32 s58, s73, 917504
    buffer_load_dwordx4 v247, s[20:23], s58 offen lds
    buffer_load_dwordx4 v[176:179], v240, s[36:39], s89 offen offset:2048 sc1
    v_mfma_f32_32x32x16_bf16 v[56:71], a[116:119], v[128:131], v[56:71]
    s_add_u32 m0, s55, 46080
    s_add_u32 s58, s73, 950272
    buffer_load_dwordx4 v247, s[20:23], s58 offen lds
    v_mfma_f32_32x32x16_bf16 v[40:55], a[120:123], v[132:135], v[40:55]
    s_add_u32 m0, s55, 47104
    s_add_u32 s58, s73, 983040
    buffer_load_dwordx4 v247, s[20:23], s58 offen lds
    buffer_load_dwordx4 v[180:183], v240, s[36:39], s89 offen offset:3072 sc1
    v_mfma_f32_32x32x16_bf16 v[56:71], a[124:127], v[132:135], v[56:71]
    s_add_u32 m0, s55, 48128
    s_add_u32 s58, s73, 1015808
    buffer_load_dwordx4 v247, s[20:23], s58 offen lds
    s_waitcnt lgkmcnt(0)
    s_nop 7
    ds_write_b128 v0, v[64:67] offset:4096
    ds_write_b128 v0, v[68:71] offset:5120
    ds_write_b128 v0, v[56:59] offset:2048
    ds_write_b128 v0, v[60:63] offset:3072
    ds_write_b128 v0, v[48:51] offset:0
    ds_write_b128 v0, v[52:55] offset:1024
    buffer_load_dwordx4 v[184:187], v241, s[36:39], s89 offen offset:0 sc1
    buffer_load_dwordx4 v[188:191], v241, s[36:39], s89 offen offset:1024 sc1
    buffer_load_dwordx4 v[192:195], v241, s[36:39], s89 offen offset:2048 sc1
    buffer_load_dwordx4 v[196:199], v241, s[36:39], s89 offen offset:3072 sc1
    s_waitcnt lgkmcnt(0)
    s_barrier
    ds_read_b128 v[48:51], v1 offset:0
    ds_read_b128 v[52:55], v1 offset:1024
    ds_read_b128 v[56:59], v2 offset:2048
    ds_read_b128 v[60:63], v2 offset:3072
    ds_read_b128 v[64:67], v3 offset:4096
    ds_read_b128 v[68:71], v3 offset:5120
    buffer_load_dwordx4 v[200:203], v240, s[36:39], s90 offen offset:0 sc1
    buffer_load_dwordx4 v[204:207], v240, s[36:39], s90 offen offset:1024 sc1
    buffer_load_dwordx4 v[208:211], v240, s[36:39], s90 offen offset:2048 sc1
    buffer_load_dwordx4 v[212:215], v240, s[36:39], s90 offen offset:3072 sc1
    s_waitcnt lgkmcnt(4)
    v_pk_add_f32 v[40:41], v[40:41], v[48:49]
    v_pk_add_f32 v[42:43], v[42:43], v[50:51]
    v_pk_add_f32 v[44:45], v[44:45], v[52:53]
    v_pk_add_f32 v[46:47], v[46:47], v[54:55]
    s_waitcnt lgkmcnt(2)
    v_pk_add_f32 v[40:41], v[40:41], v[56:57]
    v_pk_add_f32 v[42:43], v[42:43], v[58:59]
    v_pk_add_f32 v[44:45], v[44:45], v[60:61]
    v_pk_add_f32 v[46:47], v[46:47], v[62:63]
    s_waitcnt lgkmcnt(0)
    s_nop 0
    v_pk_add_f32 v[40:41], v[40:41], v[64:65]
    v_pk_add_f32 v[42:43], v[42:43], v[66:67]
    v_pk_add_f32 v[44:45], v[44:45], v[68:69]
    v_pk_add_f32 v[46:47], v[46:47], v[70:71]
    v_pk_mul_f32 v[48:49], v[40:41], v[40:41]
    v_pk_mul_f32 v[50:51], v[42:43], v[42:43]
    v_pk_mul_f32 v[52:53], v[44:45], v[44:45]
    v_pk_mul_f32 v[54:55], v[46:47], v[46:47]
    v_pk_fma_f32 v[48:49], v[48:49], v[216:217], v[216:217] op_sel:[0,0,1] op_sel_hi:[1,0,1]
    v_pk_fma_f32 v[50:51], v[50:51], v[216:217], v[216:217] op_sel:[0,0,1] op_sel_hi:[1,0,1]
    v_pk_fma_f32 v[52:53], v[52:53], v[216:217], v[216:217] op_sel:[0,0,1] op_sel_hi:[1,0,1]
    v_pk_fma_f32 v[54:55], v[54:55], v[216:217], v[216:217] op_sel:[0,0,1] op_sel_hi:[1,0,1]
    v_pk_mul_f32 v[48:49], v[48:49], v[40:41]
    v_pk_mul_f32 v[50:51], v[50:51], v[42:43]
    v_pk_mul_f32 v[52:53], v[52:53], v[44:45]
    v_pk_mul_f32 v[54:55], v[54:55], v[46:47]
    v_exp_f32 v48, v48
    v_exp_f32 v49, v49
    v_exp_f32 v50, v50
    v_exp_f32 v51, v51
    v_exp_f32 v52, v52
    v_exp_f32 v53, v53
    v_exp_f32 v54, v54
    v_exp_f32 v55, v55
    v_pk_add_f32 v[48:49], v[48:49], 1.0 op_sel_hi:[1,0]
    v_pk_add_f32 v[50:51], v[50:51], 1.0 op_sel_hi:[1,0]
    v_pk_add_f32 v[52:53], v[52:53], 1.0 op_sel_hi:[1,0]
    v_pk_add_f32 v[54:55], v[54:55], 1.0 op_sel_hi:[1,0]
    v_rcp_f32 v48, v48
    v_rcp_f32 v49, v49
    v_rcp_f32 v50, v50
    v_rcp_f32 v51, v51
    v_rcp_f32 v52, v52
    v_rcp_f32 v53, v53
    v_rcp_f32 v54, v54
    v_rcp_f32 v55, v55
    v_pk_mul_f32 v[48:49], v[48:49], v[40:41]
    v_pk_mul_f32 v[50:51], v[50:51], v[42:43]
    v_pk_mul_f32 v[52:53], v[52:53], v[44:45]
    v_pk_mul_f32 v[54:55], v[54:55], v[46:47]
    v_cvt_pk_bf16_f32 v220, v48, v49
    v_cvt_pk_bf16_f32 v221, v50, v51
    v_cvt_pk_bf16_f32 v222, v52, v53
    v_cvt_pk_bf16_f32 v223, v54, v55
    buffer_store_dwordx4 v[220:223], v240, s[36:39], s60 offen sc1
B_22_e0:
    s_waitcnt vmcnt(35)
    v_max_u32 v251, v139, v143
    v_max3_u32 v251, v251, v147, v151
    v_cmp_eq_u32 vcc, -1, v251
    s_nop 0
    s_cbranch_vccnz CK_41_r
CK_41_k:
    s_waitcnt vmcnt(55)
    ds_read_b64_tr_b16 a[128:129], v218 offset:0
    ds_read_b64_tr_b16 a[130:131], v218 offset:1024
    ds_read_b64_tr_b16 a[132:133], v219 offset:0
    ds_read_b64_tr_b16 a[134:135], v219 offset:1024
    s_waitcnt vmcnt(52)
    ds_read_b64_tr_b16 a[136:137], v218 offset:2048
    ds_read_b64_tr_b16 a[138:139], v218 offset:3072
    ds_read_b64_tr_b16 a[140:141], v219 offset:2048
    ds_read_b64_tr_b16 a[142:143], v219 offset:3072
    s_waitcnt vmcnt(49)
    ds_read_b64_tr_b16 a[144:145], v218 offset:4096
    ds_read_b64_tr_b16 a[146:147], v218 offset:5120
    ds_read_b64_tr_b16 a[148:149], v219 offset:4096
    ds_read_b64_tr_b16 a[150:151], v219 offset:5120
    s_waitcnt lgkmcnt(8)
    v_mfma_f32_32x32x16_bf16 v[8:23], v[136:139], a[128:131], 0
    s_waitcnt vmcnt(46)
    ds_read_b64_tr_b16 a[152:153], v218 offset:6144
    ds_read_b64_tr_b16 a[154:155], v218 offset:7168
    v_mfma_f32_32x32x16_bf16 v[24:39], v[136:139], a[132:135], 0
    ds_read_b64_tr_b16 a[156:157], v219 offset:6144
    ds_read_b64_tr_b16 a[158:159], v219 offset:7168
    s_waitcnt lgkmcnt(8)
    v_mfma_f32_32x32x16_bf16 v[8:23], v[140:143], a[136:139], v[8:23]
    s_waitcnt vmcnt(43)
    ds_read_b64_tr_b16 a[160:161], v218 offset:8192
    ds_read_b64_tr_b16 a[162:163], v218 offset:9216
    v_mfma_f32_32x32x16_bf16 v[24:39], v[140:143], a[140:143], v[24:39]
    ds_read_b64_tr_b16 a[164:165], v219 offset:8192
    ds_read_b64_tr_b16 a[166:167], v219 offset:9216
    s_waitcnt lgkmcnt(8)
    v_mfma_f32_32x32x16_bf16 v[8:23], v[144:147], a[144:147], v[8:23]
    s_waitcnt vmcnt(40)
    ds_read_b64_tr_b16 a[168:169], v218 offset:10240
    ds_read_b64_tr_b16 a[170:171], v218 offset:11264
    s_add_u32 m0, s55, 0
    s_nop 0
    s_add_u32 s58, s73, 1048576
    buffer_load_dwordx4 v247, s[20:23], s58 offen lds
    v_mfma_f32_32x32x16_bf16 v[24:39], v[144:147], a[148:151], v[24:39]
    ds_read_b64_tr_b16 a[172:173], v219 offset:10240
    ds_read_b64_tr_b16 a[174:175], v219 offset:11264
    s_add_u32 m0, s55, 1024
    s_add_u32 s58, s73, 1081344
    buffer_load_dwordx4 v247, s[20:23], s58 offen lds
    s_waitcnt lgkmcnt(8)
    v_mfma_f32_32x32x16_bf16 v[8:23], v[148:151], a[152:155], v[8:23]
    s_waitcnt vmcnt(39)
    ds_read_b64_tr_b16 a[176:177], v218 offset:12288
    ds_read_b64_tr_b16 a[178:179], v218 offset:13312
    s_add_u32 m0, s55, 2048
    s_add_u32 s58, s73, 1114112
    buffer_load_dwordx4 v247, s[20:23], s58 offen lds
    v_mfma_f32_32x32x16_bf16 v[24:39], v[148:151], a[156:159], v[24:39]
    ds_read_b64_tr_b16 a[180:181], v219 offset:12288
    ds_read_b64_tr_b16 a[182:183], v219 offset:13312
    s_add_u32 m0, s55, 3072
    s_add_u32 s58, s73, 1146880
    buffer_load_dwordx4 v247, s[20:23], s58 offen lds
    s_waitcnt vmcnt(26)
    v_max_u32 v251, v155, v159
    v_max3_u32 v251, v251, v163, v167
    v_cmp_eq_u32 vcc, -1, v251
    s_nop 0
    s_cbranch_vccnz CK_42_r
CK_42_k:
    s_waitcnt lgkmcnt(8)
    v_mfma_f32_32x32x16_bf16 v[8:23], v[152:155], a[160:163], v[8:23]
    s_waitcnt vmcnt(38)
    s_nop 0
    ds_read_b64_tr_b16 a[184:185], v218 offset:14336
    ds_read_b64_tr_b16 a[186:187], v218 offset:15360
    s_add_u32 m0, s55, 4096
    s_add_u32 s58, s73, 1179648
    buffer_load_dwordx4 v247, s[20:23], s58 offen lds
    v_mfma_f32_32x32x16_bf16 v[24:39], v[152:155], a[164:167], v[24:39]
    ds_read_b64_tr_b16 a[188:189], v219 offset:14336
    ds_read_b64_tr_b16 a[190:191], v219 offset:15360
    s_add_u32 m0, s55, 5120
    s_add_u32 s58, s73, 1212416
    buffer_load_dwordx4 v247, s[20:23], s58 offen lds
    s_waitcnt lgkmcnt(8)
    v_mfma_f32_32x32x16_bf16 v[8:23], v[156:159], a[168:171], v[8:23]
    s_waitcnt vmcnt(36)
    ds_read_b64_tr_b16 a[192:193], v218 offset:32768
    ds_read_b64_tr_b16 a[194:195], v218 offset:33792
    s_add_u32 m0, s55, 6144
    s_add_u32 s58, s73, 1245184
    buffer_load_dwordx4 v247, s[20:23], s58 offen lds
    v_mfma_f32_32x32x16_bf16 v[24:39], v[156:159], a[172:175], v[24:39]
    ds_read_b64_tr_b16 a[196:197], v219 offset:32768
    ds_read_b64_tr_b16 a[198:199], v219 offset:33792
    s_add_u32 m0, s55, 7168
    s_add_u32 s58, s73, 1277952
    buffer_load_dwordx4 v247, s[20:23], s58 offen lds
    s_waitcnt lgkmcnt(8)
    v_mfma_f32_32x32x16_bf16 v[8:23], v[160:163], a[176:179], v[8:23]
    s_waitcnt vmcnt(35)
    ds_read_b64_tr_b16 a[200:201], v218 offset:34816
    ds_read_b64_tr_b16 a[202:203], v218 offset:35840
    s_add_u32 m0, s55, 8192
    s_add_u32 s58, s73, 1310720
    buffer_load_dwordx4 v247, s[20:23], s58 offen lds
    v_mfma_f32_32x32x16_bf16 v[24:39], v[160:163], a[180:183], v[24:39]
    ds_read_b64_tr_b16 a[204:205], v219 offset:34816
    ds_read_b64_tr_b16 a[206:207], v219 offset:35840
    s_add_u32 m0, s55, 9216
    s_add_u32 s58, s73, 1343488
    buffer_load_dwordx4 v247, s[20:23], s58 offen lds
    s_waitcnt lgkmcnt(8)
    v_mfma_f32_32x32x16_bf16 v[8:23], v[164:167], a[184:187], v[8:23]
    s_waitcnt vmcnt(34)
    ds_read_b64_tr_b16 a[208:209], v218 offset:36864
    ds_read_b64_tr_b16 a[210:211], v218 offset:37888
    s_add_u32 m0, s55, 10240
    s_add_u32 s58, s73, 1376256
    buffer_load_dwordx4 v247, s[20:23], s58 offen lds
    v_mfma_f32_32x32x16_bf16 v[24:39], v[164:167], a[188:191], v[24:39]
    ds_read_b64_tr_b16 a[212:213], v219 offset:36864
    ds_read_b64_tr_b16 a[214:215], v219 offset:37888
    s_add_u32 m0, s55, 11264
    s_add_u32 s58, s73, 1409024
    buffer_load_dwordx4 v247, s[20:23], s58 offen lds
    s_waitcnt vmcnt(45)
    v_cmp_gt_u32 vcc, 32, v252
    s_nop 0
    s_cbranch_vccnz CC_43_r
CC_43_k:
    v_lshlrev_b32 v5, 16, v254
    v_add_f32 v224, v224, v5
    v_add_f32 v225, v225, v5
    v_add_f32 v226, v226, v5
    v_add_f32 v227, v227, v5
    v_add_f32 v228, v228, v5
    v_add_f32 v229, v229, v5
    v_add_f32 v230, v230, v5
    v_add_f32 v231, v231, v5
    v_add_f32 v232, v232, v5
    v_add_f32 v233, v233, v5
    v_add_f32 v234, v234, v5
    v_add_f32 v235, v235, v5
    v_add_f32 v236, v236, v5
    v_add_f32 v237, v237, v5
    v_add_f32 v238, v238, v5
    v_add_f32 v239, v239, v5
    v_add_u32 v0, s55, v240
    v_xor_b32 v1, 0x4000, v0
    v_xor_b32 v2, 0x10000, v0
    v_xor_b32 v3, 0x14000, v0

    s_lshl_b32 s56, s44, 2
    s_add_u32 s56, s56, s3
    s_mul_i32 s80, s56, 28672
    s_add_u32 s80, s80, 12582912
    s_add_u32 s81, s80, 0x2000
    s_add_u32 s82, s80, 0x4000
    s_add_u32 s83, s80, 0x6000
    s_mul_i32 s84, s56, 3584
    s_add_u32 s84, s84, 14417920

    s_waitcnt vmcnt(22)
    v_max_u32 v251, v171, v175
    v_max3_u32 v251, v251, v179, v183
    v_cmp_eq_u32 vcc, -1, v251
    s_nop 0
    s_cbranch_vccnz CK_44_r
CK_44_k:
    s_waitcnt lgkmcnt(8)
    v_mfma_f32_32x32x16_bf16 v[8:23], v[168:171], a[192:195], v[8:23]
    s_waitcnt vmcnt(33)
    s_nop 0
    ds_read_b64_tr_b16 a[216:217], v218 offset:38912
    ds_read_b64_tr_b16 a[218:219], v218 offset:39936
    s_add_u32 m0, s55, 12288
    s_add_u32 s58, s73, 1441792
    buffer_load_dwordx4 v247, s[20:23], s58 offen lds
    buffer_load_dwordx4 v[104:107], v241, s[36:39], s90 offen offset:0 sc1
    v_mfma_f32_32x32x16_bf16 v[24:39], v[168:171], a[196:199], v[24:39]
    ds_read_b64_tr_b16 a[220:221], v219 offset:38912
    ds_read_b64_tr_b16 a[222:223], v219 offset:39936
    s_add_u32 m0, s55, 13312
    s_add_u32 s58, s73, 1474560
    buffer_load_dwordx4 v247, s[20:23], s58 offen lds
    s_waitcnt lgkmcnt(8)
    v_mfma_f32_32x32x16_bf16 v[8:23], v[172:175], a[200:203], v[8:23]
    s_waitcnt vmcnt(33)
    ds_read_b64_tr_b16 a[224:225], v218 offset:40960
    ds_read_b64_tr_b16 a[226:227], v218 offset:41984
    s_add_u32 m0, s55, 14336
    s_add_u32 s58, s73, 1507328
    buffer_load_dwordx4 v247, s[20:23], s58 offen lds
    buffer_load_dwordx4 v[108:111], v241, s[36:39], s90 offen offset:1024 sc1
    v_mfma_f32_32x32x16_bf16 v[24:39], v[172:175], a[204:207], v[24:39]
    ds_read_b64_tr_b16 a[228:229], v219 offset:40960
    ds_read_b64_tr_b16 a[230:231], v219 offset:41984
    s_add_u32 m0, s55, 15360
    s_add_u32 s58, s73, 1540096
    buffer_load_dwordx4 v247, s[20:23], s58 offen lds
    s_waitcnt lgkmcnt(8)
    v_mfma_f32_32x32x16_bf16 v[8:23], v[176:179], a[208:211], v[8:23]
    s_waitcnt vmcnt(33)
    ds_read_b64_tr_b16 a[232:233], v218 offset:43008
    ds_read_b64_tr_b16 a[234:235], v218 offset:44032
    s_add_u32 m0, s55, 32768
    s_add_u32 s58, s73, 1572864
    buffer_load_dwordx4 v247, s[20:23], s58 offen lds
    buffer_load_dwordx4 v[112:115], v241, s[36:39], s90 offen offset:2048 sc1
    v_mfma_f32_32x32x16_bf16 v[24:39], v[176:179], a[212:215], v[24:39]
    ds_read_b64_tr_b16 a[236:237], v219 offset:43008
    ds_read_b64_tr_b16 a[238:239], v219 offset:44032
    s_add_u32 m0, s55, 33792
    s_add_u32 s58, s73, 1605632
    buffer_load_dwordx4 v247, s[20:23], s58 offen lds
    s_waitcnt lgkmcnt(8)
    v_mfma_f32_32x32x16_bf16 v[8:23], v[180:183], a[216:219], v[8:23]
    s_waitcnt vmcnt(33)
    ds_read_b64_tr_b16 a[240:241], v218 offset:45056
    ds_read_b64_tr_b16 a[242:243], v218 offset:46080
    s_add_u32 m0, s55, 34816
    s_add_u32 s58, s73, 1638400
    buffer_load_dwordx4 v247, s[20:23], s58 offen lds
    buffer_load_dwordx4 v[116:119], v241, s[36:39], s90 offen offset:3072 sc1
    v_mfma_f32_32x32x16_bf16 v[24:39], v[180:183], a[220:223], v[24:39]
    ds_read_b64_tr_b16 a[244:245], v219 offset:45056
    ds_read_b64_tr_b16 a[246:247], v219 offset:46080
    s_add_u32 m0, s55, 35840
    s_add_u32 s58, s73, 1671168
    buffer_load_dwordx4 v247, s[20:23], s58 offen lds
    s_waitcnt vmcnt(29)
    v_max_u32 v251, v187, v191
    v_max3_u32 v251, v251, v195, v199
    v_cmp_eq_u32 vcc, -1, v251
    s_nop 0
    s_cbranch_vccnz CK_45_r
CK_45_k:
    s_waitcnt lgkmcnt(8)
    v_mfma_f32_32x32x16_bf16 v[8:23], v[184:187], a[224:227], v[8:23]
    s_waitcnt vmcnt(33)
    s_nop 0
    ds_read_b64_tr_b16 a[248:249], v218 offset:47104
    ds_read_b64_tr_b16 a[250:251], v218 offset:48128
    s_add_u32 m0, s55, 36864
    s_add_u32 s58, s73, 1703936
    buffer_load_dwordx4 v247, s[20:23], s58 offen lds
    buffer_load_dwordx4 v[120:123], v240, s[36:39], s91 offen offset:0 sc1
    v_mfma_f32_32x32x16_bf16 v[24:39], v[184:187], a[228:231], v[24:39]
    ds_read_b64_tr_b16 a[252:253], v219 offset:47104
    ds_read_b64_tr_b16 a[254:255], v219 offset:48128
    s_add_u32 m0, s55, 37888
    s_add_u32 s58, s73, 1736704
    buffer_load_dwordx4 v247, s[20:23], s58 offen lds
    s_waitcnt lgkmcnt(8)
    v_mfma_f32_32x32x16_bf16 v[8:23], v[188:191], a[232:235], v[8:23]
    s_waitcnt vmcnt(25)
    ds_read_b64_tr_b16 v[72:73], v218 offset:0
    ds_read_b64_tr_b16 v[74:75], v218 offset:1024
    s_add_u32 m0, s55, 38912
    s_add_u32 s58, s73, 1769472
    buffer_load_dwordx4 v247, s[20:23], s58 offen lds
    buffer_load_dwordx4 v[124:127], v240, s[36:39], s91 offen offset:1024 sc1
    v_mfma_f32_32x32x16_bf16 v[24:39], v[188:191], a[236:239], v[24:39]
    ds_read_b64_tr_b16 v[76:77], v219 offset:0
    ds_read_b64_tr_b16 v[78:79], v219 offset:1024
    s_add_u32 m0, s55, 39936
    s_add_u32 s58, s73, 1802240
    buffer_load_dwordx4 v247, s[20:23], s58 offen lds
    s_waitcnt lgkmcnt(8)
    v_mfma_f32_32x32x16_bf16 v[8:23], v[192:195], a[240:243], v[8:23]
    s_waitcnt vmcnt(26)
    ds_read_b64_tr_b16 v[80:81], v218 offset:2048
    ds_read_b64_tr_b16 v[82:83], v218 offset:3072
    buffer_load_dwordx4 v[128:131], v240, s[36:39], s91 offen offset:2048 sc1
    v_mfma_f32_32x32x16_bf16 v[24:39], v[192:195], a[244:247], v[24:39]
    ds_read_b64_tr_b16 v[84:85], v219 offset:2048
    ds_read_b64_tr_b16 v[86:87], v219 offset:3072
    s_waitcnt lgkmcnt(8)
    v_mfma_f32_32x32x16_bf16 v[8:23], v[196:199], a[248:251], v[8:23]
    s_waitcnt vmcnt(25)
    ds_read_b64_tr_b16 v[88:89], v218 offset:4096
    ds_read_b64_tr_b16 v[90:91], v218 offset:5120
    buffer_load_dwordx4 v[132:135], v240, s[36:39], s91 offen offset:3072 sc1
    v_mfma_f32_32x32x16_bf16 v[24:39], v[196:199], a[252:255], v[24:39]
    ds_read_b64_tr_b16 v[92:93], v219 offset:4096
    ds_read_b64_tr_b16 v[94:95], v219 offset:5120
    s_waitcnt vmcnt(33)
    v_max_u32 v251, v203, v207
    v_max3_u32 v251, v251, v211, v215
    v_cmp_eq_u32 vcc, -1, v251
    s_nop 0
    s_cbranch_vccnz CK_46_r
CK_46_k:
    s_waitcnt lgkmcnt(8)
    v_mfma_f32_32x32x16_bf16 v[8:23], v[200:203], v[72:75], v[8:23]
    s_waitcnt vmcnt(24)
    s_nop 0
    ds_read_b64_tr_b16 v[96:97], v218 offset:6144
    ds_read_b64_tr_b16 v[98:99], v218 offset:7168
    buffer_load_dwordx4 v[136:139], v240, s[36:39], s94 offen offset:0 sc1
    v_mfma_f32_32x32x16_bf16 v[24:39], v[200:203], v[76:79], v[24:39]
    ds_read_b64_tr_b16 v[100:101], v219 offset:6144
    ds_read_b64_tr_b16 v[102:103], v219 offset:7168
    s_waitcnt lgkmcnt(8)
    v_mfma_f32_32x32x16_bf16 v[8:23], v[204:207], v[80:83], v[8:23]
    s_waitcnt vmcnt(23)
    ds_read_b64_tr_b16 v[72:73], v218 offset:8192
    ds_read_b64_tr_b16 v[74:75], v218 offset:9216
    buffer_load_dwordx4 v[140:143], v240, s[36:39], s94 offen offset:1024 sc1
    v_mfma_f32_32x32x16_bf16 v[24:39], v[204:207], v[84:87], v[24:39]
    ds_read_b64_tr_b16 v[76:77], v219 offset:8192
    ds_read_b64_tr_b16 v[78:79], v219 offset:9216
    s_waitcnt lgkmcnt(8)
    v_mfma_f32_32x32x16_bf16 v[8:23], v[208:211], v[88:91], v[8:23]
    s_waitcnt vmcnt(22)
    ds_read_b64_tr_b16 v[80:81], v218 offset:10240
    ds_read_b64_tr_b16 v[82:83], v218 offset:11264
    buffer_load_dwordx4 v[144:147], v240, s[36:39], s94 offen offset:2048 sc1
    v_mfma_f32_32x32x16_bf16 v[24:39], v[208:211], v[92:95], v[24:39]
    ds_read_b64_tr_b16 v[84:85], v219 offset:10240
    ds_read_b64_tr_b16 v[86:87], v219 offset:11264
    s_waitcnt lgkmcnt(8)
    v_mfma_f32_32x32x16_bf16 v[8:23], v[212:215], v[96:99], v[8:23]
    s_waitcnt vmcnt(20)
    ds_read_b64_tr_b16 v[88:89], v218 offset:12288
    ds_read_b64_tr_b16 v[90:91], v218 offset:13312
    buffer_load_dwordx4 v[148:151], v240, s[36:39], s94 offen offset:3072 sc1
    v_mfma_f32_32x32x16_bf16 v[24:39], v[212:215], v[100:103], v[24:39]
    ds_read_b64_tr_b16 v[92:93], v219 offset:12288
    ds_read_b64_tr_b16 v[94:95], v219 offset:13312
    s_waitcnt vmcnt(13)
    v_max_u32 v251, v107, v111
    v_max3_u32 v251, v251, v115, v119
    v_cmp_eq_u32 vcc, -1, v251
    s_nop 0
    s_cbranch_vccnz CK_47_r
CK_47_k:
    s_waitcnt lgkmcnt(8)
    v_mfma_f32_32x32x16_bf16 v[8:23], v[104:107], v[72:75], v[8:23]
    s_waitcnt vmcnt(18)
    s_nop 0
    ds_read_b64_tr_b16 v[96:97], v218 offset:14336
    ds_read_b64_tr_b16 v[98:99], v218 offset:15360
    buffer_load_dwordx4 v[152:155], v241, s[36:39], s94 offen offset:0 sc1
    v_mfma_f32_32x32x16_bf16 v[24:39], v[104:107], v[76:79], v[24:39]
    ds_read_b64_tr_b16 v[100:101], v219 offset:14336
    ds_read_b64_tr_b16 v[102:103], v219 offset:15360
    s_waitcnt lgkmcnt(8)
    v_mfma_f32_32x32x16_bf16 v[8:23], v[108:111], v[80:83], v[8:23]
    s_waitcnt vmcnt(16)
    ds_read_b64_tr_b16 v[72:73], v218 offset:32768
    ds_read_b64_tr_b16 v[74:75], v218 offset:33792
    buffer_load_dwordx4 v[156:159], v241, s[36:39], s94 offen offset:1024 sc1
    v_mfma_f32_32x32x16_bf16 v[24:39], v[108:111], v[84:87], v[24:39]
    ds_read_b64_tr_b16 v[76:77], v219 offset:32768
    ds_read_b64_tr_b16 v[78:79], v219 offset:33792
    s_waitcnt lgkmcnt(8)
    v_mfma_f32_32x32x16_bf16 v[8:23], v[112:115], v[88:91], v[8:23]
    s_waitcnt vmcnt(14)
    ds_read_b64_tr_b16 v[80:81], v218 offset:34816
    ds_read_b64_tr_b16 v[82:83], v218 offset:35840
    buffer_load_dwordx4 v[160:163], v241, s[36:39], s94 offen offset:2048 sc1
    v_mfma_f32_32x32x16_bf16 v[24:39], v[112:115], v[92:95], v[24:39]
    ds_read_b64_tr_b16 v[84:85], v219 offset:34816
    ds_read_b64_tr_b16 v[86:87], v219 offset:35840
    s_waitcnt lgkmcnt(8)
    v_mfma_f32_32x32x16_bf16 v[8:23], v[116:119], v[96:99], v[8:23]
    s_waitcnt vmcnt(12)
    ds_read_b64_tr_b16 v[88:89], v218 offset:36864
    ds_read_b64_tr_b16 v[90:91], v218 offset:37888
    buffer_load_dwordx4 v[164:167], v241, s[36:39], s94 offen offset:3072 sc1
    v_mfma_f32_32x32x16_bf16 v[24:39], v[116:119], v[100:103], v[24:39]
    ds_read_b64_tr_b16 v[92:93], v219 offset:36864
    ds_read_b64_tr_b16 v[94:95], v219 offset:37888
    s_waitcnt vmcnt(8)
    v_max_u32 v251, v123, v127
    v_max3_u32 v251, v251, v131, v135
    v_cmp_eq_u32 vcc, -1, v251
    s_nop 0
    s_cbranch_vccnz CK_48_r
CK_48_k:
    s_waitcnt lgkmcnt(8)
    v_mfma_f32_32x32x16_bf16 v[8:23], v[120:123], v[72:75], v[8:23]
    s_waitcnt vmcnt(10)
    s_nop 0
    ds_read_b64_tr_b16 v[96:97], v218 offset:38912
    ds_read_b64_tr_b16 v[98:99], v218 offset:39936
    buffer_load_dwordx4 v[168:171], v240, s[36:39], s95 offen offset:0 sc1
    v_mfma_f32_32x32x16_bf16 v[24:39], v[120:123], v[76:79], v[24:39]
    ds_read_b64_tr_b16 v[100:101], v219 offset:38912
    ds_read_b64_tr_b16 v[102:103], v219 offset:39936
    s_waitcnt lgkmcnt(8)
    s_nop 0
    v_mfma_f32_32x32x16_bf16 v[8:23], v[124:127], v[80:83], v[8:23]
    ds_read_b64_tr_b16 v[72:73], v218 offset:0
    ds_read_b64_tr_b16 v[74:75], v218 offset:1024
    buffer_load_dwordx4 v[172:175], v240, s[36:39], s95 offen offset:1024 sc1
    v_mfma_f32_32x32x16_bf16 v[24:39], v[124:127], v[84:87], v[24:39]
    ds_read_b64_tr_b16 v[76:77], v219 offset:0
    ds_read_b64_tr_b16 v[78:79], v219 offset:1024
    s_waitcnt lgkmcnt(8)
    s_nop 0
    v_mfma_f32_32x32x16_bf16 v[8:23], v[128:131], v[88:91], v[8:23]
    ds_read_b64_tr_b16 v[80:81], v218 offset:2048
    ds_read_b64_tr_b16 v[82:83], v218 offset:3072
    buffer_load_dwordx4 v[176:179], v240, s[36:39], s95 offen offset:2048 sc1
    v_mfma_f32_32x32x16_bf16 v[24:39], v[128:131], v[92:95], v[24:39]
    ds_read_b64_tr_b16 v[84:85], v219 offset:2048
    ds_read_b64_tr_b16 v[86:87], v219 offset:3072
    s_waitcnt lgkmcnt(8)
    s_nop 0
    v_mfma_f32_32x32x16_bf16 v[8:23], v[132:135], v[96:99], v[8:23]
    ds_read_b64_tr_b16 v[88:89], v218 offset:4096
    ds_read_b64_tr_b16 v[90:91], v218 offset:5120
    buffer_load_dwordx4 v[180:183], v240, s[36:39], s95 offen offset:3072 sc1
    v_mfma_f32_32x32x16_bf16 v[24:39], v[132:135], v[100:103], v[24:39]
    ds_read_b64_tr_b16 v[92:93], v219 offset:4096
    ds_read_b64_tr_b16 v[94:95], v219 offset:5120
    s_waitcnt vmcnt(8)
    v_max_u32 v251, v139, v143
    v_max3_u32 v251, v251, v147, v151
    v_cmp_eq_u32 vcc, -1, v251
    s_nop 0
    s_cbranch_vccnz CK_49_r
CK_49_k:
    s_waitcnt lgkmcnt(8)
    v_mfma_f32_32x32x16_bf16 v[40:55], v[136:139], v[72:75], 0
    ds_read_b64_tr_b16 v[96:97], v218 offset:6144
    ds_read_b64_tr_b16 v[98:99], v218 offset:7168
    buffer_load_dwordx4 v[184:187], v240, s[36:39], s92 offen offset:0 sc1
    v_mfma_f32_32x32x16_bf16 v[56:71], v[136:139], v[76:79], 0
    ds_read_b64_tr_b16 v[100:101], v219 offset:6144
    ds_read_b64_tr_b16 v[102:103], v219 offset:7168
    s_waitcnt lgkmcnt(8)
    s_nop 0
    v_mfma_f32_32x32x16_bf16 v[40:55], v[140:143], v[80:83], v[40:55]
    ds_read_b64_tr_b16 v[72:73], v218 offset:8192
    ds_read_b64_tr_b16 v[74:75], v218 offset:9216
    buffer_load_dwordx4 v[188:191], v240, s[36:39], s92 offen offset:1024 sc1
    v_mfma_f32_32x32x16_bf16 v[56:71], v[140:143], v[84:87], v[56:71]
    ds_read_b64_tr_b16 v[76:77], v219 offset:8192
    ds_read_b64_tr_b16 v[78:79], v219 offset:9216
    s_waitcnt lgkmcnt(8)
    s_nop 0
    v_mfma_f32_32x32x16_bf16 v[40:55], v[144:147], v[88:91], v[40:55]
    ds_read_b64_tr_b16 v[80:81], v218 offset:10240
    ds_read_b64_tr_b16 v[82:83], v218 offset:11264
    buffer_load_dwordx4 v[192:195], v240, s[36:39], s92 offen offset:2048 sc1
    v_mfma_f32_32x32x16_bf16 v[56:71], v[144:147], v[92:95], v[56:71]
    ds_read_b64_tr_b16 v[84:85], v219 offset:10240
    ds_read_b64_tr_b16 v[86:87], v219 offset:11264
    s_waitcnt lgkmcnt(8)
    s_nop 0
    v_mfma_f32_32x32x16_bf16 v[40:55], v[148:151], v[96:99], v[40:55]
    ds_read_b64_tr_b16 v[88:89], v218 offset:12288
    ds_read_b64_tr_b16 v[90:91], v218 offset:13312
    buffer_load_dwordx4 v[196:199], v240, s[36:39], s92 offen offset:3072 sc1
    v_mfma_f32_32x32x16_bf16 v[56:71], v[148:151], v[100:103], v[56:71]
    ds_read_b64_tr_b16 v[92:93], v219 offset:12288
    ds_read_b64_tr_b16 v[94:95], v219 offset:13312
    s_waitcnt vmcnt(8)
    v_max_u32 v251, v155, v159
    v_max3_u32 v251, v251, v163, v167
    v_cmp_eq_u32 vcc, -1, v251
    s_nop 0
    s_cbranch_vccnz CK_50_r
CK_50_k:
    s_waitcnt lgkmcnt(8)
    v_mfma_f32_32x32x16_bf16 v[40:55], v[152:155], v[72:75], v[40:55]
    ds_read_b64_tr_b16 v[96:97], v218 offset:14336
    ds_read_b64_tr_b16 v[98:99], v218 offset:15360
    buffer_load_dwordx4 v[200:203], v241, s[36:39], s92 offen offset:0 sc1
    v_mfma_f32_32x32x16_bf16 v[56:71], v[152:155], v[76:79], v[56:71]
    ds_read_b64_tr_b16 v[100:101], v219 offset:14336
    ds_read_b64_tr_b16 v[102:103], v219 offset:15360
    s_waitcnt lgkmcnt(0)
    s_nop 0
    ds_write_b128 v0, v[8:11] offset:40960
    ds_write_b128 v0, v[12:15] offset:41984
    ds_write_b128 v0, v[16:19] offset:43008
    ds_write_b128 v0, v[20:23] offset:44032
    ds_write_b128 v0, v[24:27] offset:45056
    ds_write_b128 v0, v[28:31] offset:46080
    ds_write_b128 v0, v[32:35] offset:47104
    ds_write_b128 v0, v[36:39] offset:48128
    s_waitcnt lgkmcnt(8)
    s_nop 0
    v_mfma_f32_32x32x16_bf16 v[40:55], v[156:159], v[80:83], v[40:55]
    ds_read_b64_tr_b16 v[72:73], v218 offset:32768
    ds_read_b64_tr_b16 v[74:75], v218 offset:33792
    buffer_load_dwordx4 v[204:207], v241, s[36:39], s92 offen offset:1024 sc1
    v_mfma_f32_32x32x16_bf16 v[56:71], v[156:159], v[84:87], v[56:71]
    ds_read_b64_tr_b16 v[76:77], v219 offset:32768
    ds_read_b64_tr_b16 v[78:79], v219 offset:33792
    s_waitcnt lgkmcnt(8)
    s_nop 0
    v_mfma_f32_32x32x16_bf16 v[40:55], v[160:163], v[88:91], v[40:55]
    ds_read_b64_tr_b16 v[80:81], v218 offset:34816
    ds_read_b64_tr_b16 v[82:83], v218 offset:35840
    buffer_load_dwordx4 v[208:211], v241, s[36:39], s92 offen offset:2048 sc1
    v_mfma_f32_32x32x16_bf16 v[56:71], v[160:163], v[92:95], v[56:71]
    ds_read_b64_tr_b16 v[84:85], v219 offset:34816
    ds_read_b64_tr_b16 v[86:87], v219 offset:35840
    s_waitcnt lgkmcnt(8)
    s_nop 0
    v_mfma_f32_32x32x16_bf16 v[40:55], v[164:167], v[96:99], v[40:55]
    ds_read_b64_tr_b16 v[88:89], v218 offset:36864
    ds_read_b64_tr_b16 v[90:91], v218 offset:37888
    buffer_load_dwordx4 v[212:215], v241, s[36:39], s92 offen offset:3072 sc1
    v_mfma_f32_32x32x16_bf16 v[56:71], v[164:167], v[100:103], v[56:71]
    ds_read_b64_tr_b16 v[92:93], v219 offset:36864
    ds_read_b64_tr_b16 v[94:95], v219 offset:37888
    s_waitcnt lgkmcnt(0)
    s_barrier
    s_cmp_eq_u32 s53, 0
    s_cbranch_scc1 OE_51
OE_51_r:
    s_waitcnt vmcnt(8)
    v_max_u32 v251, v171, v175
    v_max3_u32 v251, v251, v179, v183
    v_cmp_eq_u32 vcc, -1, v251
    s_nop 0
    s_cbranch_vccnz CK_53_r
CK_53_k:
    s_waitcnt lgkmcnt(8)
    v_mfma_f32_32x32x16_bf16 v[40:55], v[168:171], v[72:75], v[40:55]
    ds_read_b64_tr_b16 v[96:97], v218 offset:38912
    ds_read_b64_tr_b16 v[98:99], v218 offset:39936
    buffer_load_dwordx4 v[104:107], v240, s[36:39], s93 offen offset:0 sc1
    v_mfma_f32_32x32x16_bf16 v[56:71], v[168:171], v[76:79], v[56:71]
    ds_read_b64_tr_b16 v[100:101], v219 offset:38912
    ds_read_b64_tr_b16 v[102:103], v219 offset:39936
    s_waitcnt lgkmcnt(8)
    v_mfma_f32_32x32x16_bf16 v[40:55], v[172:175], v[80:83], v[40:55]
    buffer_load_dwordx4 v[108:111], v240, s[36:39], s93 offen offset:1024 sc1
    v_mfma_f32_32x32x16_bf16 v[56:71], v[172:175], v[84:87], v[56:71]
    s_waitcnt lgkmcnt(4)
    v_mfma_f32_32x32x16_bf16 v[40:55], v[176:179], v[88:91], v[40:55]
    s_add_u32 m0, s55, 0
    s_add_u32 s58, s70, 0
    buffer_load_dwordx4 v240, s[36:39], s58 offen sc1 lds
    buffer_load_dwordx4 v[112:115], v240, s[36:39], s93 offen offset:2048 sc1
    v_mfma_f32_32x32x16_bf16 v[56:71], v[176:179], v[92:95], v[56:71]
    s_add_u32 m0, s55, 1024
    s_add_u32 s58, s70, 1024
    buffer_load_dwordx4 v240, s[36:39], s58 offen sc1 lds
    s_waitcnt lgkmcnt(0)
    s_nop 0
    v_mfma_f32_32x32x16_bf16 v[40:55], v[180:183], v[96:99], v[40:55]
    s_add_u32 m0, s55, 2048
    s_add_u32 s58, s70, 2048
    buffer_load_dwordx4 v240, s[36:39], s58 offen sc1 lds
    buffer_load_dwordx4 v[116:119], v240, s[36:39], s93 offen offset:3072 sc1
    v_mfma_f32_32x32x16_bf16 v[56:71], v[180:183], v[100:103], v[56:71]
    s_add_u32 m0, s55, 3072
    s_add_u32 s58, s70, 3072
    buffer_load_dwordx4 v240, s[36:39], s58 offen sc1 lds
    s_waitcnt vmcnt(12)
    v_max_u32 v251, v187, v191
    v_max3_u32 v251, v251, v195, v199
    v_cmp_eq_u32 vcc, -1, v251
    s_nop 0
    s_cbranch_vccnz CK_54_r
CK_54_k:
    s_nop 0
    v_mfma_f32_32x32x16_bf16 v[40:55], v[184:187], a[128:131], v[40:55]
    s_add_u32 m0, s55, 4096
    s_add_u32 s58, s70, 4096
    buffer_load_dwordx4 v240, s[36:39], s58 offen sc1 lds
    buffer_load_dwordx4 v[120:123], v241, s[36:39], s93 offen offset:0 sc1
    v_mfma_f32_32x32x16_bf16 v[56:71], v[184:187], a[132:135], v[56:71]
    s_add_u32 m0, s55, 5120
    s_add_u32 s58, s70, 5120
    buffer_load_dwordx4 v240, s[36:39], s58 offen sc1 lds
    v_mfma_f32_32x32x16_bf16 v[40:55], v[188:191], a[136:139], v[40:55]
    s_add_u32 m0, s55, 6144
    s_add_u32 s58, s70, 6144
    buffer_load_dwordx4 v240, s[36:39], s58 offen sc1 lds
    buffer_load_dwordx4 v[124:127], v241, s[36:39], s93 offen offset:1024 sc1
    v_mfma_f32_32x32x16_bf16 v[56:71], v[188:191], a[140:143], v[56:71]
    s_add_u32 m0, s55, 7168
    s_add_u32 s58, s70, 7168
    buffer_load_dwordx4 v240, s[36:39], s58 offen sc1 lds
    v_mfma_f32_32x32x16_bf16 v[40:55], v[192:195], a[144:147], v[40:55]
    s_add_u32 m0, s55, 8192
    s_add_u32 s58, s70, 8192
    buffer_load_dwordx4 v240, s[36:39], s58 offen sc1 lds
    buffer_load_dwordx4 v[128:131], v241, s[36:39], s93 offen offset:2048 sc1
    v_mfma_f32_32x32x16_bf16 v[56:71], v[192:195], a[148:151], v[56:71]
    s_add_u32 m0, s55, 9216
    s_add_u32 s58, s70, 9216
    buffer_load_dwordx4 v240, s[36:39], s58 offen sc1 lds
    v_mfma_f32_32x32x16_bf16 v[40:55], v[196:199], a[152:155], v[40:55]
    s_add_u32 m0, s55, 10240
    s_add_u32 s58, s70, 10240
    buffer_load_dwordx4 v240, s[36:39], s58 offen sc1 lds
    buffer_load_dwordx4 v[132:135], v241, s[36:39], s93 offen offset:3072 sc1
    v_mfma_f32_32x32x16_bf16 v[56:71], v[196:199], a[156:159], v[56:71]
    s_add_u32 m0, s55, 11264
    s_add_u32 s58, s70, 11264
    buffer_load_dwordx4 v240, s[36:39], s58 offen sc1 lds
    s_waitcnt vmcnt(20)
    v_max_u32 v251, v203, v207
    v_max3_u32 v251, v251, v211, v215
    v_cmp_eq_u32 vcc, -1, v251
    s_nop 0
    s_cbranch_vccnz CK_55_r
CK_55_k:
    s_nop 0
    v_mfma_f32_32x32x16_bf16 v[40:55], v[200:203], a[160:163], v[40:55]
    s_add_u32 m0, s55, 12288
    s_add_u32 s58, s70, 12288
    buffer_load_dwordx4 v240, s[36:39], s58 offen sc1 lds
    v_mfma_f32_32x32x16_bf16 v[56:71], v[200:203], a[164:167], v[56:71]
    s_add_u32 m0, s55, 13312
    s_add_u32 s58, s70, 13312
    buffer_load_dwordx4 v240, s[36:39], s58 offen sc1 lds
    v_mfma_f32_32x32x16_bf16 v[40:55], v[204:207], a[168:171], v[40:55]
    s_add_u32 m0, s55, 14336
    s_add_u32 s58, s70, 14336
    buffer_load_dwordx4 v240, s[36:39], s58 offen sc1 lds
    v_mfma_f32_32x32x16_bf16 v[56:71], v[204:207], a[172:175], v[56:71]
    s_add_u32 m0, s55, 15360
    s_add_u32 s58, s70, 15360
    buffer_load_dwordx4 v240, s[36:39], s58 offen sc1 lds
    v_mfma_f32_32x32x16_bf16 v[40:55], v[208:211], a[176:179], v[40:55]
    s_add_u32 m0, s71, 131072
    s_add_u32 s58, s69, 65536
    buffer_load_dwordx4 v240, s[36:39], s58 offen sc1 lds
    v_mfma_f32_32x32x16_bf16 v[56:71], v[208:211], a[180:183], v[56:71]
    s_add_u32 m0, s71, 135168
    s_add_u32 s58, s69, 69632
    buffer_load_dwordx4 v240, s[36:39], s58 offen sc1 lds
    v_mfma_f32_32x32x16_bf16 v[40:55], v[212:215], a[184:187], v[40:55]
    s_add_u32 m0, s71, 139264
    s_add_u32 s58, s69, 73728
    buffer_load_dwordx4 v240, s[36:39], s58 offen sc1 lds
    v_mfma_f32_32x32x16_bf16 v[56:71], v[212:215], a[188:191], v[56:71]
    s_add_u32 m0, s71, 143360
    s_add_u32 s58, s69, 77824
    buffer_load_dwordx4 v240, s[36:39], s58 offen sc1 lds
    s_waitcnt vmcnt(21)
    v_max_u32 v251, v107, v111
    v_max3_u32 v251, v251, v115, v119
    v_cmp_eq_u32 vcc, -1, v251
    s_nop 0
    s_cbranch_vccnz CK_56_r
CK_56_k:
    s_nop 0
    v_mfma_f32_32x32x16_bf16 v[40:55], v[104:107], a[192:195], v[40:55]
    s_add_u32 m0, s71, 147456
    s_add_u32 s58, s69, 81920
    buffer_load_dwordx4 v240, s[36:39], s58 offen sc1 lds
    v_mfma_f32_32x32x16_bf16 v[56:71], v[104:107], a[196:199], v[56:71]
    v_mfma_f32_32x32x16_bf16 v[40:55], v[108:111], a[200:203], v[40:55]
    v_mfma_f32_32x32x16_bf16 v[56:71], v[108:111], a[204:207], v[56:71]
    v_mfma_f32_32x32x16_bf16 v[40:55], v[112:115], a[208:211], v[40:55]
    buffer_load_dwordx4 v[72:75], v240, s[36:39], s80 offen offset:0 sc1
    v_mfma_f32_32x32x16_bf16 v[56:71], v[112:115], a[212:215], v[56:71]
    buffer_load_dwordx4 v[76:79], v240, s[36:39], s80 offen offset:1024 sc1
    v_mfma_f32_32x32x16_bf16 v[40:55], v[116:119], a[216:219], v[40:55]
    buffer_load_dwordx4 v[80:83], v241, s[36:39], s80 offen offset:0 sc1
    v_mfma_f32_32x32x16_bf16 v[56:71], v[116:119], a[220:223], v[56:71]
    buffer_load_dwordx4 v[84:87], v241, s[36:39], s80 offen offset:1024 sc1
    s_waitcnt vmcnt(14)
    v_max_u32 v251, v123, v127
    v_max3_u32 v251, v251, v131, v135
    v_cmp_eq_u32 vcc, -1, v251
    s_nop 0
    s_cbranch_vccnz CK_57_r
CK_57_k:
    s_nop 0
    v_mfma_f32_32x32x16_bf16 v[40:55], v[120:123], a[224:227], v[40:55]
    buffer_load_dwordx4 v[88:91], v240, s[36:39], s81 offen offset:0 sc1
    v_mfma_f32_32x32x16_bf16 v[56:71], v[120:123], a[228:231], v[56:71]
    buffer_load_dwordx4 v[92:95], v240, s[36:39], s81 offen offset:1024 sc1
    v_mfma_f32_32x32x16_bf16 v[40:55], v[124:127], a[232:235], v[40:55]
    buffer_load_dwordx4 v[96:99], v241, s[36:39], s81 offen offset:0 sc1
    v_mfma_f32_32x32x16_bf16 v[56:71], v[124:127], a[236:239], v[56:71]
    buffer_load_dwordx4 v[100:103], v241, s[36:39], s81 offen offset:1024 sc1
    v_mfma_f32_32x32x16_bf16 v[40:55], v[128:131], a[240:243], v[40:55]
    v_mfma_f32_32x32x16_bf16 v[56:71], v[128:131], a[244:247], v[56:71]
    v_mfma_f32_32x32x16_bf16 v[40:55], v[132:135], a[248:251], v[40:55]
    v_mfma_f32_32x32x16_bf16 v[56:71], v[132:135], a[252:255], v[56:71]
    s_nop 10
    s_nop 0
    ds_write_b128 v0, v[40:43] offset:32768
    ds_write_b128 v0, v[44:47] offset:33792
    ds_write_b128 v0, v[48:51] offset:34816
    ds_write_b128 v0, v[52:55] offset:35840
    ds_write_b128 v0, v[56:59] offset:36864
    ds_write_b128 v0, v[60:63] offset:37888
    ds_write_b128 v0, v[64:67] offset:38912
    ds_write_b128 v0, v[68:71] offset:39936
    s_waitcnt vmcnt(8) lgkmcnt(0)
    s_barrier
    s_cmp_eq_u32 s53, 1
    s_cbranch_scc1 OE_58
OE_58_r:
    buffer_load_dwordx4 v[104:107], v240, s[36:39], s82 offen offset:0 sc1
    buffer_load_dwordx4 v[108:111], v240, s[36:39], s82 offen offset:1024 sc1
    buffer_load_dwordx4 v[112:115], v241, s[36:39], s82 offen offset:0 sc1
    buffer_load_dwordx4 v[116:119], v241, s[36:39], s82 offen offset:1024 sc1
    buffer_load_dwordx4 v[120:123], v240, s[36:39], s83 offen offset:0 sc1
    buffer_load_dwordx4 v[124:127], v240, s[36:39], s83 offen offset:1024 sc1
    v_pk_add_f32 v[128:129], v[224:225], v[226:227]
    v_pk_add_f32 v[130:131], v[228:229], v[230:231]
    v_pk_add_f32 v[132:133], v[232:233], v[234:235]
    v_pk_add_f32 v[134:135], v[236:237], v[238:239]
    v_pk_add_f32 v[128:129], v[128:129], v[130:131]
    v_pk_add_f32 v[132:133], v[132:133], v[134:135]
    v_pk_add_f32 v[128:129], v[128:129], v[132:133]
    v_add_f32 v144, v128, v129
    v_mov_b32 v145, v144
    s_nop 1
    v_permlane32_swap_b32 v144, v145
    v_add_f32_e64 v144, v144, v145
    v_mul_f32 v146, 0xbd000000, v144
    v_pk_add_f32 v[128:129], v[224:225], v[146:147] op_sel_hi:[1,0]
    v_pk_add_f32 v[130:131], v[226:227], v[146:147] op_sel_hi:[1,0]
    v_pk_add_f32 v[132:133], v[228:229], v[146:147] op_sel_hi:[1,0]
    v_pk_add_f32 v[134:135], v[230:231], v[146:147] op_sel_hi:[1,0]
    v_pk_add_f32 v[136:137], v[232:233], v[146:147] op_sel_hi:[1,0]
    v_pk_add_f32 v[138:139], v[234:235], v[146:147] op_sel_hi:[1,0]
    v_pk_add_f32 v[140:141], v[236:237], v[146:147] op_sel_hi:[1,0]
    v_pk_add_f32 v[142:143], v[238:239], v[146:147] op_sel_hi:[1,0]
    v_pk_mul_f32 v[146:147], v[128:129], v[128:129]
    v_pk_mul_f32 v[148:149], v[130:131], v[130:131]
    v_pk_fma_f32 v[146:147], v[132:133], v[132:133], v[146:147]
    v_pk_fma_f32 v[148:149], v[134:135], v[134:135], v[148:149]
    v_pk_fma_f32 v[146:147], v[136:137], v[136:137], v[146:147]
    v_pk_fma_f32 v[148:149], v[138:139], v[138:139], v[148:149]
    v_pk_fma_f32 v[146:147], v[140:141], v[140:141], v[146:147]
    v_pk_fma_f32 v[148:149], v[142:143], v[142:143], v[148:149]
    v_pk_add_f32 v[146:147], v[146:147], v[148:149]
    v_add_f32 v145, v146, v147
    v_mov_b32 v146, v145
    s_nop 1
    v_permlane32_swap_b32 v145, v146
    v_add_f32 v145, v145, v146
    s_mov_b32 exec_hi, 0
    s_cmp_eq_u32 s100, 0
    s_cbranch_scc1 LS_60_g
    buffer_store_dwordx2 v[144:145], v245, s[36:39], s65 offen
LS_60_r:
    s_mov_b64 exec, -1
    s_branch B_22_end
    s_branch B_22_j
B_22_i1:
    s_waitcnt vmcnt(17)
    v_max_u32_e64 v251, v123, v127
    v_max3_u32 v251, v251, v131, v135
    v_cmp_eq_u32 vcc, -1, v251
    s_nop 0
    s_cbranch_vccnz CK_61_r
CK_61_k:
    s_waitcnt lgkmcnt(8)
    v_mfma_f32_32x32x16_bf16 v[40:55], v[72:75], v[120:123], v[40:55]
    ds_read_b64_tr_b16 v[96:97], v6 offset:6144
    ds_read_b64_tr_b16 v[98:99], v6 offset:6656
    v_mfma_f32_32x32x16_bf16 v[56:71], v[76:79], v[120:123], 0
    ds_read_b64_tr_b16 v[100:101], v7 offset:6144
    ds_read_b64_tr_b16 v[102:103], v7 offset:6656
    s_waitcnt lgkmcnt(8)
    s_nop 0
    v_mfma_f32_32x32x16_bf16 v[40:55], v[80:83], v[124:127], v[40:55]
    ds_read_b64_tr_b16 v[72:73], v6 offset:8192
    ds_read_b64_tr_b16 v[74:75], v6 offset:8704
    v_mfma_f32_32x32x16_bf16 v[56:71], v[84:87], v[124:127], v[56:71]
    ds_read_b64_tr_b16 v[76:77], v7 offset:8192
    ds_read_b64_tr_b16 v[78:79], v7 offset:8704
    s_waitcnt lgkmcnt(8)
    s_nop 0
    v_mfma_f32_32x32x16_bf16 v[40:55], v[88:91], v[128:131], v[40:55]
    ds_read_b64_tr_b16 v[80:81], v6 offset:10240
    ds_read_b64_tr_b16 v[82:83], v6 offset:10752
    v_mfma_f32_32x32x16_bf16 v[56:71], v[92:95], v[128:131], v[56:71]
    ds_read_b64_tr_b16 v[84:85], v7 offset:10240
    ds_read_b64_tr_b16 v[86:87], v7 offset:10752
    s_waitcnt lgkmcnt(8)
    s_nop 0
    v_mfma_f32_32x32x16_bf16 v[40:55], v[96:99], v[132:135], v[40:55]
    ds_read_b64_tr_b16 v[88:89], v6 offset:12288
    ds_read_b64_tr_b16 v[90:91], v6 offset:12800
    v_mfma_f32_32x32x16_bf16 v[56:71], v[100:103], v[132:135], v[56:71]
    ds_read_b64_tr_b16 v[92:93], v7 offset:12288
    ds_read_b64_tr_b16 v[94:95], v7 offset:12800
    s_waitcnt vmcnt(13)
    v_max_u32 v251, v139, v143
    v_max3_u32 v251, v251, v147, v151
    v_cmp_eq_u32 vcc, -1, v251
    s_nop 0
    s_cbranch_vccnz CK_62_r
CK_62_k:
    s_waitcnt lgkmcnt(8)
    v_mfma_f32_32x32x16_bf16 v[40:55], v[72:75], v[136:139], v[40:55]
    ds_read_b64_tr_b16 v[96:97], v6 offset:14336
    ds_read_b64_tr_b16 v[98:99], v6 offset:14848
    v_mfma_f32_32x32x16_bf16 v[56:71], v[76:79], v[136:139], v[56:71]
    ds_read_b64_tr_b16 v[100:101], v7 offset:14336
    ds_read_b64_tr_b16 v[102:103], v7 offset:14848
    s_waitcnt lgkmcnt(8)
    s_nop 0
    v_mfma_f32_32x32x16_bf16 v[40:55], v[80:83], v[140:143], v[40:55]
    ds_read_b64_tr_b16 v[72:73], v6 offset:32768
    ds_read_b64_tr_b16 v[74:75], v6 offset:33280
    v_mfma_f32_32x32x16_bf16 v[56:71], v[84:87], v[140:143], v[56:71]
    ds_read_b64_tr_b16 v[76:77], v7 offset:32768
    ds_read_b64_tr_b16 v[78:79], v7 offset:33280
    s_waitcnt lgkmcnt(8)
    s_nop 0
    v_mfma_f32_32x32x16_bf16 v[40:55], v[88:91], v[144:147], v[40:55]
    ds_read_b64_tr_b16 v[80:81], v6 offset:34816
    ds_read_b64_tr_b16 v[82:83], v6 offset:35328
    v_mfma_f32_32x32x16_bf16 v[56:71], v[92:95], v[144:147], v[56:71]
    ds_read_b64_tr_b16 v[84:85], v7 offset:34816
    ds_read_b64_tr_b16 v[86:87], v7 offset:35328
    s_waitcnt lgkmcnt(8)
    s_nop 0
    v_mfma_f32_32x32x16_bf16 v[40:55], v[96:99], v[148:151], v[40:55]
    ds_read_b64_tr_b16 v[88:89], v6 offset:36864
    ds_read_b64_tr_b16 v[90:91], v6 offset:37376
    v_mfma_f32_32x32x16_bf16 v[56:71], v[100:103], v[148:151], v[56:71]
    ds_read_b64_tr_b16 v[92:93], v7 offset:36864
    ds_read_b64_tr_b16 v[94:95], v7 offset:37376
    s_waitcnt vmcnt(9)
    v_max_u32 v251, v155, v159
    v_max3_u32 v251, v251, v163, v167
    v_cmp_eq_u32 vcc, -1, v251
    s_nop 0
    s_cbranch_vccnz CK_63_r
CK_63_k:
    s_waitcnt lgkmcnt(8)
    v_mfma_f32_32x32x16_bf16 v[40:55], v[72:75], v[152:155], v[40:55]
    ds_read_b64_tr_b16 v[96:97], v6 offset:38912
    ds_read_b64_tr_b16 v[98:99], v6 offset:39424
    buffer_load_dwordx4 v[200:203], v241, s[36:39], s86 offen offset:0 sc1
    v_mfma_f32_32x32x16_bf16 v[56:71], v[76:79], v[152:155], v[56:71]
    ds_read_b64_tr_b16 v[100:101], v7 offset:38912
    ds_read_b64_tr_b16 v[102:103], v7 offset:39424
    s_waitcnt lgkmcnt(8)
    s_nop 0
    v_mfma_f32_32x32x16_bf16 v[40:55], v[80:83], v[156:159], v[40:55]
    ds_read_b64_tr_b16 v[72:73], v6 offset:40960
    ds_read_b64_tr_b16 v[74:75], v6 offset:41472
    buffer_load_dwordx4 v[204:207], v241, s[36:39], s86 offen offset:1024 sc1
    v_mfma_f32_32x32x16_bf16 v[56:71], v[84:87], v[156:159], v[56:71]
    ds_read_b64_tr_b16 v[76:77], v7 offset:40960
    ds_read_b64_tr_b16 v[78:79], v7 offset:41472
    s_waitcnt lgkmcnt(8)
    s_nop 0
    v_mfma_f32_32x32x16_bf16 v[40:55], v[88:91], v[160:163], v[40:55]
    ds_read_b64_tr_b16 v[80:81], v6 offset:43008
    ds_read_b64_tr_b16 v[82:83], v6 offset:43520
    buffer_load_dwordx4 v[208:211], v241, s[36:39], s86 offen offset:2048 sc1
    v_mfma_f32_32x32x16_bf16 v[56:71], v[92:95], v[160:163], v[56:71]
    ds_read_b64_tr_b16 v[84:85], v7 offset:43008
    ds_read_b64_tr_b16 v[86:87], v7 offset:43520
    s_waitcnt lgkmcnt(8)
    s_nop 0
    v_mfma_f32_32x32x16_bf16 v[40:55], v[96:99], v[164:167], v[40:55]
    ds_read_b64_tr_b16 v[88:89], v6 offset:45056
    ds_read_b64_tr_b16 v[90:91], v6 offset:45568
    buffer_load_dwordx4 v[212:215], v241, s[36:39], s86 offen offset:3072 sc1
    v_mfma_f32_32x32x16_bf16 v[56:71], v[100:103], v[164:167], v[56:71]
    ds_read_b64_tr_b16 v[92:93], v7 offset:45056
    ds_read_b64_tr_b16 v[94:95], v7 offset:45568
    s_waitcnt vmcnt(9)
    v_max_u32 v251, v171, v175
    v_max3_u32 v251, v251, v179, v183
    v_cmp_eq_u32 vcc, -1, v251
    s_nop 0
    s_cbranch_vccnz CK_64_r
CK_64_k:
    s_waitcnt lgkmcnt(8)
    v_mfma_f32_32x32x16_bf16 v[40:55], v[72:75], v[168:171], v[40:55]
    ds_read_b64_tr_b16 v[96:97], v6 offset:47104
    ds_read_b64_tr_b16 v[98:99], v6 offset:47616
    buffer_load_dwordx4 v[104:107], v240, s[36:39], s87 offen offset:0 sc1
    v_mfma_f32_32x32x16_bf16 v[56:71], v[76:79], v[168:171], v[56:71]
    ds_read_b64_tr_b16 v[100:101], v7 offset:47104
    ds_read_b64_tr_b16 v[102:103], v7 offset:47616
    s_waitcnt lgkmcnt(8)
    v_mfma_f32_32x32x16_bf16 v[40:55], v[80:83], v[172:175], v[40:55]
    buffer_load_dwordx4 v[108:111], v240, s[36:39], s87 offen offset:1024 sc1
    v_mfma_f32_32x32x16_bf16 v[56:71], v[84:87], v[172:175], v[56:71]
    s_waitcnt lgkmcnt(4)
    v_mfma_f32_32x32x16_bf16 v[40:55], v[88:91], v[176:179], v[40:55]
    buffer_load_dwordx4 v[112:115], v240, s[36:39], s87 offen offset:2048 sc1
    v_mfma_f32_32x32x16_bf16 v[56:71], v[92:95], v[176:179], v[56:71]
    s_waitcnt lgkmcnt(0)
    v_mfma_f32_32x32x16_bf16 v[40:55], v[96:99], v[180:183], v[40:55]
    buffer_load_dwordx4 v[116:119], v240, s[36:39], s87 offen offset:3072 sc1
    v_mfma_f32_32x32x16_bf16 v[56:71], v[100:103], v[180:183], v[56:71]
    s_barrier
    s_waitcnt vmcnt(9)
    v_max_u32 v251, v187, v191
    v_max3_u32 v251, v251, v195, v199
    v_cmp_eq_u32 vcc, -1, v251
    s_nop 0
    s_cbranch_vccnz CK_65_r
CK_65_k:
    s_nop 0
    v_mfma_f32_32x32x16_bf16 v[40:55], a[0:3], v[184:187], v[40:55]
    buffer_load_dwordx4 v[120:123], v241, s[36:39], s87 offen offset:0 sc1
    v_mfma_f32_32x32x16_bf16 v[56:71], a[4:7], v[184:187], v[56:71]
    v_mfma_f32_32x32x16_bf16 v[40:55], a[8:11], v[188:191], v[40:55]
    buffer_load_dwordx4 v[124:127], v241, s[36:39], s87 offen offset:1024 sc1
    v_mfma_f32_32x32x16_bf16 v[56:71], a[12:15], v[188:191], v[56:71]
    v_mfma_f32_32x32x16_bf16 v[40:55], a[16:19], v[192:195], v[40:55]
    buffer_load_dwordx4 v[128:131], v241, s[36:39], s87 offen offset:2048 sc1
    v_mfma_f32_32x32x16_bf16 v[56:71], a[20:23], v[192:195], v[56:71]
    v_mfma_f32_32x32x16_bf16 v[40:55], a[24:27], v[196:199], v[40:55]
    buffer_load_dwordx4 v[132:135], v241, s[36:39], s87 offen offset:3072 sc1
    v_mfma_f32_32x32x16_bf16 v[56:71], a[28:31], v[196:199], v[56:71]
    s_waitcnt vmcnt(8)
    v_max_u32 v251, v203, v207
    v_max3_u32 v251, v251, v211, v215
    v_cmp_eq_u32 vcc, -1, v251
    s_nop 0
    s_cbranch_vccnz CK_66_r
CK_66_k:
    s_nop 0
    v_mfma_f32_32x32x16_bf16 v[40:55], a[32:35], v[200:203], v[40:55]
    buffer_load_dwordx4 v[136:139], v240, s[36:39], s88 offen offset:0 sc1
    v_mfma_f32_32x32x16_bf16 v[56:71], a[36:39], v[200:203], v[56:71]
    v_mfma_f32_32x32x16_bf16 v[40:55], a[40:43], v[204:207], v[40:55]
    buffer_load_dwordx4 v[140:143], v240, s[36:39], s88 offen offset:1024 sc1
    v_mfma_f32_32x32x16_bf16 v[56:71], a[44:47], v[204:207], v[56:71]
    v_mfma_f32_32x32x16_bf16 v[40:55], a[48:51], v[208:211], v[40:55]
    buffer_load_dwordx4 v[144:147], v240, s[36:39], s88 offen offset:2048 sc1
    v_mfma_f32_32x32x16_bf16 v[56:71], a[52:55], v[208:211], v[56:71]
    v_mfma_f32_32x32x16_bf16 v[40:55], a[56:59], v[212:215], v[40:55]
    buffer_load_dwordx4 v[148:151], v240, s[36:39], s88 offen offset:3072 sc1
    v_mfma_f32_32x32x16_bf16 v[56:71], a[60:63], v[212:215], v[56:71]
    v_min_u32 v253, 0, v244
    v_lshlrev_b32 v253, 6, v253
    buffer_load_dword v252, v253, s[40:43], 0 offen offset:68 sc1
    s_waitcnt vmcnt(9)
    v_max_u32 v251, v107, v111
    v_max3_u32 v251, v251, v115, v119
    v_cmp_eq_u32 vcc, -1, v251
    s_nop 0
    s_cbranch_vccnz CK_67_r
CK_67_k:
    s_nop 0
    v_mfma_f32_32x32x16_bf16 v[40:55], a[64:67], v[104:107], v[40:55]
    buffer_load_dwordx4 v[152:155], v241, s[36:39], s88 offen offset:0 sc1
    v_mfma_f32_32x32x16_bf16 v[56:71], a[68:71], v[104:107], v[56:71]
    v_mfma_f32_32x32x16_bf16 v[40:55], a[72:75], v[108:111], v[40:55]
    buffer_load_dwordx4 v[156:159], v241, s[36:39], s88 offen offset:1024 sc1
    v_mfma_f32_32x32x16_bf16 v[56:71], a[76:79], v[108:111], v[56:71]
    v_mfma_f32_32x32x16_bf16 v[40:55], a[80:83], v[112:115], v[40:55]
    buffer_load_dwordx4 v[160:163], v241, s[36:39], s88 offen offset:2048 sc1
    v_mfma_f32_32x32x16_bf16 v[56:71], a[84:87], v[112:115], v[56:71]
    v_mfma_f32_32x32x16_bf16 v[40:55], a[88:91], v[116:119], v[40:55]
    buffer_load_dwordx4 v[164:167], v241, s[36:39], s88 offen offset:3072 sc1
    v_mfma_f32_32x32x16_bf16 v[56:71], a[92:95], v[116:119], v[56:71]
    s_waitcnt vmcnt(9)
    v_max_u32 v251, v123, v127
    v_max3_u32 v251, v251, v131, v135
    v_cmp_eq_u32 vcc, -1, v251
    s_nop 0
    s_cbranch_vccnz CK_68_r
CK_68_k:
    v_mfma_f32_32x32x16_bf16 v[40:55], a[96:99], v[120:123], v[40:55]
    s_add_u32 m0, s55, 0
    s_add_u32 s58, s73, 1048576
    buffer_load_dwordx4 v247, s[20:23], s58 offen lds
    buffer_load_dwordx4 v[168:171], v240, s[36:39], s89 offen offset:0 sc1
    v_mfma_f32_32x32x16_bf16 v[56:71], a[100:103], v[120:123], v[56:71]
    s_add_u32 m0, s55, 1024
    s_add_u32 s58, s73, 1081344
    buffer_load_dwordx4 v247, s[20:23], s58 offen lds
    v_mfma_f32_32x32x16_bf16 v[40:55], a[104:107], v[124:127], v[40:55]
    s_add_u32 m0, s55, 2048
    s_add_u32 s58, s73, 1114112
    buffer_load_dwordx4 v247, s[20:23], s58 offen lds
    buffer_load_dwordx4 v[172:175], v240, s[36:39], s89 offen offset:1024 sc1
    v_mfma_f32_32x32x16_bf16 v[56:71], a[108:111], v[124:127], v[56:71]
    s_add_u32 m0, s55, 3072
    s_add_u32 s58, s73, 1146880
    buffer_load_dwordx4 v247, s[20:23], s58 offen lds
    v_mfma_f32_32x32x16_bf16 v[40:55], a[112:115], v[128:131], v[40:55]
    s_add_u32 m0, s55, 4096
    s_add_u32 s58, s73, 1179648
    buffer_load_dwordx4 v247, s[20:23], s58 offen lds
    buffer_load_dwordx4 v[176:179], v240, s[36:39], s89 offen offset:2048 sc1
    v_mfma_f32_32x32x16_bf16 v[56:71], a[116:119], v[128:131], v[56:71]
    s_add_u32 m0, s55, 5120
    s_add_u32 s58, s73, 1212416
    buffer_load_dwordx4 v247, s[20:23], s58 offen lds
    v_mfma_f32_32x32x16_bf16 v[40:55], a[120:123], v[132:135], v[40:55]
    s_add_u32 m0, s55, 6144
    s_add_u32 s58, s73, 1245184
    buffer_load_dwordx4 v247, s[20:23], s58 offen lds
    buffer_load_dwordx4 v[180:183], v240, s[36:39], s89 offen offset:3072 sc1
    v_mfma_f32_32x32x16_bf16 v[56:71], a[124:127], v[132:135], v[56:71]
    s_add_u32 m0, s55, 7168
    s_add_u32 s58, s73, 1277952
    buffer_load_dwordx4 v247, s[20:23], s58 offen lds
    s_waitcnt lgkmcnt(0)
    s_nop 7
    ds_write_b128 v0, v[64:67] offset:4096
    ds_write_b128 v0, v[68:71] offset:5120
    ds_write_b128 v0, v[56:59] offset:2048
    ds_write_b128 v0, v[60:63] offset:3072
    ds_write_b128 v0, v[48:51] offset:0
    ds_write_b128 v0, v[52:55] offset:1024
    buffer_load_dwordx4 v[184:187], v241, s[36:39], s89 offen offset:0 sc1
    buffer_load_dwordx4 v[188:191], v241, s[36:39], s89 offen offset:1024 sc1
    buffer_load_dwordx4 v[192:195], v241, s[36:39], s89 offen offset:2048 sc1
    buffer_load_dwordx4 v[196:199], v241, s[36:39], s89 offen offset:3072 sc1
    s_waitcnt lgkmcnt(0)
    s_barrier
    ds_read_b128 v[48:51], v1 offset:0
    ds_read_b128 v[52:55], v1 offset:1024
    ds_read_b128 v[56:59], v2 offset:2048
    ds_read_b128 v[60:63], v2 offset:3072
    ds_read_b128 v[64:67], v3 offset:4096
    ds_read_b128 v[68:71], v3 offset:5120
    buffer_load_dwordx4 v[200:203], v240, s[36:39], s90 offen offset:0 sc1
    buffer_load_dwordx4 v[204:207], v240, s[36:39], s90 offen offset:1024 sc1
    buffer_load_dwordx4 v[208:211], v240, s[36:39], s90 offen offset:2048 sc1
    buffer_load_dwordx4 v[212:215], v240, s[36:39], s90 offen offset:3072 sc1
    s_waitcnt lgkmcnt(4)
    v_pk_add_f32 v[40:41], v[40:41], v[48:49]
    v_pk_add_f32 v[42:43], v[42:43], v[50:51]
    v_pk_add_f32 v[44:45], v[44:45], v[52:53]
    v_pk_add_f32 v[46:47], v[46:47], v[54:55]
    s_waitcnt lgkmcnt(2)
    v_pk_add_f32 v[40:41], v[40:41], v[56:57]
    v_pk_add_f32 v[42:43], v[42:43], v[58:59]
    v_pk_add_f32 v[44:45], v[44:45], v[60:61]
    v_pk_add_f32 v[46:47], v[46:47], v[62:63]
    s_waitcnt lgkmcnt(0)
    s_nop 0
    v_pk_add_f32 v[40:41], v[40:41], v[64:65]
    v_pk_add_f32 v[42:43], v[42:43], v[66:67]
    v_pk_add_f32 v[44:45], v[44:45], v[68:69]
    v_pk_add_f32 v[46:47], v[46:47], v[70:71]
    v_pk_mul_f32 v[48:49], v[40:41], v[40:41]
    v_pk_mul_f32 v[50:51], v[42:43], v[42:43]
    v_pk_mul_f32 v[52:53], v[44:45], v[44:45]
    v_pk_mul_f32 v[54:55], v[46:47], v[46:47]
    v_pk_fma_f32 v[48:49], v[48:49], v[216:217], v[216:217] op_sel:[0,0,1] op_sel_hi:[1,0,1]
    v_pk_fma_f32 v[50:51], v[50:51], v[216:217], v[216:217] op_sel:[0,0,1] op_sel_hi:[1,0,1]
    v_pk_fma_f32 v[52:53], v[52:53], v[216:217], v[216:217] op_sel:[0,0,1] op_sel_hi:[1,0,1]
    v_pk_fma_f32 v[54:55], v[54:55], v[216:217], v[216:217] op_sel:[0,0,1] op_sel_hi:[1,0,1]
    v_pk_mul_f32 v[48:49], v[48:49], v[40:41]
    v_pk_mul_f32 v[50:51], v[50:51], v[42:43]
    v_pk_mul_f32 v[52:53], v[52:53], v[44:45]
    v_pk_mul_f32 v[54:55], v[54:55], v[46:47]
    v_exp_f32 v48, v48
    v_exp_f32 v49, v49
    v_exp_f32 v50, v50
    v_exp_f32 v51, v51
    v_exp_f32 v52, v52
    v_exp_f32 v53, v53
    v_exp_f32 v54, v54
    v_exp_f32 v55, v55
    v_pk_add_f32 v[48:49], v[48:49], 1.0 op_sel_hi:[1,0]
    v_pk_add_f32 v[50:51], v[50:51], 1.0 op_sel_hi:[1,0]
    v_pk_add_f32 v[52:53], v[52:53], 1.0 op_sel_hi:[1,0]
    v_pk_add_f32 v[54:55], v[54:55], 1.0 op_sel_hi:[1,0]
    v_rcp_f32 v48, v48
    v_rcp_f32 v49, v49
    v_rcp_f32 v50, v50
    v_rcp_f32 v51, v51
    v_rcp_f32 v52, v52
    v_rcp_f32 v53, v53
    v_rcp_f32 v54, v54
    v_rcp_f32 v55, v55
    v_pk_mul_f32 v[48:49], v[48:49], v[40:41]
    v_pk_mul_f32 v[50:51], v[50:51], v[42:43]
    v_pk_mul_f32 v[52:53], v[52:53], v[44:45]
    v_pk_mul_f32 v[54:55], v[54:55], v[46:47]
    v_cvt_pk_bf16_f32 v220, v48, v49
    v_cvt_pk_bf16_f32 v221, v50, v51
    v_cvt_pk_bf16_f32 v222, v52, v53
    v_cvt_pk_bf16_f32 v223, v54, v55
    buffer_store_dwordx4 v[220:223], v240, s[36:39], s60 offen sc1
B_22_e1:
    s_waitcnt vmcnt(26)
    v_max_u32 v251, v139, v143
    v_max3_u32 v251, v251, v147, v151
    v_cmp_eq_u32 vcc, -1, v251
    s_nop 0
    s_cbranch_vccnz CK_69_r
CK_69_k:
    s_nop 0
    v_mfma_f32_32x32x16_bf16 v[8:23], v[136:139], a[128:131], 0
    s_add_u32 m0, s55, 8192
    s_add_u32 s58, s73, 1310720
    buffer_load_dwordx4 v247, s[20:23], s58 offen lds
    v_mfma_f32_32x32x16_bf16 v[24:39], v[136:139], a[132:135], 0
    s_add_u32 m0, s55, 9216
    s_add_u32 s58, s73, 1343488
    buffer_load_dwordx4 v247, s[20:23], s58 offen lds
    v_mfma_f32_32x32x16_bf16 v[8:23], v[140:143], a[136:139], v[8:23]
    s_add_u32 m0, s55, 10240
    s_add_u32 s58, s73, 1376256
    buffer_load_dwordx4 v247, s[20:23], s58 offen lds
    v_mfma_f32_32x32x16_bf16 v[24:39], v[140:143], a[140:143], v[24:39]
    s_add_u32 m0, s55, 11264
    s_add_u32 s58, s73, 1409024
    buffer_load_dwordx4 v247, s[20:23], s58 offen lds
    v_mfma_f32_32x32x16_bf16 v[8:23], v[144:147], a[144:147], v[8:23]
    s_add_u32 m0, s55, 12288
    s_add_u32 s58, s73, 1441792
    buffer_load_dwordx4 v247, s[20:23], s58 offen lds
    v_mfma_f32_32x32x16_bf16 v[24:39], v[144:147], a[148:151], v[24:39]
    s_add_u32 m0, s55, 13312
    s_add_u32 s58, s73, 1474560
    buffer_load_dwordx4 v247, s[20:23], s58 offen lds
    v_mfma_f32_32x32x16_bf16 v[8:23], v[148:151], a[152:155], v[8:23]
    s_add_u32 m0, s55, 14336
    s_add_u32 s58, s73, 1507328
    buffer_load_dwordx4 v247, s[20:23], s58 offen lds
    v_mfma_f32_32x32x16_bf16 v[24:39], v[148:151], a[156:159], v[24:39]
    s_add_u32 m0, s55, 15360
    s_add_u32 s58, s73, 1540096
    buffer_load_dwordx4 v247, s[20:23], s58 offen lds
    s_waitcnt vmcnt(29)
    v_max_u32 v251, v155, v159
    v_max3_u32 v251, v251, v163, v167
    v_cmp_eq_u32 vcc, -1, v251
    s_nop 0
    s_cbranch_vccnz CK_70_r
CK_70_k:
    s_nop 0
    v_mfma_f32_32x32x16_bf16 v[8:23], v[152:155], a[160:163], v[8:23]
    s_add_u32 m0, s55, 32768
    s_add_u32 s58, s73, 1572864
    buffer_load_dwordx4 v247, s[20:23], s58 offen lds
    v_mfma_f32_32x32x16_bf16 v[24:39], v[152:155], a[164:167], v[24:39]
    s_add_u32 m0, s55, 33792
    s_add_u32 s58, s73, 1605632
    buffer_load_dwordx4 v247, s[20:23], s58 offen lds
    v_mfma_f32_32x32x16_bf16 v[8:23], v[156:159], a[168:171], v[8:23]
    s_add_u32 m0, s55, 34816
    s_add_u32 s58, s73, 1638400
    buffer_load_dwordx4 v247, s[20:23], s58 offen lds
    v_mfma_f32_32x32x16_bf16 v[24:39], v[156:159], a[172:175], v[24:39]
    s_add_u32 m0, s55, 35840
    s_add_u32 s58, s73, 1671168
    buffer_load_dwordx4 v247, s[20:23], s58 offen lds
    v_mfma_f32_32x32x16_bf16 v[8:23], v[160:163], a[176:179], v[8:23]
    s_add_u32 m0, s55, 36864
    s_add_u32 s58, s73, 1703936
    buffer_load_dwordx4 v247, s[20:23], s58 offen lds
    v_mfma_f32_32x32x16_bf16 v[24:39], v[160:163], a[180:183], v[24:39]
    s_add_u32 m0, s55, 37888
    s_add_u32 s58, s73, 1736704
    buffer_load_dwordx4 v247, s[20:23], s58 offen lds
    v_mfma_f32_32x32x16_bf16 v[8:23], v[164:167], a[184:187], v[8:23]
    s_add_u32 m0, s55, 38912
    s_add_u32 s58, s73, 1769472
    buffer_load_dwordx4 v247, s[20:23], s58 offen lds
    v_mfma_f32_32x32x16_bf16 v[24:39], v[164:167], a[188:191], v[24:39]
    s_add_u32 m0, s55, 39936
    s_add_u32 s58, s73, 1802240
    buffer_load_dwordx4 v247, s[20:23], s58 offen lds
    s_waitcnt vmcnt(41)
    v_cmp_gt_u32 vcc, 32, v252
    s_nop 0
    s_cbranch_vccnz CC_71_r
CC_71_k:
    v_lshlrev_b32 v5, 16, v254
    v_add_f32 v40, v224, v5
    v_add_f32 v41, v225, v5
    v_add_f32 v42, v226, v5
    v_add_f32 v43, v227, v5
    v_add_f32 v44, v228, v5
    v_add_f32 v45, v229, v5
    v_add_f32 v46, v230, v5
    v_add_f32 v47, v231, v5
    v_add_f32 v48, v232, v5
    v_add_f32 v49, v233, v5
    v_add_f32 v50, v234, v5
    v_add_f32 v51, v235, v5
    v_add_f32 v52, v236, v5
    v_add_f32 v53, v237, v5
    v_add_f32 v54, v238, v5
    v_add_f32 v55, v239, v5
    v_add_u32 v0, s55, v240
    v_xor_b32 v1, 0x4000, v0
    v_xor_b32 v2, 0x10000, v0
    v_xor_b32 v3, 0x14000, v0
    s_waitcnt vmcnt(26)
    v_max_u32 v251, v171, v175
    v_max3_u32 v251, v251, v179, v183
    v_cmp_eq_u32 vcc, -1, v251
    s_nop 0
    s_cbranch_vccnz CK_72_r
CK_72_k:
    s_nop 0
    v_mfma_f32_32x32x16_bf16 v[8:23], v[168:171], a[192:195], v[8:23]
    buffer_load_dwordx4 v[104:107], v241, s[36:39], s90 offen offset:0 sc1
    v_mfma_f32_32x32x16_bf16 v[24:39], v[168:171], a[196:199], v[24:39]
    v_mfma_f32_32x32x16_bf16 v[8:23], v[172:175], a[200:203], v[8:23]
    buffer_load_dwordx4 v[108:111], v241, s[36:39], s90 offen offset:1024 sc1
    v_mfma_f32_32x32x16_bf16 v[24:39], v[172:175], a[204:207], v[24:39]
    v_mfma_f32_32x32x16_bf16 v[8:23], v[176:179], a[208:211], v[8:23]
    buffer_load_dwordx4 v[112:115], v241, s[36:39], s90 offen offset:2048 sc1
    v_mfma_f32_32x32x16_bf16 v[24:39], v[176:179], a[212:215], v[24:39]
    v_mfma_f32_32x32x16_bf16 v[8:23], v[180:183], a[216:219], v[8:23]
    buffer_load_dwordx4 v[116:119], v241, s[36:39], s90 offen offset:3072 sc1
    v_mfma_f32_32x32x16_bf16 v[24:39], v[180:183], a[220:223], v[24:39]
    s_waitcnt vmcnt(25)
    v_max_u32 v251, v187, v191
    v_max3_u32 v251, v251, v195, v199
    v_cmp_eq_u32 vcc, -1, v251
    s_nop 0
    s_cbranch_vccnz CK_73_r
CK_73_k:
    v_mfma_f32_32x32x16_bf16 v[8:23], v[184:187], a[224:227], v[8:23]
    buffer_load_dwordx4 v[120:123], v240, s[36:39], s91 offen offset:0 sc1
    v_mfma_f32_32x32x16_bf16 v[24:39], v[184:187], a[228:231], v[24:39]
    v_mfma_f32_32x32x16_bf16 v[8:23], v[188:191], a[232:235], v[8:23]
    s_waitcnt vmcnt(39)
    ds_read_b64_tr_b16 v[72:73], v218 offset:0
    ds_read_b64_tr_b16 v[74:75], v218 offset:1024
    buffer_load_dwordx4 v[124:127], v240, s[36:39], s91 offen offset:1024 sc1
    v_mfma_f32_32x32x16_bf16 v[24:39], v[188:191], a[236:239], v[24:39]
    ds_read_b64_tr_b16 v[76:77], v219 offset:0
    ds_read_b64_tr_b16 v[78:79], v219 offset:1024
    v_mfma_f32_32x32x16_bf16 v[8:23], v[192:195], a[240:243], v[8:23]
    s_waitcnt vmcnt(37)
    s_nop 0
    ds_read_b64_tr_b16 v[80:81], v218 offset:2048
    ds_read_b64_tr_b16 v[82:83], v218 offset:3072
    buffer_load_dwordx4 v[128:131], v240, s[36:39], s91 offen offset:2048 sc1
    v_mfma_f32_32x32x16_bf16 v[24:39], v[192:195], a[244:247], v[24:39]
    ds_read_b64_tr_b16 v[84:85], v219 offset:2048
    ds_read_b64_tr_b16 v[86:87], v219 offset:3072
    v_mfma_f32_32x32x16_bf16 v[8:23], v[196:199], a[248:251], v[8:23]
    s_waitcnt vmcnt(35)
    s_nop 0
    ds_read_b64_tr_b16 v[88:89], v218 offset:4096
    ds_read_b64_tr_b16 v[90:91], v218 offset:5120
    buffer_load_dwordx4 v[132:135], v240, s[36:39], s91 offen offset:3072 sc1
    v_mfma_f32_32x32x16_bf16 v[24:39], v[196:199], a[252:255], v[24:39]
    ds_read_b64_tr_b16 v[92:93], v219 offset:4096
    ds_read_b64_tr_b16 v[94:95], v219 offset:5120
    s_waitcnt vmcnt(25)
    v_max_u32 v251, v203, v207
    v_max3_u32 v251, v251, v211, v215
    v_cmp_eq_u32 vcc, -1, v251
    s_nop 0
    s_cbranch_vccnz CK_74_r
CK_74_k:
    s_waitcnt lgkmcnt(8)
    v_mfma_f32_32x32x16_bf16 v[8:23], v[200:203], v[72:75], v[8:23]
    s_waitcnt vmcnt(33)
    s_nop 0
    ds_read_b64_tr_b16 v[96:97], v218 offset:6144
    ds_read_b64_tr_b16 v[98:99], v218 offset:7168
    buffer_load_dwordx4 v[136:139], v240, s[36:39], s92 offen offset:0 sc1
    v_mfma_f32_32x32x16_bf16 v[24:39], v[200:203], v[76:79], v[24:39]
    ds_read_b64_tr_b16 v[100:101], v219 offset:6144
    ds_read_b64_tr_b16 v[102:103], v219 offset:7168
    s_waitcnt lgkmcnt(8)
    v_mfma_f32_32x32x16_bf16 v[8:23], v[204:207], v[80:83], v[8:23]
    s_waitcnt vmcnt(23)
    ds_read_b64_tr_b16 v[72:73], v218 offset:8192
    ds_read_b64_tr_b16 v[74:75], v218 offset:9216
    buffer_load_dwordx4 v[140:143], v240, s[36:39], s92 offen offset:1024 sc1
    v_mfma_f32_32x32x16_bf16 v[24:39], v[204:207], v[84:87], v[24:39]
    ds_read_b64_tr_b16 v[76:77], v219 offset:8192
    ds_read_b64_tr_b16 v[78:79], v219 offset:9216
    s_waitcnt lgkmcnt(8)
    v_mfma_f32_32x32x16_bf16 v[8:23], v[208:211], v[88:91], v[8:23]
    s_waitcnt vmcnt(22)
    ds_read_b64_tr_b16 v[80:81], v218 offset:10240
    ds_read_b64_tr_b16 v[82:83], v218 offset:11264
    buffer_load_dwordx4 v[144:147], v240, s[36:39], s92 offen offset:2048 sc1
    v_mfma_f32_32x32x16_bf16 v[24:39], v[208:211], v[92:95], v[24:39]
    ds_read_b64_tr_b16 v[84:85], v219 offset:10240
    ds_read_b64_tr_b16 v[86:87], v219 offset:11264
    s_waitcnt lgkmcnt(8)
    v_mfma_f32_32x32x16_bf16 v[8:23], v[212:215], v[96:99], v[8:23]
    s_waitcnt vmcnt(21)
    ds_read_b64_tr_b16 v[88:89], v218 offset:12288
    ds_read_b64_tr_b16 v[90:91], v218 offset:13312
    buffer_load_dwordx4 v[148:151], v240, s[36:39], s92 offen offset:3072 sc1
    v_mfma_f32_32x32x16_bf16 v[24:39], v[212:215], v[100:103], v[24:39]
    ds_read_b64_tr_b16 v[92:93], v219 offset:12288
    ds_read_b64_tr_b16 v[94:95], v219 offset:13312
    s_waitcnt vmcnt(8)
    v_max_u32 v251, v107, v111
    v_max3_u32 v251, v251, v115, v119
    v_cmp_eq_u32 vcc, -1, v251
    s_nop 0
    s_cbranch_vccnz CK_75_r
CK_75_k:
    s_waitcnt lgkmcnt(8)
    v_mfma_f32_32x32x16_bf16 v[8:23], v[104:107], v[72:75], v[8:23]
    s_waitcnt vmcnt(20)
    s_nop 0
    ds_read_b64_tr_b16 v[96:97], v218 offset:14336
    ds_read_b64_tr_b16 v[98:99], v218 offset:15360
    buffer_load_dwordx4 v[152:155], v241, s[36:39], s92 offen offset:0 sc1
    v_mfma_f32_32x32x16_bf16 v[24:39], v[104:107], v[76:79], v[24:39]
    ds_read_b64_tr_b16 v[100:101], v219 offset:14336
    ds_read_b64_tr_b16 v[102:103], v219 offset:15360
    s_waitcnt lgkmcnt(8)
    v_mfma_f32_32x32x16_bf16 v[8:23], v[108:111], v[80:83], v[8:23]
    s_waitcnt vmcnt(19)
    ds_read_b64_tr_b16 v[72:73], v218 offset:32768
    ds_read_b64_tr_b16 v[74:75], v218 offset:33792
    buffer_load_dwordx4 v[156:159], v241, s[36:39], s92 offen offset:1024 sc1
    v_mfma_f32_32x32x16_bf16 v[24:39], v[108:111], v[84:87], v[24:39]
    ds_read_b64_tr_b16 v[76:77], v219 offset:32768
    ds_read_b64_tr_b16 v[78:79], v219 offset:33792
    s_waitcnt lgkmcnt(8)
    v_mfma_f32_32x32x16_bf16 v[8:23], v[112:115], v[88:91], v[8:23]
    s_waitcnt vmcnt(18)
    ds_read_b64_tr_b16 v[80:81], v218 offset:34816
    ds_read_b64_tr_b16 v[82:83], v218 offset:35840
    buffer_load_dwordx4 v[160:163], v241, s[36:39], s92 offen offset:2048 sc1
    v_mfma_f32_32x32x16_bf16 v[24:39], v[112:115], v[92:95], v[24:39]
    ds_read_b64_tr_b16 v[84:85], v219 offset:34816
    ds_read_b64_tr_b16 v[86:87], v219 offset:35840
    s_waitcnt lgkmcnt(8)
    v_mfma_f32_32x32x16_bf16 v[8:23], v[116:119], v[96:99], v[8:23]
    s_waitcnt vmcnt(17)
    ds_read_b64_tr_b16 v[88:89], v218 offset:36864
    ds_read_b64_tr_b16 v[90:91], v218 offset:37888
    buffer_load_dwordx4 v[164:167], v241, s[36:39], s92 offen offset:3072 sc1
    v_mfma_f32_32x32x16_bf16 v[24:39], v[116:119], v[100:103], v[24:39]
    ds_read_b64_tr_b16 v[92:93], v219 offset:36864
    ds_read_b64_tr_b16 v[94:95], v219 offset:37888
    s_waitcnt vmcnt(8)
    v_max_u32 v251, v123, v127
    v_max3_u32 v251, v251, v131, v135
    v_cmp_eq_u32 vcc, -1, v251
    s_nop 0
    s_cbranch_vccnz CK_76_r
CK_76_k:
    s_waitcnt lgkmcnt(8)
    v_mfma_f32_32x32x16_bf16 v[8:23], v[120:123], v[72:75], v[8:23]
    s_waitcnt vmcnt(16)
    s_nop 0
    ds_read_b64_tr_b16 v[96:97], v218 offset:38912
    ds_read_b64_tr_b16 v[98:99], v218 offset:39936
    buffer_load_dwordx4 v[168:171], v240, s[36:39], s93 offen offset:0 sc1
    v_mfma_f32_32x32x16_bf16 v[24:39], v[120:123], v[76:79], v[24:39]
    ds_read_b64_tr_b16 v[100:101], v219 offset:38912
    ds_read_b64_tr_b16 v[102:103], v219 offset:39936
    s_waitcnt lgkmcnt(8)
    v_mfma_f32_32x32x16_bf16 v[8:23], v[124:127], v[80:83], v[8:23]
    buffer_load_dwordx4 v[172:175], v240, s[36:39], s93 offen offset:1024 sc1
    v_mfma_f32_32x32x16_bf16 v[24:39], v[124:127], v[84:87], v[24:39]
    s_waitcnt lgkmcnt(4)
    v_mfma_f32_32x32x16_bf16 v[8:23], v[128:131], v[88:91], v[8:23]
    buffer_load_dwordx4 v[176:179], v240, s[36:39], s93 offen offset:2048 sc1
    v_mfma_f32_32x32x16_bf16 v[24:39], v[128:131], v[92:95], v[24:39]
    s_waitcnt lgkmcnt(0)
    v_mfma_f32_32x32x16_bf16 v[8:23], v[132:135], v[96:99], v[8:23]
    buffer_load_dwordx4 v[180:183], v240, s[36:39], s93 offen offset:3072 sc1
    v_mfma_f32_32x32x16_bf16 v[24:39], v[132:135], v[100:103], v[24:39]
    s_waitcnt vmcnt(8)
    v_max_u32_e64 v251, v139, v143
    v_max3_u32 v251, v251, v147, v151
    v_cmp_eq_u32 vcc, -1, v251
    s_nop 0
    s_cbranch_vccnz CK_77_r
CK_77_k:
    s_nop 0
    v_mfma_f32_32x32x16_bf16 v[40:55], v[136:139], a[128:131], v[40:55]
    buffer_load_dwordx4 v[184:187], v241, s[36:39], s93 offen offset:0 sc1
    v_mfma_f32_32x32x16_bf16 v[56:71], v[136:139], a[132:135], 0
    v_mfma_f32_32x32x16_bf16 v[40:55], v[140:143], a[136:139], v[40:55]
    buffer_load_dwordx4 v[188:191], v241, s[36:39], s93 offen offset:1024 sc1
    v_mfma_f32_32x32x16_bf16 v[56:71], v[140:143], a[140:143], v[56:71]
    v_mfma_f32_32x32x16_bf16 v[40:55], v[144:147], a[144:147], v[40:55]
    buffer_load_dwordx4 v[192:195], v241, s[36:39], s93 offen offset:2048 sc1
    v_mfma_f32_32x32x16_bf16 v[56:71], v[144:147], a[148:151], v[56:71]
    v_mfma_f32_32x32x16_bf16 v[40:55], v[148:151], a[152:155], v[40:55]
    buffer_load_dwordx4 v[196:199], v241, s[36:39], s93 offen offset:3072 sc1
    v_mfma_f32_32x32x16_bf16 v[56:71], v[148:151], a[156:159], v[56:71]
    ds_write_b128 v0, v[8:11] offset:40960
    ds_write_b128 v0, v[12:15] offset:41984
    ds_write_b128 v0, v[16:19] offset:43008
    ds_write_b128 v0, v[20:23] offset:44032
    ds_write_b128 v0, v[24:27] offset:45056
    ds_write_b128 v0, v[28:31] offset:46080
    ds_write_b128 v0, v[32:35] offset:47104
    ds_write_b128 v0, v[36:39] offset:48128
    s_waitcnt vmcnt(8)
    v_max_u32 v251, v155, v159
    v_max3_u32 v251, v251, v163, v167
    v_cmp_eq_u32 vcc, -1, v251
    s_nop 0
    s_cbranch_vccnz CK_78_r
CK_78_k:
    s_nop 0
    v_mfma_f32_32x32x16_bf16 v[40:55], v[152:155], a[160:163], v[40:55]
    buffer_load_dwordx4 v[200:203], v240, s[36:39], s94 offen offset:0 sc1
    v_mfma_f32_32x32x16_bf16 v[56:71], v[152:155], a[164:167], v[56:71]
    v_mfma_f32_32x32x16_bf16 v[40:55], v[156:159], a[168:171], v[40:55]
    buffer_load_dwordx4 v[204:207], v240, s[36:39], s94 offen offset:1024 sc1
    v_mfma_f32_32x32x16_bf16 v[56:71], v[156:159], a[172:175], v[56:71]
    v_mfma_f32_32x32x16_bf16 v[40:55], v[160:163], a[176:179], v[40:55]
    buffer_load_dwordx4 v[208:211], v240, s[36:39], s94 offen offset:2048 sc1
    v_mfma_f32_32x32x16_bf16 v[56:71], v[160:163], a[180:183], v[56:71]
    v_mfma_f32_32x32x16_bf16 v[40:55], v[164:167], a[184:187], v[40:55]
    buffer_load_dwordx4 v[212:215], v240, s[36:39], s94 offen offset:3072 sc1
    v_mfma_f32_32x32x16_bf16 v[56:71], v[164:167], a[188:191], v[56:71]
    s_waitcnt lgkmcnt(0)
    s_barrier
    ds_read_b128 v[8:11], v2 offset:40960
    ds_read_b128 v[12:15], v2 offset:41984
    ds_read_b128 v[16:19], v2 offset:43008
    ds_read_b128 v[20:23], v2 offset:44032
    ds_read_b128 v[24:27], v3 offset:45056
    ds_read_b128 v[28:31], v3 offset:46080
    ds_read_b128 v[32:35], v3 offset:47104
    ds_read_b128 v[36:39], v3 offset:48128
    s_waitcnt vmcnt(8)
    v_max_u32 v251, v171, v175
    v_max3_u32 v251, v251, v179, v183
    v_cmp_eq_u32 vcc, -1, v251
    s_nop 0
    s_cbranch_vccnz CK_79_r
CK_79_k:
    s_nop 0
    v_mfma_f32_32x32x16_bf16 v[40:55], v[168:171], a[192:195], v[40:55]
    buffer_load_dwordx4 v[104:107], v241, s[36:39], s94 offen offset:0 sc1
    v_mfma_f32_32x32x16_bf16 v[56:71], v[168:171], a[196:199], v[56:71]
    v_mfma_f32_32x32x16_bf16 v[40:55], v[172:175], a[200:203], v[40:55]
    buffer_load_dwordx4 v[108:111], v241, s[36:39], s94 offen offset:1024 sc1
    v_mfma_f32_32x32x16_bf16 v[56:71], v[172:175], a[204:207], v[56:71]
    v_mfma_f32_32x32x16_bf16 v[40:55], v[176:179], a[208:211], v[40:55]
    buffer_load_dwordx4 v[112:115], v241, s[36:39], s94 offen offset:2048 sc1
    v_mfma_f32_32x32x16_bf16 v[56:71], v[176:179], a[212:215], v[56:71]
    v_mfma_f32_32x32x16_bf16 v[40:55], v[180:183], a[216:219], v[40:55]
    buffer_load_dwordx4 v[116:119], v241, s[36:39], s94 offen offset:3072 sc1
    v_mfma_f32_32x32x16_bf16 v[56:71], v[180:183], a[220:223], v[56:71]
    s_waitcnt vmcnt(8)
    v_max_u32 v251, v187, v191
    v_max3_u32 v251, v251, v195, v199
    v_cmp_eq_u32 vcc, -1, v251
    s_nop 0
    s_cbranch_vccnz CK_80_r
CK_80_k:
    s_nop 0
    v_mfma_f32_32x32x16_bf16 v[40:55], v[184:187], a[224:227], v[40:55]
    buffer_load_dwordx4 v[120:123], v240, s[36:39], s95 offen offset:0 sc1
    v_mfma_f32_32x32x16_bf16 v[56:71], v[184:187], a[228:231], v[56:71]
    v_mfma_f32_32x32x16_bf16 v[40:55], v[188:191], a[232:235], v[40:55]
    ds_read_b64_tr_b16 v[72:73], v218 offset:0
    ds_read_b64_tr_b16 v[74:75], v218 offset:1024
    buffer_load_dwordx4 v[124:127], v240, s[36:39], s95 offen offset:1024 sc1
    v_mfma_f32_32x32x16_bf16 v[56:71], v[188:191], a[236:239], v[56:71]
    ds_read_b64_tr_b16 v[76:77], v219 offset:0
    ds_read_b64_tr_b16 v[78:79], v219 offset:1024
    v_mfma_f32_32x32x16_bf16 v[40:55], v[192:195], a[240:243], v[40:55]
    ds_read_b64_tr_b16 v[80:81], v218 offset:2048
    ds_read_b64_tr_b16 v[82:83], v218 offset:3072
    buffer_load_dwordx4 v[128:131], v240, s[36:39], s95 offen offset:2048 sc1
    v_mfma_f32_32x32x16_bf16 v[56:71], v[192:195], a[244:247], v[56:71]
    ds_read_b64_tr_b16 v[84:85], v219 offset:2048
    ds_read_b64_tr_b16 v[86:87], v219 offset:3072
    v_mfma_f32_32x32x16_bf16 v[40:55], v[196:199], a[248:251], v[40:55]
    ds_read_b64_tr_b16 v[88:89], v218 offset:4096
    ds_read_b64_tr_b16 v[90:91], v218 offset:5120
    buffer_load_dwordx4 v[132:135], v240, s[36:39], s95 offen offset:3072 sc1
    v_mfma_f32_32x32x16_bf16 v[56:71], v[196:199], a[252:255], v[56:71]
    ds_read_b64_tr_b16 v[92:93], v219 offset:4096
    ds_read_b64_tr_b16 v[94:95], v219 offset:5120
    s_waitcnt vmcnt(8)
    v_max_u32 v251, v203, v207
    v_max3_u32 v251, v251, v211, v215
    v_cmp_eq_u32 vcc, -1, v251
    s_nop 0
    s_cbranch_vccnz CK_81_r
CK_81_k:
    s_waitcnt lgkmcnt(8)
    v_mfma_f32_32x32x16_bf16 v[40:55], v[200:203], v[72:75], v[40:55]
    ds_read_b64_tr_b16 v[96:97], v218 offset:6144
    ds_read_b64_tr_b16 v[98:99], v218 offset:7168
    v_mfma_f32_32x32x16_bf16 v[56:71], v[200:203], v[76:79], v[56:71]
    ds_read_b64_tr_b16 v[100:101], v219 offset:6144
    ds_read_b64_tr_b16 v[102:103], v219 offset:7168
    s_waitcnt lgkmcnt(8)
    s_nop 0
    v_mfma_f32_32x32x16_bf16 v[40:55], v[204:207], v[80:83], v[40:55]
    ds_read_b64_tr_b16 v[72:73], v218 offset:8192
    ds_read_b64_tr_b16 v[74:75], v218 offset:9216
    v_mfma_f32_32x32x16_bf16 v[56:71], v[204:207], v[84:87], v[56:71]
    ds_read_b64_tr_b16 v[76:77], v219 offset:8192
    ds_read_b64_tr_b16 v[78:79], v219 offset:9216
    v_add_f32 v8, v8, v24
    v_add_f32 v9, v9, v25
    v_add_f32 v10, v10, v26
    v_add_f32 v11, v11, v27
    s_waitcnt lgkmcnt(8)
    s_nop 0
    v_mfma_f32_32x32x16_bf16 v[40:55], v[208:211], v[88:91], v[40:55]
    ds_read_b64_tr_b16 v[80:81], v218 offset:10240
    ds_read_b64_tr_b16 v[82:83], v218 offset:11264
    v_mfma_f32_32x32x16_bf16 v[56:71], v[208:211], v[92:95], v[56:71]
    ds_read_b64_tr_b16 v[84:85], v219 offset:10240
    ds_read_b64_tr_b16 v[86:87], v219 offset:11264
    v_add_f32 v12, v12, v28
    v_add_f32 v13, v13, v29
    v_add_f32 v14, v14, v30
    v_add_f32 v15, v15, v31
    s_waitcnt lgkmcnt(8)
    s_nop 0
    v_mfma_f32_32x32x16_bf16 v[40:55], v[212:215], v[96:99], v[40:55]
    ds_read_b64_tr_b16 v[88:89], v218 offset:12288
    ds_read_b64_tr_b16 v[90:91], v218 offset:13312
    v_mfma_f32_32x32x16_bf16 v[56:71], v[212:215], v[100:103], v[56:71]
    ds_read_b64_tr_b16 v[92:93], v219 offset:12288
    ds_read_b64_tr_b16 v[94:95], v219 offset:13312
    v_add_f32 v16, v16, v32
    v_add_f32 v17, v17, v33
    v_add_f32 v18, v18, v34
    v_add_f32 v19, v19, v35
    s_waitcnt vmcnt(4)
    v_max_u32 v251, v107, v111
    v_max3_u32 v251, v251, v115, v119
    v_cmp_eq_u32 vcc, -1, v251
    s_nop 0
    s_cbranch_vccnz CK_82_r
CK_82_k:
    s_waitcnt lgkmcnt(8)
    v_mfma_f32_32x32x16_bf16 v[40:55], v[104:107], v[72:75], v[40:55]
    ds_read_b64_tr_b16 v[96:97], v218 offset:14336
    ds_read_b64_tr_b16 v[98:99], v218 offset:15360
    v_mfma_f32_32x32x16_bf16 v[56:71], v[104:107], v[76:79], v[56:71]
    ds_read_b64_tr_b16 v[100:101], v219 offset:14336
    ds_read_b64_tr_b16 v[102:103], v219 offset:15360
    v_add_f32 v20, v20, v36
    v_add_f32 v21, v21, v37
    v_add_f32 v22, v22, v38
    v_add_f32 v23, v23, v39
    s_waitcnt lgkmcnt(8)
    s_nop 0
    v_mfma_f32_32x32x16_bf16 v[40:55], v[108:111], v[80:83], v[40:55]
    ds_read_b64_tr_b16 v[72:73], v218 offset:32768
    ds_read_b64_tr_b16 v[74:75], v218 offset:33792
    v_mfma_f32_32x32x16_bf16 v[56:71], v[108:111], v[84:87], v[56:71]
    ds_read_b64_tr_b16 v[76:77], v219 offset:32768
    ds_read_b64_tr_b16 v[78:79], v219 offset:33792
    s_waitcnt lgkmcnt(8)
    s_nop 0
    v_mfma_f32_32x32x16_bf16 v[40:55], v[112:115], v[88:91], v[40:55]
    ds_read_b64_tr_b16 v[80:81], v218 offset:34816
    ds_read_b64_tr_b16 v[82:83], v218 offset:35840
    v_mfma_f32_32x32x16_bf16 v[56:71], v[112:115], v[92:95], v[56:71]
    ds_read_b64_tr_b16 v[84:85], v219 offset:34816
    ds_read_b64_tr_b16 v[86:87], v219 offset:35840
    s_waitcnt lgkmcnt(8)
    s_nop 0
    v_mfma_f32_32x32x16_bf16 v[40:55], v[116:119], v[96:99], v[40:55]
    ds_read_b64_tr_b16 v[88:89], v218 offset:36864
    ds_read_b64_tr_b16 v[90:91], v218 offset:37888
    v_mfma_f32_32x32x16_bf16 v[56:71], v[116:119], v[100:103], v[56:71]
    ds_read_b64_tr_b16 v[92:93], v219 offset:36864
    ds_read_b64_tr_b16 v[94:95], v219 offset:37888
    s_waitcnt vmcnt(0)
    v_max_u32 v251, v123, v127
    v_max3_u32 v251, v251, v131, v135
    v_cmp_eq_u32 vcc, -1, v251
    s_nop 0
    s_cbranch_vccnz CK_83_r
CK_83_k:
    s_waitcnt lgkmcnt(8)
    v_mfma_f32_32x32x16_bf16 v[40:55], v[120:123], v[72:75], v[40:55]
    ds_read_b64_tr_b16 v[96:97], v218 offset:38912
    ds_read_b64_tr_b16 v[98:99], v218 offset:39936
    v_mfma_f32_32x32x16_bf16 v[56:71], v[120:123], v[76:79], v[56:71]
    ds_read_b64_tr_b16 v[100:101], v219 offset:38912
    ds_read_b64_tr_b16 v[102:103], v219 offset:39936
    s_waitcnt lgkmcnt(8)
    v_mfma_f32_32x32x16_bf16 v[40:55], v[124:127], v[80:83], v[40:55]
    v_mfma_f32_32x32x16_bf16 v[56:71], v[124:127], v[84:87], v[56:71]
    s_waitcnt lgkmcnt(4)
    v_mfma_f32_32x32x16_bf16 v[40:55], v[128:131], v[88:91], v[40:55]
    v_mfma_f32_32x32x16_bf16 v[56:71], v[128:131], v[92:95], v[56:71]
    s_waitcnt lgkmcnt(0)
    v_mfma_f32_32x32x16_bf16 v[40:55], v[132:135], v[96:99], v[40:55]
    v_mfma_f32_32x32x16_bf16 v[56:71], v[132:135], v[100:103], v[56:71]
    s_nop 11
    ds_write_b128 v0, v[56:59] offset:36864
    ds_write_b128 v0, v[60:63] offset:37888
    ds_write_b128 v0, v[64:67] offset:38912
    ds_write_b128 v0, v[68:71] offset:39936
    v_pk_add_f32 v[40:41], v[40:41], v[8:9]
    v_pk_add_f32 v[42:43], v[42:43], v[10:11]
    v_pk_add_f32 v[44:45], v[44:45], v[12:13]
    v_pk_add_f32 v[46:47], v[46:47], v[14:15]
    v_pk_add_f32 v[48:49], v[48:49], v[16:17]
    v_pk_add_f32 v[50:51], v[50:51], v[18:19]
    v_pk_add_f32 v[52:53], v[52:53], v[20:21]
    v_pk_add_f32 v[54:55], v[54:55], v[22:23]
    s_waitcnt lgkmcnt(0)
    s_barrier
    ds_read_b128 v[56:59], v1 offset:36864
    ds_read_b128 v[60:63], v1 offset:37888
    ds_read_b128 v[64:67], v1 offset:38912
    ds_read_b128 v[68:71], v1 offset:39936
B_22_j:
    v_mul_u32_u24 v0, 896, v243
    v_lshl_add_u32 v0, v242, 4, v0
    s_waitcnt lgkmcnt(3)
    v_pk_add_f32 v[40:41], v[40:41], v[56:57]
    v_pk_add_f32 v[42:43], v[42:43], v[58:59]
    s_waitcnt lgkmcnt(2)
    v_pk_add_f32 v[44:45], v[44:45], v[60:61]
    v_pk_add_f32 v[46:47], v[46:47], v[62:63]
    s_waitcnt lgkmcnt(1)
    v_pk_add_f32 v[48:49], v[48:49], v[64:65]
    v_pk_add_f32 v[50:51], v[50:51], v[66:67]
    s_waitcnt lgkmcnt(0)
    v_pk_add_f32 v[52:53], v[52:53], v[68:69]
    v_pk_add_f32 v[54:55], v[54:55], v[70:71]
    v_cvt_pk_bf16_f32 v112, v40, v41
    v_cvt_pk_bf16_f32 v113, v42, v43
    v_cvt_pk_bf16_f32 v114, v44, v45
    v_cvt_pk_bf16_f32 v115, v46, v47
    v_cvt_pk_bf16_f32 v116, v48, v49
    v_cvt_pk_bf16_f32 v117, v50, v51
    v_cvt_pk_bf16_f32 v118, v52, v53
    v_cvt_pk_bf16_f32 v119, v54, v55
    v_permlane32_swap_b32 v112, v114
    v_permlane32_swap_b32 v113, v115
    buffer_store_dwordx4 v[112:115], v0, s[32:35], s68 offen offset:0
    v_permlane32_swap_b32 v116, v118
    v_permlane32_swap_b32 v117, v119
    buffer_store_dwordx4 v[116:119], v0, s[32:35], s68 offen offset:32
B_22_end:

L_next:
    s_cmp_eq_u32 s50, 1
    s_cbranch_scc1 L_fin
    s_mov_b32 s50, 1
    s_mov_b32 s51, 6291456
    s_branch L_iter
L_helper:

    s_cmp_eq_u32 s50, 0
    s_cbranch_scc1 L_hnl
    s_add_u32 s58, s62, 0
    s_nop 0
    buffer_load_dwordx2 v[160:161], v245, s[36:39], s58 offen offset:0 sc1
    buffer_load_dwordx2 v[162:163], v245, s[36:39], s58 offen offset:2048 sc1
    s_add_u32 s58, s62, 4096
    buffer_load_dwordx2 v[164:165], v245, s[36:39], s58 offen offset:0 sc1
    buffer_load_dwordx2 v[166:167], v245, s[36:39], s58 offen offset:2048 sc1
    s_add_u32 s58, s62, 8192
    buffer_load_dwordx2 v[168:169], v245, s[36:39], s58 offen offset:0 sc1
    buffer_load_dwordx2 v[170:171], v245, s[36:39], s58 offen offset:2048 sc1
    s_add_u32 s58, s62, 12288
    buffer_load_dwordx2 v[172:173], v245, s[36:39], s58 offen offset:0 sc1
    buffer_load_dwordx2 v[174:175], v245, s[36:39], s58 offen offset:2048 sc1
    s_add_u32 s58, s62, 16384
    buffer_load_dwordx2 v[176:177], v245, s[36:39], s58 offen offset:0 sc1
    buffer_load_dwordx2 v[178:179], v245, s[36:39], s58 offen offset:2048 sc1
    s_add_u32 s58, s62, 20480
    buffer_load_dwordx2 v[180:181], v245, s[36:39], s58 offen offset:0 sc1
    buffer_load_dwordx2 v[182:183], v245, s[36:39], s58 offen offset:2048 sc1
    s_add_u32 s58, s62, 24576
    buffer_load_dwordx2 v[184:185], v245, s[36:39], s58 offen offset:0 sc1
    buffer_load_dwordx2 v[186:187], v245, s[36:39], s58 offen offset:2048 sc1
    s_add_u32 s58, s62, 28672
    buffer_load_dwordx2 v[188:189], v245, s[36:39], s58 offen offset:0 sc1
    buffer_load_dwordx2 v[190:191], v245, s[36:39], s58 offen offset:2048 sc1
L_hnl:
    s_waitcnt vmcnt(0)
    v_mov_b32 v204, 0x3f80
    v_mov_b32 v205, 0x3f800000
    v_add_u32 v206, 155648, v240
    v_max_u32_e64 v251, v161, v163
    v_max3_u32 v251, v251, v165, v167
    v_max3_u32 v251, v251, v169, v171
    v_max3_u32 v251, v251, v173, v175
    v_max3_u32 v251, v251, v177, v179
    v_max3_u32 v251, v251, v181, v183
    v_max3_u32 v251, v251, v185, v187
    v_max3_u32 v251, v251, v189, v191
    v_cmp_eq_u32 vcc, -1, v251
    s_nop 0
    s_cbranch_vccnz CK_86_r
CK_86_k:
    s_nop 0
    v_dot2_f32_bf16 v200, v160, v204, 0
    v_dot2_f32_bf16 v201, v160, v205, 0
    v_dot2_f32_bf16 v202, v161, v204, 0
    v_dot2_f32_bf16 v203, v161, v205, 0
    v_dot2_f32_bf16 v200, v162, v204, v200
    v_dot2_f32_bf16 v201, v162, v205, v201
    v_dot2_f32_bf16 v202, v163, v204, v202
    v_dot2_f32_bf16 v203, v163, v205, v203
    v_dot2_f32_bf16 v200, v164, v204, v200
    v_dot2_f32_bf16 v201, v164, v205, v201
    v_dot2_f32_bf16 v202, v165, v204, v202
    v_dot2_f32_bf16 v203, v165, v205, v203
    v_dot2_f32_bf16 v200, v166, v204, v200
    v_dot2_f32_bf16 v201, v166, v205, v201
    v_dot2_f32_bf16 v202, v167, v204, v202
    v_dot2_f32_bf16 v203, v167, v205, v203
    v_dot2_f32_bf16 v200, v168, v204, v200
    v_dot2_f32_bf16 v201, v168, v205, v201
    v_dot2_f32_bf16 v202, v169, v204, v202
    v_dot2_f32_bf16 v203, v169, v205, v203
    v_dot2_f32_bf16 v200, v170, v204, v200
    v_dot2_f32_bf16 v201, v170, v205, v201
    v_dot2_f32_bf16 v202, v171, v204, v202
    v_dot2_f32_bf16 v203, v171, v205, v203
    v_dot2_f32_bf16 v200, v172, v204, v200
    v_dot2_f32_bf16 v201, v172, v205, v201
    v_dot2_f32_bf16 v202, v173, v204, v202
    v_dot2_f32_bf16 v203, v173, v205, v203
    v_dot2_f32_bf16 v200, v174, v204, v200
    v_dot2_f32_bf16 v201, v174, v205, v201
    v_dot2_f32_bf16 v202, v175, v204, v202
    v_dot2_f32_bf16 v203, v175, v205, v203
    v_dot2_f32_bf16 v200, v176, v204, v200
    v_dot2_f32_bf16 v201, v176, v205, v201
    v_dot2_f32_bf16 v202, v177, v204, v202
    v_dot2_f32_bf16 v203, v177, v205, v203
    v_dot2_f32_bf16 v200, v178, v204, v200
    v_dot2_f32_bf16 v201, v178, v205, v201
    v_dot2_f32_bf16 v202, v179, v204, v202
    v_dot2_f32_bf16 v203, v179, v205, v203
    v_dot2_f32_bf16 v200, v180, v204, v200
    v_dot2_f32_bf16 v201, v180, v205, v201
    v_dot2_f32_bf16 v202, v181, v204, v202
    v_dot2_f32_bf16 v203, v181, v205, v203
    v_dot2_f32_bf16 v200, v182, v204, v200
    v_dot2_f32_bf16 v201, v182, v205, v201
    v_dot2_f32_bf16 v202, v183, v204, v202
    v_dot2_f32_bf16 v203, v183, v205, v203
    v_dot2_f32_bf16 v200, v184, v204, v200
    v_dot2_f32_bf16 v201, v184, v205, v201
    v_dot2_f32_bf16 v202, v185, v204, v202
    v_dot2_f32_bf16 v203, v185, v205, v203
    v_dot2_f32_bf16 v200, v186, v204, v200
    v_dot2_f32_bf16 v201, v186, v205, v201
    v_dot2_f32_bf16 v202, v187, v204, v202
    v_dot2_f32_bf16 v203, v187, v205, v203
    v_dot2_f32_bf16 v200, v188, v204, v200
    v_dot2_f32_bf16 v201, v188, v205, v201
    v_dot2_f32_bf16 v202, v189, v204, v202
    v_dot2_f32_bf16 v203, v189, v205, v203
    v_dot2_f32_bf16 v200, v190, v204, v200
    v_dot2_f32_bf16 v201, v190, v205, v201
    v_dot2_f32_bf16 v202, v191, v204, v202
    v_dot2_f32_bf16 v203, v191, v205, v203

    v_mov_b32 v196, 0
    v_mov_b32 v197, 0
    s_mov_b32 exec_hi, s66
    v_cvt_pk_bf16_f32 v196, v200, v201
    v_cvt_pk_bf16_f32 v197, v202, v203
    s_mov_b64 exec, -1
    ds_write_b64 v195, v[196:197]
    s_waitcnt lgkmcnt(0)
    s_barrier
    ds_read_b128 v[216:219], v206
    ds_read_b128 v[220:223], v206 offset:1024
    s_waitcnt lgkmcnt(1)
    v_mfma_f32_32x32x16_bf16 v[160:175], v[216:219], v[208:211], 0
    s_waitcnt lgkmcnt(0)
    v_mfma_f32_32x32x16_bf16 v[160:175], v[220:223], v[212:215], v[160:175]
    v_mov_b32 v183, 0
    s_nop 10
    v_add_f32 v196, 0x358637bd, v175
    v_rcp_f32 v196, v196

    s_nop 0
    v_pk_mul_f32 v[160:161], v[160:161], v[196:197] op_sel_hi:[1,0]
    v_pk_mul_f32 v[162:163], v[162:163], v[196:197] op_sel_hi:[1,0]
    v_pk_mul_f32 v[164:165], v[164:165], v[196:197] op_sel_hi:[1,0]
    v_pk_mul_f32 v[166:167], v[166:167], v[196:197] op_sel_hi:[1,0]
    v_pk_mul_f32 v[168:169], v[168:169], v[196:197] op_sel_hi:[1,0]
    v_pk_mul_f32 v[170:171], v[170:171], v[196:197] op_sel_hi:[1,0]
    v_pk_mul_f32 v[172:173], v[172:173], v[196:197] op_sel_hi:[1,0]
    v_cvt_pk_bf16_f32 v176, v160, v161
    v_cvt_pk_bf16_f32 v177, v162, v163
    v_cvt_pk_bf16_f32 v178, v164, v165
    v_cvt_pk_bf16_f32 v179, v166, v167
    v_cvt_pk_bf16_f32 v180, v168, v169
    v_cvt_pk_bf16_f32 v181, v170, v171
    v_cvt_pk_bf16_f32 v182, v172, v173
    s_cmp_eq_u32 s100, 0
    s_cbranch_scc1 LS_87_g
    buffer_store_dwordx4 v[176:179], v240, s[36:39], s63 offen
    buffer_store_dwordx4 v[180:183], v240, s[36:39], s63 offen offset:1024
LS_87_r:

    s_and_b32 s56, s2, 7
    s_lshl_b32 s56, s56, 2
    s_lshr_b32 s57, s2, 3
    s_add_u32 s56, s56, s57
    s_sub_u32 s56, s56, 28
    s_lshl_b32 s56, s56, 2
    s_add_u32 s56, s56, s3

    s_waitcnt vmcnt(0)
    s_barrier

    s_cmp_eq_u32 s50, 1
    s_cbranch_scc0 L_h0

    s_lshr_b32 s64, s2, 3
    s_sub_u32 s64, s64, 28
    s_and_b32 s65, s2, 7
    v_mul_u32_u24 v12, 37, v244
    v_lshrrev_b32 v12, 8, v12
    v_mul_u32_u24 v13, 7, v12
    v_sub_u32 v13, v244, v13
    v_min_u32_e64 v12, 7, v12
    v_mul_u32_u24 v12, 3584, v12
    v_lshl_add_u32 v12, v13, 7, v12
    v_lshrrev_b32 v13, 2, v244
    v_lshlrev_b32 v13, 12, v13
    v_and_b32_e64 v14, 3, v244
    v_lshl_add_u32 v13, v14, 7, v13

    s_mul_i32 s66, s64, 1835008
    s_mul_i32 s67, s3, 114688
    s_add_u32 s66, s66, s67
    s_lshr_b32 s67, s65, 1
    s_mul_i32 s67, s67, 896
    s_add_u32 s66, s66, s67

    s_nop 0
    s_add_u32 s67, s66, 458752
    buffer_load_dword v15, v12, s[16:19], s67 offen
    s_add_u32 s67, s66, 487424
    buffer_load_dword v15, v12, s[16:19], s67 offen
    s_add_u32 s67, s66, 516096
    buffer_load_dword v15, v12, s[16:19], s67 offen
    s_add_u32 s67, s66, 544768
    buffer_load_dword v15, v12, s[16:19], s67 offen

    s_mul_i32 s66, s64, 1835008
    s_mul_i32 s67, s3, 196608
    s_add_u32 s66, s66, s67
    s_lshl_b32 s67, s65, 9
    s_add_u32 s66, s66, s67

    s_nop 0
    s_add_u32 s67, s66, 1048576
    buffer_load_dword v15, v13, s[20:23], s67 offen
    s_add_u32 s67, s66, 1114112
    buffer_load_dword v15, v13, s[20:23], s67 offen
    s_add_u32 s67, s66, 1179648
    buffer_load_dword v15, v13, s[20:23], s67 offen
    s_branch L_fin
L_h0:

    v_lshrrev_b32 v4, 2, v244
    v_mul_u32_u24 v4, 2688, v4
    v_and_b32_e64 v5, 3, v244
    v_lshl_add_u32 v4, v5, 4, v4
    v_mov_b32 v8, -1
    v_mov_b32 v9, -1
    v_mov_b32 v10, -1
    v_mov_b32 v11, -1
    v_lshlrev_b32 v6, 7, v244

    s_add_u32 s57, s56, 0
    s_min_u32 s57, s57, 1343
    s_mul_i32 s58, s57, 3121
    s_lshr_b32 s58, s58, 18
    s_mul_i32 s59, s58, 84
    s_sub_u32 s59, s57, s59
    s_mul_i32 s58, s58, 56
    s_and_b32 s58, s58, 0xfff0
    s_lshr_b32 s60, s59, 1
    s_and_b32 s61, s59, 1
    s_add_u32 s61, s61, 1
    s_sub_u32 s62, s59, 56
    s_cmp_lt_u32 s59, 56
    s_cselect_b32 s60, s60, s62
    s_cselect_b32 s61, s61, 0
    s_mul_i32 s60, s60, 43008
    s_mul_i32 s61, s61, 896
    s_add_u32 s58, s58, s60
    s_add_u32 s58, s58, s61
    buffer_load_dwordx4 v[16:19], v4, s[8:11], s58 offen

    s_add_u32 s57, s56, 128
    s_min_u32 s57, s57, 1343
    s_mul_i32 s58, s57, 3121
    s_lshr_b32 s58, s58, 18
    s_mul_i32 s59, s58, 84
    s_sub_u32 s59, s57, s59
    s_mul_i32 s58, s58, 56
    s_and_b32 s58, s58, 0xfff0
    s_lshr_b32 s60, s59, 1
    s_and_b32 s61, s59, 1
    s_add_u32 s61, s61, 1
    s_sub_u32 s62, s59, 56
    s_cmp_lt_u32 s59, 56
    s_cselect_b32 s60, s60, s62
    s_cselect_b32 s61, s61, 0
    s_mul_i32 s60, s60, 43008
    s_mul_i32 s61, s61, 896
    s_add_u32 s58, s58, s60
    s_add_u32 s58, s58, s61
    buffer_load_dwordx4 v[20:23], v4, s[8:11], s58 offen

    s_add_u32 s57, s56, 256
    s_min_u32 s57, s57, 1343
    s_mul_i32 s58, s57, 3121
    s_lshr_b32 s58, s58, 18
    s_mul_i32 s59, s58, 84
    s_sub_u32 s59, s57, s59
    s_mul_i32 s58, s58, 56
    s_and_b32 s58, s58, 0xfff0
    s_lshr_b32 s60, s59, 1
    s_and_b32 s61, s59, 1
    s_add_u32 s61, s61, 1
    s_sub_u32 s62, s59, 56
    s_cmp_lt_u32 s59, 56
    s_cselect_b32 s60, s60, s62
    s_cselect_b32 s61, s61, 0
    s_mul_i32 s60, s60, 43008
    s_mul_i32 s61, s61, 896
    s_add_u32 s58, s58, s60
    s_add_u32 s58, s58, s61
    buffer_load_dwordx4 v[24:27], v4, s[8:11], s58 offen

    s_add_u32 s57, s56, 384
    s_min_u32 s57, s57, 1343
    s_mul_i32 s58, s57, 3121
    s_lshr_b32 s58, s58, 18
    s_mul_i32 s59, s58, 84
    s_sub_u32 s59, s57, s59
    s_mul_i32 s58, s58, 56
    s_and_b32 s58, s58, 0xfff0
    s_lshr_b32 s60, s59, 1
    s_and_b32 s61, s59, 1
    s_add_u32 s61, s61, 1
    s_sub_u32 s62, s59, 56
    s_cmp_lt_u32 s59, 56
    s_cselect_b32 s60, s60, s62
    s_cselect_b32 s61, s61, 0
    s_mul_i32 s60, s60, 43008
    s_mul_i32 s61, s61, 896
    s_add_u32 s58, s58, s60
    s_add_u32 s58, s58, s61
    buffer_load_dwordx4 v[28:31], v4, s[8:11], s58 offen

    s_add_u32 s57, s56, 512
    s_min_u32 s57, s57, 1343
    s_mul_i32 s58, s57, 3121
    s_lshr_b32 s58, s58, 18
    s_mul_i32 s59, s58, 84
    s_sub_u32 s59, s57, s59
    s_mul_i32 s58, s58, 56
    s_and_b32 s58, s58, 0xfff0
    s_lshr_b32 s60, s59, 1
    s_and_b32 s61, s59, 1
    s_add_u32 s61, s61, 1
    s_sub_u32 s62, s59, 56
    s_cmp_lt_u32 s59, 56
    s_cselect_b32 s60, s60, s62
    s_cselect_b32 s61, s61, 0
    s_mul_i32 s60, s60, 43008
    s_mul_i32 s61, s61, 896
    s_add_u32 s58, s58, s60
    s_add_u32 s58, s58, s61
    buffer_load_dwordx4 v[32:35], v4, s[8:11], s58 offen

    s_add_u32 s57, s56, 640
    s_min_u32 s57, s57, 1343
    s_mul_i32 s58, s57, 3121
    s_lshr_b32 s58, s58, 18
    s_mul_i32 s59, s58, 84
    s_sub_u32 s59, s57, s59
    s_mul_i32 s58, s58, 56
    s_and_b32 s58, s58, 0xfff0
    s_lshr_b32 s60, s59, 1
    s_and_b32 s61, s59, 1
    s_add_u32 s61, s61, 1
    s_sub_u32 s62, s59, 56
    s_cmp_lt_u32 s59, 56
    s_cselect_b32 s60, s60, s62
    s_cselect_b32 s61, s61, 0
    s_mul_i32 s60, s60, 43008
    s_mul_i32 s61, s61, 896
    s_add_u32 s58, s58, s60
    s_add_u32 s58, s58, s61
    buffer_load_dwordx4 v[36:39], v4, s[8:11], s58 offen

    s_add_u32 s57, s56, 768
    s_min_u32 s57, s57, 1343
    s_mul_i32 s58, s57, 3121
    s_lshr_b32 s58, s58, 18
    s_mul_i32 s59, s58, 84
    s_sub_u32 s59, s57, s59
    s_mul_i32 s58, s58, 56
    s_and_b32 s58, s58, 0xfff0
    s_lshr_b32 s60, s59, 1
    s_and_b32 s61, s59, 1
    s_add_u32 s61, s61, 1
    s_sub_u32 s62, s59, 56
    s_cmp_lt_u32 s59, 56
    s_cselect_b32 s60, s60, s62
    s_cselect_b32 s61, s61, 0
    s_mul_i32 s60, s60, 43008
    s_mul_i32 s61, s61, 896
    s_add_u32 s58, s58, s60
    s_add_u32 s58, s58, s61
    buffer_load_dwordx4 v[40:43], v4, s[8:11], s58 offen

    s_add_u32 s57, s56, 896
    s_min_u32 s57, s57, 1343
    s_mul_i32 s58, s57, 3121
    s_lshr_b32 s58, s58, 18
    s_mul_i32 s59, s58, 84
    s_sub_u32 s59, s57, s59
    s_mul_i32 s58, s58, 56
    s_and_b32 s58, s58, 0xfff0
    s_lshr_b32 s60, s59, 1
    s_and_b32 s61, s59, 1
    s_add_u32 s61, s61, 1
    s_sub_u32 s62, s59, 56
    s_cmp_lt_u32 s59, 56
    s_cselect_b32 s60, s60, s62
    s_cselect_b32 s61, s61, 0
    s_mul_i32 s60, s60, 43008
    s_mul_i32 s61, s61, 896
    s_add_u32 s58, s58, s60
    s_add_u32 s58, s58, s61
    buffer_load_dwordx4 v[44:47], v4, s[8:11], s58 offen

    s_add_u32 s57, s56, 1024
    s_min_u32 s57, s57, 1343
    s_mul_i32 s58, s57, 3121
    s_lshr_b32 s58, s58, 18
    s_mul_i32 s59, s58, 84
    s_sub_u32 s59, s57, s59
    s_mul_i32 s58, s58, 56
    s_and_b32 s58, s58, 0xfff0
    s_lshr_b32 s60, s59, 1
    s_and_b32 s61, s59, 1
    s_add_u32 s61, s61, 1
    s_sub_u32 s62, s59, 56
    s_cmp_lt_u32 s59, 56
    s_cselect_b32 s60, s60, s62
    s_cselect_b32 s61, s61, 0
    s_mul_i32 s60, s60, 43008
    s_mul_i32 s61, s61, 896
    s_add_u32 s58, s58, s60
    s_add_u32 s58, s58, s61
    buffer_load_dwordx4 v[48:51], v4, s[8:11], s58 offen

    s_add_u32 s57, s56, 1152
    s_min_u32 s57, s57, 1343
    s_mul_i32 s58, s57, 3121
    s_lshr_b32 s58, s58, 18
    s_mul_i32 s59, s58, 84
    s_sub_u32 s59, s57, s59
    s_mul_i32 s58, s58, 56
    s_and_b32 s58, s58, 0xfff0
    s_lshr_b32 s60, s59, 1
    s_and_b32 s61, s59, 1
    s_add_u32 s61, s61, 1
    s_sub_u32 s62, s59, 56
    s_cmp_lt_u32 s59, 56
    s_cselect_b32 s60, s60, s62
    s_cselect_b32 s61, s61, 0
    s_mul_i32 s60, s60, 43008
    s_mul_i32 s61, s61, 896
    s_add_u32 s58, s58, s60
    s_add_u32 s58, s58, s61
    buffer_load_dwordx4 v[52:55], v4, s[8:11], s58 offen

    s_add_u32 s57, s56, 1280
    s_min_u32 s57, s57, 1343
    s_mul_i32 s58, s57, 3121
    s_lshr_b32 s58, s58, 18
    s_mul_i32 s59, s58, 84
    s_sub_u32 s59, s57, s59
    s_mul_i32 s58, s58, 56
    s_and_b32 s58, s58, 0xfff0
    s_lshr_b32 s60, s59, 1
    s_and_b32 s61, s59, 1
    s_add_u32 s61, s61, 1
    s_sub_u32 s62, s59, 56
    s_cmp_lt_u32 s59, 56
    s_cselect_b32 s60, s60, s62
    s_cselect_b32 s61, s61, 0
    s_mul_i32 s60, s60, 43008
    s_mul_i32 s61, s61, 896
    s_add_u32 s58, s58, s60
    s_add_u32 s58, s58, s61
    buffer_load_dwordx4 v[56:59], v4, s[8:11], s58 offen

    s_lshl_b32 s57, s56, 10
    s_add_u32 s57, s57, 4685824
HWF_89:
    buffer_store_dwordx4 v[8:11], v240, s[36:39], s57 offen sc1
    s_add_u32 s57, s57, 131072
    s_cmp_lt_u32 s57, 6291456
    s_cbranch_scc1 HWF_89

    s_waitcnt vmcnt(0)
    s_barrier
    s_cmp_lg_u32 s3, 0
    s_cbranch_scc1 HWS_90
    v_mov_b32 v2, 1
    v_mov_b32 v3, 4
    s_mov_b64 exec, 1
    buffer_atomic_add v2, v3, s[40:43], 0 offen sc1
    s_mov_b64 exec, -1
HWS_90:

    s_add_u32 s57, s56, 0
    s_min_u32 s57, s57, 1343
    s_lshl_b32 s58, s57, 10
    s_add_u32 s58, s58, 16777216
    buffer_store_dwordx4 v[16:19], v240, s[36:39], s58 offen sc1

    s_add_u32 s57, s56, 128
    s_min_u32 s57, s57, 1343
    s_lshl_b32 s58, s57, 10
    s_add_u32 s58, s58, 16777216
    buffer_store_dwordx4 v[20:23], v240, s[36:39], s58 offen sc1

    s_add_u32 s57, s56, 256
    s_min_u32 s57, s57, 1343
    s_lshl_b32 s58, s57, 10
    s_add_u32 s58, s58, 16777216
    buffer_store_dwordx4 v[24:27], v240, s[36:39], s58 offen sc1

    s_add_u32 s57, s56, 384
    s_min_u32 s57, s57, 1343
    s_lshl_b32 s58, s57, 10
    s_add_u32 s58, s58, 16777216
    buffer_store_dwordx4 v[28:31], v240, s[36:39], s58 offen sc1

    s_add_u32 s57, s56, 512
    s_min_u32 s57, s57, 1343
    s_lshl_b32 s58, s57, 10
    s_add_u32 s58, s58, 16777216
    buffer_store_dwordx4 v[32:35], v240, s[36:39], s58 offen sc1

    s_add_u32 s57, s56, 640
    s_min_u32 s57, s57, 1343
    s_lshl_b32 s58, s57, 10
    s_add_u32 s58, s58, 16777216
    buffer_store_dwordx4 v[36:39], v240, s[36:39], s58 offen sc1

    s_add_u32 s57, s56, 768
    s_min_u32 s57, s57, 1343
    s_lshl_b32 s58, s57, 10
    s_add_u32 s58, s58, 16777216
    buffer_store_dwordx4 v[40:43], v240, s[36:39], s58 offen sc1

    s_add_u32 s57, s56, 896
    s_min_u32 s57, s57, 1343
    s_lshl_b32 s58, s57, 10
    s_add_u32 s58, s58, 16777216
    buffer_store_dwordx4 v[44:47], v240, s[36:39], s58 offen sc1

    s_add_u32 s57, s56, 1024
    s_min_u32 s57, s57, 1343
    s_lshl_b32 s58, s57, 10
    s_add_u32 s58, s58, 16777216
    buffer_store_dwordx4 v[48:51], v240, s[36:39], s58 offen sc1

    s_add_u32 s57, s56, 1152
    s_min_u32 s57, s57, 1343
    s_lshl_b32 s58, s57, 10
    s_add_u32 s58, s58, 16777216
    buffer_store_dwordx4 v[52:55], v240, s[36:39], s58 offen sc1

    s_add_u32 s57, s56, 1280
    s_min_u32 s57, s57, 1343
    s_lshl_b32 s58, s57, 10
    s_add_u32 s58, s58, 16777216
    buffer_store_dwordx4 v[56:59], v240, s[36:39], s58 offen sc1

    s_and_b32 s57, s2, 7
    s_mul_i32 s63, s57, 229376
    s_add_u32 s63, s63, 12582912
    s_and_b32 s57, s56, 15
    s_lshl_b32 s57, s57, 10
    s_add_u32 s57, s57, s63
    s_add_u32 s63, s63, 229376
HWL_91:

    s_cmp_eq_u32 s100, 0
    s_cbranch_scc1 LS_92_g
    buffer_store_dwordx4 v[8:11], v240, s[36:39], s57 offen
LS_92_r:

    s_add_u32 s57, s57, 0x4000
    s_cmp_lt_u32 s57, s63
    s_cbranch_scc1 HWL_91

    s_and_b32 s57, s2, 7
    s_mul_i32 s63, s57, 28672
    s_add_u32 s63, s63, 14417920
    s_and_b32 s57, s56, 15
    s_lshl_b32 s57, s57, 10
    s_add_u32 s57, s57, s63
    s_add_u32 s63, s63, 28672
HWL_93:

    s_cmp_eq_u32 s100, 0
    s_cbranch_scc1 LS_94_g
    buffer_store_dwordx4 v[8:11], v240, s[36:39], s57 offen
LS_94_r:

    s_add_u32 s57, s57, 0x4000
    s_cmp_lt_u32 s57, s63
    s_cbranch_scc1 HWL_93

    s_waitcnt vmcnt(0)
    s_barrier
    s_cmp_lg_u32 s3, 0
    s_cbranch_scc1 HWS_95
    v_mov_b32_e64 v2, 1
    v_mov_b32 v3, 68
    s_mov_b64 exec, 1
    buffer_atomic_add v2, v3, s[40:43], 0 offen sc1
    s_mov_b64 exec, -1
HWS_95:

    s_lshl_b32 s57, s56, 13
    s_add_u32 s57, s57, 0
HWW_96:
    buffer_load_dword v7, v6, s[20:23], s57 offen

    s_add_u32 s57, s57, 1048576
    s_cmp_lt_u32 s57, 7340032
    s_cbranch_scc1 HWW_96

    s_lshl_b32 s57, s56, 10
    s_add_u32 s57, s57, 8388608
HWF_97:
    buffer_store_dwordx4 v[8:11], v240, s[36:39], s57 offen sc1
    s_add_u32 s57, s57, 131072
    s_cmp_lt_u32 s57, 8912896
    s_cbranch_scc1 HWF_97

    s_lshl_b32 s57, s56, 10
    s_add_u32 s57, s57, 9142272
HWF_98:
    buffer_store_dwordx4 v[8:11], v240, s[36:39], s57 offen sc1
    s_add_u32 s57, s57, 131072
    s_cmp_lt_u32 s57, 12582912
    s_cbranch_scc1 HWF_98

    s_and_b32 s57, s2, 7
    s_mul_i32 s63, s57, 262144
    s_add_u32 s63, s63, 6291456
    s_and_b32 s57, s56, 15
    s_lshl_b32 s57, s57, 10
    s_add_u32 s57, s57, s63
    s_add_u32 s63, s63, 262144
HWL_99:

    s_cmp_eq_u32 s100, 0
    s_cbranch_scc1 LS_100_g
    buffer_store_dwordx4 v[8:11], v240, s[36:39], s57 offen
LS_100_r:

    s_add_u32 s57, s57, 0x4000
    s_cmp_lt_u32 s57, s63
    s_cbranch_scc1 HWL_99

    s_and_b32 s57, s2, 7
    s_mul_i32 s63, s57, 28672
    s_add_u32 s63, s63, 8912896
    s_and_b32 s57, s56, 15
    s_lshl_b32 s57, s57, 10
    s_add_u32 s57, s57, s63
    s_add_u32 s63, s63, 28672
HWL_101:

    s_cmp_eq_u32 s100, 0
    s_cbranch_scc1 LS_102_g
    buffer_store_dwordx4 v[8:11], v240, s[36:39], s57 offen
LS_102_r:

    s_add_u32 s57, s57, 0x4000
    s_cmp_lt_u32 s57, s63
    s_cbranch_scc1 HWL_101

    s_waitcnt vmcnt(0)
    s_barrier
    s_cmp_lg_u32 s3, 0
    s_cbranch_scc1 HWS_103
    v_mov_b32 v2, 1
    v_mov_b32 v3, 132
    s_mov_b64 exec, 1
    buffer_atomic_add v2, v3, s[40:43], 0 offen sc1
    s_mov_b64 exec, -1
HWS_103:

    v_lshlrev_b32 v3, 6, v244
    s_mov_b64 exec, 1
CW_104_p:
    buffer_load_dword v2, v3, s[40:43], 0 offen offset:68 sc1
    s_waitcnt vmcnt(0)
    v_cmp_gt_u32 vcc, 32, v2
    s_nop 0
    s_cbranch_vccz CW_104_o
    s_cmp_le_i32 s52, 0
    s_cbranch_scc1 CW_104_o
    s_sub_u32 s52, s52, 1
    s_sleep 12
    s_branch CW_104_p
CW_104_o:
    s_mov_b64 exec, -1

    s_barrier

    s_mul_i32 s69, s45, 86016
    s_add_u32 s69, s69, 16777216
    s_lshl_b32 s71, s3, 10
    s_lshl_b32 s70, s3, 14
    s_add_u32 s70, s70, s69
    s_add_u32 s69, s69, s71

    s_add_u32 m0, s55, 0
    s_add_u32 s58, s70, 0
    s_nop 0
    buffer_load_dwordx4 v240, s[36:39], s58 offen sc1 lds
    s_add_u32 m0, s55, 1024
    s_add_u32 s58, s70, 1024
    buffer_load_dwordx4 v240, s[36:39], s58 offen sc1 lds
    s_add_u32 m0, s55, 2048
    s_add_u32 s58, s70, 2048
    buffer_load_dwordx4 v240, s[36:39], s58 offen sc1 lds
    s_add_u32 m0, s55, 3072
    s_add_u32 s58, s70, 3072
    buffer_load_dwordx4 v240, s[36:39], s58 offen sc1 lds
    s_add_u32 m0, s55, 4096
    s_add_u32 s58, s70, 4096
    buffer_load_dwordx4 v240, s[36:39], s58 offen sc1 lds
    s_add_u32 m0, s55, 5120
    s_add_u32 s58, s70, 5120
    buffer_load_dwordx4 v240, s[36:39], s58 offen sc1 lds
    s_add_u32 m0, s55, 6144
    s_add_u32 s58, s70, 6144
    buffer_load_dwordx4 v240, s[36:39], s58 offen sc1 lds
    s_add_u32 m0, s55, 7168
    s_add_u32 s58, s70, 7168
    buffer_load_dwordx4 v240, s[36:39], s58 offen sc1 lds
    s_add_u32 m0, s55, 8192
    s_add_u32 s58, s70, 8192
    buffer_load_dwordx4 v240, s[36:39], s58 offen sc1 lds
    s_add_u32 m0, s55, 9216
    s_add_u32 s58, s70, 9216
    buffer_load_dwordx4 v240, s[36:39], s58 offen sc1 lds
    s_add_u32 m0, s55, 10240
    s_add_u32 s58, s70, 10240
    buffer_load_dwordx4 v240, s[36:39], s58 offen sc1 lds
    s_add_u32 m0, s55, 11264
    s_add_u32 s58, s70, 11264
    buffer_load_dwordx4 v240, s[36:39], s58 offen sc1 lds
    s_add_u32 m0, s55, 12288
    s_add_u32 s58, s70, 12288
    buffer_load_dwordx4 v240, s[36:39], s58 offen sc1 lds
    s_add_u32 m0, s55, 13312
    s_add_u32 s58, s70, 13312
    buffer_load_dwordx4 v240, s[36:39], s58 offen sc1 lds
    s_add_u32 m0, s55, 14336
    s_add_u32 s58, s70, 14336
    buffer_load_dwordx4 v240, s[36:39], s58 offen sc1 lds
    s_add_u32 m0, s55, 15360
    s_add_u32 s58, s70, 15360
    buffer_load_dwordx4 v240, s[36:39], s58 offen sc1 lds
    s_add_u32 m0, s71, 131072
    s_add_u32 s58, s69, 65536
    buffer_load_dwordx4 v240, s[36:39], s58 offen sc1 lds
    s_add_u32 m0, s71, 135168
    s_add_u32 s58, s69, 69632
    buffer_load_dwordx4 v240, s[36:39], s58 offen sc1 lds
    s_add_u32 m0, s71, 139264
    s_add_u32 s58, s69, 73728
    buffer_load_dwordx4 v240, s[36:39], s58 offen sc1 lds
    s_add_u32 m0, s71, 143360
    s_add_u32 s58, s69, 77824
    buffer_load_dwordx4 v240, s[36:39], s58 offen sc1 lds
    s_add_u32 m0, s71, 147456
    s_add_u32 s58, s69, 81920
    buffer_load_dwordx4 v240, s[36:39], s58 offen sc1 lds

    s_lshl_b32 s56, s44, 2
    s_add_u32 s56, s56, s3
    s_mul_i32 s80, s56, 28672
    s_add_u32 s80, s80, 12582912
    s_add_u32 s81, s80, 0x2000
    s_add_u32 s82, s80, 0x4000
    s_add_u32 s83, s80, 0x6000
    s_mul_i32 s84, s56, 3584
    s_add_u32 s84, s84, 14417920

    v_min_u32 v4, 6, v244
    v_lshlrev_b32 v4, 12, v4
    v_add_u32 v4, 2044, v4
    s_waitcnt vmcnt(0)
    s_barrier
    s_branch PB_105_q
PB_105_p:
    s_sleep 6
PB_105_q:
    buffer_load_dword v5, v4, s[36:39], s80 offen sc1
    s_sub_u32 s52, s52, 1
PB_105_c:
    s_waitcnt vmcnt(0)
    v_cmp_eq_u32 vcc, -1, v5

    s_cmp_gt_i32 s52, 0
    s_cselect_b64 vcc, vcc, 0
    s_cbranch_vccnz PB_105_p

    buffer_load_dwordx4 v[72:75], v240, s[36:39], s80 offen offset:0 sc1
    buffer_load_dwordx4 v[76:79], v240, s[36:39], s80 offen offset:1024 sc1
    buffer_load_dwordx4 v[80:83], v241, s[36:39], s80 offen offset:0 sc1
    buffer_load_dwordx4 v[84:87], v241, s[36:39], s80 offen offset:1024 sc1
    buffer_load_dwordx4 v[88:91], v240, s[36:39], s81 offen offset:0 sc1
    buffer_load_dwordx4 v[92:95], v240, s[36:39], s81 offen offset:1024 sc1
    buffer_load_dwordx4 v[96:99], v241, s[36:39], s81 offen offset:0 sc1
    buffer_load_dwordx4 v[100:103], v241, s[36:39], s81 offen offset:1024 sc1
    buffer_load_dwordx4 v[104:107], v240, s[36:39], s82 offen offset:0 sc1
    buffer_load_dwordx4 v[108:111], v240, s[36:39], s82 offen offset:1024 sc1
    buffer_load_dwordx4 v[112:115], v241, s[36:39], s82 offen offset:0 sc1
    buffer_load_dwordx4 v[116:119], v241, s[36:39], s82 offen offset:1024 sc1
    buffer_load_dwordx4 v[120:123], v240, s[36:39], s83 offen offset:0 sc1
    buffer_load_dwordx4 v[124:127], v240, s[36:39], s83 offen offset:1024 sc1
    s_branch L_next
L_fin:
L_end:
    s_endpgm
A1f_3_sg:
    s_lshl_b64 s[76:77], 1, s101
    s_and_b32 s77, s77, 0xffff
    s_or_b32 s77, s77, 0x10000
    s_and_b32 s56, s2, 3
    s_lshl_b32 s56, s56, 6
    s_bfe_u32 s57, s2, 0x10002
    s_lshl_b32 s57, s57, 3
    s_add_u32 s56, s56, s57
    v_mov_b32 v2, s76
    v_mov_b32 v3, s77
    s_mov_b64 exec, 1
    buffer_atomic_add_x2 v[2:3], off, s[40:43], s56 offset:16 sc1
    s_mov_b64 exec, -1
    s_branch A1f_3_sgr
CK_4_r:
    s_cmp_le_i32 s52, 0
    s_cbranch_scc1 CK_4_k
    s_sub_u32 s52, s52, 1
    s_sleep 1
    buffer_load_dwordx4 v[72:75], v240, s[36:39], s80 offen offset:0 sc1
    buffer_load_dwordx4 v[76:79], v240, s[36:39], s80 offen offset:1024 sc1
    buffer_load_dwordx4 v[80:83], v241, s[36:39], s80 offen offset:0 sc1
    buffer_load_dwordx4 v[84:87], v241, s[36:39], s80 offen offset:1024 sc1
    buffer_load_dwordx4 v[88:91], v240, s[36:39], s81 offen offset:0 sc1
    buffer_load_dwordx4 v[92:95], v240, s[36:39], s81 offen offset:1024 sc1
    buffer_load_dwordx4 v[96:99], v241, s[36:39], s81 offen offset:0 sc1
    buffer_load_dwordx4 v[100:103], v241, s[36:39], s81 offen offset:1024 sc1
    buffer_load_dwordx4 v[104:107], v240, s[36:39], s82 offen offset:0 sc1
    buffer_load_dwordx4 v[108:111], v240, s[36:39], s82 offen offset:1024 sc1
    buffer_load_dwordx4 v[112:115], v241, s[36:39], s82 offen offset:0 sc1
    buffer_load_dwordx4 v[116:119], v241, s[36:39], s82 offen offset:1024 sc1
    buffer_load_dwordx4 v[120:123], v240, s[36:39], s83 offen offset:0 sc1
    buffer_load_dwordx4 v[124:127], v240, s[36:39], s83 offen offset:1024 sc1
    s_waitcnt vmcnt(0)
    v_max_u32 v251, v75, v79
    v_max3_u32 v251, v251, v83, v87
    v_cmp_eq_u32 vcc, -1, v251
    s_nop 0
    s_cbranch_vccnz CK_4_r
    s_branch CK_4_k
CK_5_r:
    s_cmp_le_i32 s52, 0
    s_cbranch_scc1 CK_5_k
    s_sub_u32 s52, s52, 1
    s_sleep 1
    buffer_load_dwordx4 v[88:91], v240, s[36:39], s81 offen offset:0 sc1
    buffer_load_dwordx4 v[92:95], v240, s[36:39], s81 offen offset:1024 sc1
    buffer_load_dwordx4 v[96:99], v241, s[36:39], s81 offen offset:0 sc1
    buffer_load_dwordx4 v[100:103], v241, s[36:39], s81 offen offset:1024 sc1
    buffer_load_dwordx4 v[104:107], v240, s[36:39], s82 offen offset:0 sc1
    buffer_load_dwordx4 v[108:111], v240, s[36:39], s82 offen offset:1024 sc1
    buffer_load_dwordx4 v[112:115], v241, s[36:39], s82 offen offset:0 sc1
    buffer_load_dwordx4 v[116:119], v241, s[36:39], s82 offen offset:1024 sc1
    buffer_load_dwordx4 v[120:123], v240, s[36:39], s83 offen offset:0 sc1
    buffer_load_dwordx4 v[124:127], v240, s[36:39], s83 offen offset:1024 sc1
    s_waitcnt vmcnt(0)
    v_max_u32 v251, v91, v95
    v_max3_u32 v251, v251, v99, v103
    v_cmp_eq_u32 vcc, -1, v251
    s_nop 0
    s_cbranch_vccnz CK_5_r
    s_branch CK_5_k
CK_6_r:
    s_cmp_le_i32 s52, 0
    s_cbranch_scc1 CK_6_k
    s_sub_u32 s52, s52, 1
    s_sleep 1
    buffer_load_dwordx4 v[104:107], v240, s[36:39], s82 offen offset:0 sc1
    buffer_load_dwordx4 v[108:111], v240, s[36:39], s82 offen offset:1024 sc1
    buffer_load_dwordx4 v[112:115], v241, s[36:39], s82 offen offset:0 sc1
    buffer_load_dwordx4 v[116:119], v241, s[36:39], s82 offen offset:1024 sc1
    buffer_load_dwordx4 v[120:123], v240, s[36:39], s83 offen offset:0 sc1
    buffer_load_dwordx4 v[124:127], v240, s[36:39], s83 offen offset:1024 sc1
    buffer_load_dwordx4 v[128:131], v240, s[36:39], s80 offen offset:2048 sc1
    buffer_load_dwordx4 v[132:135], v240, s[36:39], s80 offen offset:3072 sc1
    buffer_load_dwordx4 v[136:139], v241, s[36:39], s80 offen offset:2048 sc1
    buffer_load_dwordx4 v[140:143], v241, s[36:39], s80 offen offset:3072 sc1
    buffer_load_dwordx4 v[144:147], v240, s[36:39], s81 offen offset:2048 sc1
    buffer_load_dwordx4 v[148:151], v240, s[36:39], s81 offen offset:3072 sc1
    s_waitcnt vmcnt(0)
    v_max_u32 v251, v107, v111
    v_max3_u32 v251, v251, v115, v119
    v_max3_u32 v251, v251, v123, v127
    v_cmp_eq_u32 vcc, -1, v251
    s_nop 0
    s_cbranch_vccnz CK_6_r
    s_branch CK_6_k
CK_7_r:
    s_cmp_le_i32 s52, 0
    s_cbranch_scc1 CK_7_k
    s_sub_u32 s52, s52, 1
    s_sleep 1
    buffer_load_dwordx4 v[128:131], v240, s[36:39], s80 offen offset:2048 sc1
    buffer_load_dwordx4 v[132:135], v240, s[36:39], s80 offen offset:3072 sc1
    buffer_load_dwordx4 v[136:139], v241, s[36:39], s80 offen offset:2048 sc1
    buffer_load_dwordx4 v[140:143], v241, s[36:39], s80 offen offset:3072 sc1
    buffer_load_dwordx4 v[144:147], v240, s[36:39], s81 offen offset:2048 sc1
    buffer_load_dwordx4 v[148:151], v240, s[36:39], s81 offen offset:3072 sc1
    buffer_load_dwordx4 v[152:155], v241, s[36:39], s81 offen offset:2048 sc1
    buffer_load_dwordx4 v[156:159], v241, s[36:39], s81 offen offset:3072 sc1
    buffer_load_dwordx4 v[160:163], v240, s[36:39], s82 offen offset:2048 sc1
    buffer_load_dwordx4 v[164:167], v240, s[36:39], s82 offen offset:3072 sc1
    buffer_load_dwordx4 v[168:171], v241, s[36:39], s82 offen offset:2048 sc1
    buffer_load_dwordx4 v[172:175], v241, s[36:39], s82 offen offset:3072 sc1
    buffer_load_dwordx4 v[64:67], v240, s[36:39], s83 offen offset:2048 sc1
    buffer_load_dwordx4 v[68:71], v240, s[36:39], s83 offen offset:3072 sc1
    s_waitcnt vmcnt(0)
    v_max_u32 v251, v131, v135
    v_max3_u32 v251, v251, v139, v143
    v_cmp_eq_u32 vcc, -1, v251
    s_nop 0
    s_cbranch_vccnz CK_7_r
    s_branch CK_7_k
CK_8_r:
    s_cmp_le_i32 s52, 0
    s_cbranch_scc1 CK_8_k
    s_sub_u32 s52, s52, 1
    s_sleep 1
    buffer_load_dwordx4 v[144:147], v240, s[36:39], s81 offen offset:2048 sc1
    buffer_load_dwordx4 v[148:151], v240, s[36:39], s81 offen offset:3072 sc1
    buffer_load_dwordx4 v[152:155], v241, s[36:39], s81 offen offset:2048 sc1
    buffer_load_dwordx4 v[156:159], v241, s[36:39], s81 offen offset:3072 sc1
    buffer_load_dwordx4 v[160:163], v240, s[36:39], s82 offen offset:2048 sc1
    buffer_load_dwordx4 v[164:167], v240, s[36:39], s82 offen offset:3072 sc1
    buffer_load_dwordx4 v[168:171], v241, s[36:39], s82 offen offset:2048 sc1
    buffer_load_dwordx4 v[172:175], v241, s[36:39], s82 offen offset:3072 sc1
    buffer_load_dwordx4 v[64:67], v240, s[36:39], s83 offen offset:2048 sc1
    buffer_load_dwordx4 v[68:71], v240, s[36:39], s83 offen offset:3072 sc1
    s_waitcnt vmcnt(0)
    v_max_u32 v251, v147, v151
    v_max3_u32 v251, v251, v155, v159
    v_cmp_eq_u32 vcc, -1, v251
    s_nop 0
    s_cbranch_vccnz CK_8_r
    s_branch CK_8_k
CK_9_r:
    s_cmp_le_i32 s52, 0
    s_cbranch_scc1 CK_9_k
    s_sub_u32 s52, s52, 1
    s_nop 0
    buffer_load_dwordx2 v[72:73], v245, s[36:39], s84 offen offset:0 sc1
    buffer_load_dwordx2 v[74:75], v245, s[36:39], s84 offen offset:512 sc1
    buffer_load_dwordx2 v[76:77], v245, s[36:39], s84 offen offset:1024 sc1
    buffer_load_dwordx2 v[78:79], v245, s[36:39], s84 offen offset:1536 sc1
    buffer_load_dwordx2 v[80:81], v245, s[36:39], s84 offen offset:2048 sc1
    buffer_load_dwordx2 v[82:83], v245, s[36:39], s84 offen offset:2560 sc1
    buffer_load_dwordx2 v[84:85], v245, s[36:39], s84 offen offset:3072 sc1
    s_waitcnt vmcnt(0)
    v_max3_u32 v251, v73, v75, v77
    v_max3_u32 v251, v251, v79, v81
    v_max3_u32 v251, v251, v83, v85
    v_cmp_eq_u32 vcc, -1, v251
    s_nop 0
    s_cbranch_vccnz CK_9_r
    s_branch CK_9_k

CC_10_r:
    s_cmp_le_i32 s52, 0
    s_cbranch_scc1 CC_10_k
    s_sub_u32 s52, s52, 1
    s_sleep 8
    buffer_load_dword v252, v253, s[40:43], 0 offen offset:132 sc1
    s_waitcnt vmcnt(0)
    v_cmp_gt_u32 vcc, 32, v252
    s_nop 0
    s_cbranch_vccnz CC_10_r
    s_branch CC_10_k

CK_11_r:
    s_cmp_le_i32 s52, 0
    s_cbranch_scc1 CK_11_k
    s_sub_u32 s52, s52, 1
    s_sleep 1
    buffer_load_dwordx4 v[160:163], v240, s[36:39], s82 offen offset:2048 sc1
    buffer_load_dwordx4 v[164:167], v240, s[36:39], s82 offen offset:3072 sc1
    buffer_load_dwordx4 v[168:171], v241, s[36:39], s82 offen offset:2048 sc1
    buffer_load_dwordx4 v[172:175], v241, s[36:39], s82 offen offset:3072 sc1
    buffer_load_dwordx4 v[64:67], v240, s[36:39], s83 offen offset:2048 sc1
    buffer_load_dwordx4 v[68:71], v240, s[36:39], s83 offen offset:3072 sc1
    s_waitcnt vmcnt(0)
    v_max_u32 v251, v163, v167
    v_max3_u32 v251, v251, v171, v175
    v_max3_u32 v251, v251, v67, v71
    v_cmp_eq_u32 vcc, -1, v251
    s_nop 0
    s_cbranch_vccnz CK_11_r
    s_branch CK_11_k

LE_12_r:
    s_cmp_le_i32 s52, 0
    s_cbranch_scc1 LE_12_k
    s_sub_u32 s52, s52, 1
    s_sleep 16
    buffer_load_dwordx2 v[228:229], v230, s[40:43], 0 offen offset:16 sc1
    s_waitcnt vmcnt(0)
    v_cmp_gt_u32 vcc, 0x200000, v229
    s_nop 0
    s_cbranch_vccnz LE_12_r
    s_branch LE_12_k

A1_2_le:
    s_waitcnt vmcnt(4)
    s_cmp_lg_u32 s3, 0
    s_cbranch_scc1 A1_2_ler
    v_cmp_gt_u32 vcc, 0x200000, v229
    s_nop 0
    s_cbranch_vccnz LE_12_r
LE_12_k:

    s_and_b32 s56, s2, 7
    v_readlane_b32 s76, v228, s56
    v_readlane_b32 s77, v229, s56
    s_nop 0
    s_and_b32 s77, s77, 0xffff
    s_lshr_b64 s[76:77], s[76:77], s101
    s_and_b32 s76, s76, 63
    s_cmp_eq_u32 s76, 32
    s_cselect_b32 s100, 1, 0

    v_mov_b32 v228, s100
    v_mov_b32 v229, 0x27f00
    ds_write_b32 v229, v228
    s_branch A1_2_ler
A1_2_cq:

    s_lshl_b32 s56, s3, 10
    v_add_u32 v176, s56, v5
    v_add_u32 v177, s56, v8
    v_add_u32 v178, s56, v6
    v_add_u32 v179, s56, v9
    v_mov_b32_e64 v180, 0
    v_mov_b32 v229, 0x27f00
    ds_read_b32 v228, v229

    ds_read_b64_tr_b16 v[196:197], v176 offset:24576
    ds_read_b64_tr_b16 v[198:199], v177 offset:24576
    ds_read_b64_tr_b16 v[200:201], v176 offset:28672
    ds_read_b64_tr_b16 v[202:203], v177 offset:28672
    ds_read_b64_tr_b16 v[204:205], v178 offset:0
    ds_read_b64_tr_b16 v[206:207], v179 offset:0
    ds_read_b64_tr_b16 v[208:209], v178 offset:4096
    ds_read_b64_tr_b16 v[210:211], v179 offset:4096
    ds_read_b64_tr_b16 v[212:213], v178 offset:8192
    ds_read_b64_tr_b16 v[214:215], v179 offset:8192
    ds_read_b64_tr_b16 v[216:217], v178 offset:12288
    ds_read_b64_tr_b16 v[218:219], v179 offset:12288
    ds_read_b64_tr_b16 v[220:221], v178 offset:16384
    ds_read_b64_tr_b16 v[222:223], v179 offset:16384
    s_waitcnt lgkmcnt(0)
    v_readfirstlane_b32 s100, v228
    ds_read_b64_tr_b16 v[32:33], v5 offset:24576
    ds_read_b64_tr_b16 v[34:35], v8 offset:24576
    ds_read_b64_tr_b16 v[36:37], v5 offset:25600
    ds_read_b64_tr_b16 v[38:39], v8 offset:25600
    ds_read_b64_tr_b16 v[40:41], v5 offset:26624
    ds_read_b64_tr_b16 v[42:43], v8 offset:26624
    ds_read_b64_tr_b16 v[44:45], v5 offset:27648
    ds_read_b64_tr_b16 v[46:47], v8 offset:27648
    v_dot2c_f32_bf16 v180, v196, v14
    v_dot2c_f32_bf16 v180, v197, v14
    v_dot2c_f32_bf16 v180, v198, v14
    v_dot2c_f32_bf16 v180, v199, v14
    v_dot2c_f32_bf16 v180, v200, v14
    v_dot2c_f32_bf16 v180, v201, v14
    v_dot2c_f32_bf16 v180, v202, v14
    v_dot2c_f32_bf16 v180, v203, v14
    v_dot2c_f32_bf16 v180, v204, v14
    v_dot2c_f32_bf16 v180, v205, v14
    v_dot2c_f32_bf16 v180, v206, v14
    v_dot2c_f32_bf16 v180, v207, v14
    v_dot2c_f32_bf16 v180, v208, v14
    v_dot2c_f32_bf16 v180, v209, v14
    v_dot2c_f32_bf16 v180, v210, v14
    v_dot2c_f32_bf16 v180, v211, v14
    v_dot2c_f32_bf16 v180, v212, v14
    v_dot2c_f32_bf16 v180, v213, v14
    v_dot2c_f32_bf16 v180, v214, v14
    v_dot2c_f32_bf16 v180, v215, v14
    v_dot2c_f32_bf16 v180, v216, v14
    v_dot2c_f32_bf16 v180, v217, v14
    v_dot2c_f32_bf16 v180, v218, v14
    v_dot2c_f32_bf16 v180, v219, v14
    v_dot2c_f32_bf16 v180, v220, v14
    v_dot2c_f32_bf16 v180, v221, v14
    v_dot2c_f32_bf16 v180, v222, v14
    v_dot2c_f32_bf16 v180, v223, v14

    s_nop 2
    v_mov_b32 v181, v180
    s_nop 1
    v_permlane32_swap_b32 v180, v181
    v_add_f32 v180, v180, v181
    s_waitcnt lgkmcnt(0)
    ds_write_b32 v11, v180

    v_mul_u32_u24 v188, 896, v243
    v_lshl_add_u32 v188, v242, 3, v188
    s_min_u32 s56, s47, 31
    s_lshl_b32 s56, s56, 1
    s_add_u32 s56, s56, s54
    s_mul_i32 s56, s56, 28672
    s_lshl_b32 s57, s46, 7
    s_add_u32 s56, s56, s57
    s_lshl_b32 s57, s53, 6
    s_add_u32 s68, s56, s57

    v_lshrrev_b32 v2, 2, v244
    v_and_b32 v2, 3, v2
    v_mul_u32_u24 v3, 8, v242
    v_add_u32_e64 v2, v2, v3
    v_bfe_u32 v3, v2, 1, 1
    v_xor_b32 v3, s53, v3
    v_lshlrev_b32 v2, 7, v2
    v_lshl_add_u32 v2, v3, 6, v2
    v_lshrrev_b32 v3, 4, v244
    v_and_b32 v3, 1, v3
    v_lshl_add_u32 v2, v3, 5, v2
    v_and_b32_e64 v3, 3, v244
    v_lshl_add_u32 v182, v3, 3, v2
    v_add_u32 v182, s55, v182
    v_xor_b32 v183, 64, v182

    s_lshl_b32 s58, s54, 5
    v_xor_b32 v182, s58, v182
    v_xor_b32 v183, s58, v183
    s_waitcnt vmcnt(6)
    ds_read_b64_tr_b16 v[48:49], v5 offset:28672
    ds_read_b64_tr_b16 v[50:51], v8 offset:28672
    s_waitcnt lgkmcnt(8)
    s_nop 0
    v_mfma_f32_32x32x16_bf16 v[16:31], v[32:35], v[64:67], 0
    ds_read_b64_tr_b16 a[0:1], v182 offset:32768
    ds_read_b64_tr_b16 a[2:3], v182 offset:33280
    buffer_load_dwordx2 v[224:225], v188, s[4:7], s68 offen offset:0
    ds_read_b64_tr_b16 v[52:53], v5 offset:29696
    ds_read_b64_tr_b16 v[54:55], v8 offset:29696
    s_waitcnt lgkmcnt(10)
    s_nop 0
    v_mfma_f32_32x32x16_bf16 v[16:31], v[36:39], v[68:71], v[16:31]
    ds_read_b64_tr_b16 a[4:5], v183 offset:32768
    ds_read_b64_tr_b16 a[6:7], v183 offset:33280
    ds_read_b64_tr_b16 v[56:57], v5 offset:30720
    ds_read_b64_tr_b16 v[58:59], v8 offset:30720
    s_waitcnt lgkmcnt(12)
    s_nop 0
    v_mfma_f32_32x32x16_bf16 v[16:31], v[40:43], v[72:75], v[16:31]
    ds_read_b64_tr_b16 a[8:9], v182 offset:34816
    ds_read_b64_tr_b16 a[10:11], v182 offset:35328
    buffer_load_dwordx2 v[226:227], v188, s[4:7], s68 offen offset:16
    ds_read_b64_tr_b16 v[60:61], v5 offset:31744
    ds_read_b64_tr_b16 v[62:63], v8 offset:31744
    s_waitcnt lgkmcnt(14)
    s_nop 0
    v_mfma_f32_32x32x16_bf16 v[16:31], v[44:47], v[76:79], v[16:31]
    ds_read_b64_tr_b16 a[12:13], v183 offset:34816
    ds_read_b64_tr_b16 a[14:15], v183 offset:35328
    ds_read_b64_tr_b16 v[32:33], v6 offset:0
    ds_read_b64_tr_b16 v[34:35], v9 offset:0
    s_waitcnt lgkmcnt(15)
    s_nop 0
    v_mfma_f32_32x32x16_bf16 v[16:31], v[48:51], v[80:83], v[16:31]
    ds_read_b64_tr_b16 a[16:17], v182 offset:36864
    ds_read_b64_tr_b16 a[18:19], v182 offset:37376
    buffer_load_dwordx2 v[236:237], v188, s[4:7], s68 offen offset:32
    ds_read_b64_tr_b16 v[36:37], v6 offset:1024
    ds_read_b64_tr_b16 v[38:39], v9 offset:1024
    s_waitcnt lgkmcnt(15)
    s_nop 0
    v_mfma_f32_32x32x16_bf16 v[16:31], v[52:55], v[84:87], v[16:31]
    ds_read_b64_tr_b16 a[20:21], v183 offset:36864
    ds_read_b64_tr_b16 a[22:23], v183 offset:37376
    ds_read_b64_tr_b16 v[40:41], v6 offset:2048
    ds_read_b64_tr_b16 v[42:43], v9 offset:2048
    s_waitcnt lgkmcnt(15)
    s_nop 0
    v_mfma_f32_32x32x16_bf16 v[16:31], v[56:59], v[88:91], v[16:31]
    ds_read_b64_tr_b16 a[24:25], v182 offset:38912
    ds_read_b64_tr_b16 a[26:27], v182 offset:39424
    buffer_load_dwordx2 v[238:239], v188, s[4:7], s68 offen offset:48
    ds_read_b64_tr_b16 v[44:45], v6 offset:3072
    ds_read_b64_tr_b16 v[46:47], v9 offset:3072
    s_waitcnt lgkmcnt(15)
    s_nop 0
    v_mfma_f32_32x32x16_bf16 v[16:31], v[60:63], v[92:95], v[16:31]
    ds_read_b64_tr_b16 a[28:29], v183 offset:38912
    ds_read_b64_tr_b16 a[30:31], v183 offset:39424
    ds_read_b64_tr_b16 v[48:49], v6 offset:4096
    ds_read_b64_tr_b16 v[50:51], v9 offset:4096
    s_waitcnt lgkmcnt(15)
    v_mfma_f32_32x32x16_bf16 v[16:31], v[32:35], v[96:99], v[16:31]
    ds_read_b64_tr_b16 a[32:33], v182 offset:40960
    ds_read_b64_tr_b16 a[34:35], v182 offset:41472
    s_add_u32 m0, s69, 0
    s_add_u32 s58, s72, 1376256
    buffer_load_dwordx4 v246, s[16:19], s58 offen lds
    ds_read_b64_tr_b16 v[52:53], v6 offset:5120
    ds_read_b64_tr_b16 v[54:55], v9 offset:5120
    s_waitcnt lgkmcnt(15)
    s_nop 0
    v_mfma_f32_32x32x16_bf16 v[16:31], v[36:39], v[100:103], v[16:31]
    ds_read_b64_tr_b16 a[36:37], v183 offset:40960
    ds_read_b64_tr_b16 a[38:39], v183 offset:41472
    ds_read_b64_tr_b16 v[56:57], v6 offset:6144
    ds_read_b64_tr_b16 v[58:59], v9 offset:6144
    s_waitcnt lgkmcnt(15)
    s_nop 0
    v_mfma_f32_32x32x16_bf16 v[16:31], v[40:43], v[104:107], v[16:31]
    ds_read_b64_tr_b16 a[40:41], v182 offset:43008
    ds_read_b64_tr_b16 a[42:43], v182 offset:43520
    s_add_u32 m0, s69, 1024
    s_add_u32 s58, s72, 1404928
    buffer_load_dwordx4 v246, s[16:19], s58 offen lds
    ds_read_b64_tr_b16 v[60:61], v6 offset:7168
    ds_read_b64_tr_b16 v[62:63], v9 offset:7168
    s_waitcnt lgkmcnt(15)
    s_nop 0
    v_mfma_f32_32x32x16_bf16 v[16:31], v[44:47], v[108:111], v[16:31]
    ds_read_b64_tr_b16 a[44:45], v183 offset:43008
    ds_read_b64_tr_b16 a[46:47], v183 offset:43520
    ds_read_b64_tr_b16 v[32:33], v6 offset:8192
    ds_read_b64_tr_b16 v[34:35], v9 offset:8192
    s_waitcnt lgkmcnt(15)
    s_nop 0
    v_mfma_f32_32x32x16_bf16 v[16:31], v[48:51], v[112:115], v[16:31]
    ds_read_b64_tr_b16 a[48:49], v182 offset:45056
    ds_read_b64_tr_b16 a[50:51], v182 offset:45568
    s_add_u32 m0, s69, 2048
    s_add_u32 s58, s72, 1433600
    buffer_load_dwordx4 v246, s[16:19], s58 offen lds
    ds_read_b64_tr_b16 v[36:37], v6 offset:9216
    ds_read_b64_tr_b16 v[38:39], v9 offset:9216
    s_waitcnt lgkmcnt(15)
    s_nop 0
    v_mfma_f32_32x32x16_bf16 v[16:31], v[52:55], v[116:119], v[16:31]
    ds_read_b64_tr_b16 a[52:53], v183 offset:45056
    ds_read_b64_tr_b16 a[54:55], v183 offset:45568
    ds_read_b64_tr_b16 v[40:41], v6 offset:10240
    ds_read_b64_tr_b16 v[42:43], v9 offset:10240
    s_waitcnt lgkmcnt(15)
    s_nop 0
    v_mfma_f32_32x32x16_bf16 v[16:31], v[56:59], v[120:123], v[16:31]
    ds_read_b64_tr_b16 a[56:57], v182 offset:47104
    ds_read_b64_tr_b16 a[58:59], v182 offset:47616
    s_add_u32 m0, s69, 3072
    s_add_u32 s58, s72, 1462272
    buffer_load_dwordx4 v246, s[16:19], s58 offen lds
    ds_read_b64_tr_b16 v[44:45], v6 offset:11264
    ds_read_b64_tr_b16 v[46:47], v9 offset:11264
    s_waitcnt lgkmcnt(15)
    s_nop 0
    v_mfma_f32_32x32x16_bf16 v[16:31], v[60:63], v[124:127], v[16:31]
    ds_read_b64_tr_b16 a[60:61], v183 offset:47104
    ds_read_b64_tr_b16 a[62:63], v183 offset:47616
    ds_read_b64_tr_b16 v[48:49], v6 offset:12288
    ds_read_b64_tr_b16 v[50:51], v9 offset:12288
    s_waitcnt lgkmcnt(15)
    s_nop 0
    v_mfma_f32_32x32x16_bf16 v[16:31], v[32:35], v[128:131], v[16:31]
    s_add_u32 m0, s69, 4096
    s_add_u32 s58, s72, 1490944
    buffer_load_dwordx4 v246, s[16:19], s58 offen lds
    ds_read_b64_tr_b16 v[52:53], v6 offset:13312
    ds_read_b64_tr_b16 v[54:55], v9 offset:13312
    s_waitcnt lgkmcnt(14)
    v_mfma_f32_32x32x16_bf16 v[16:31], v[36:39], v[132:135], v[16:31]
    ds_read_b64_tr_b16 v[56:57], v6 offset:14336
    ds_read_b64_tr_b16 v[58:59], v9 offset:14336
    s_waitcnt lgkmcnt(12)
    v_mfma_f32_32x32x16_bf16 v[16:31], v[40:43], v[136:139], v[16:31]
    s_add_u32 m0, s69, 5120
    s_add_u32 s58, s72, 1519616
    buffer_load_dwordx4 v246, s[16:19], s58 offen lds
    ds_read_b64_tr_b16 v[60:61], v6 offset:15360
    ds_read_b64_tr_b16 v[62:63], v9 offset:15360
    s_waitcnt lgkmcnt(10)
    v_mfma_f32_32x32x16_bf16 v[16:31], v[44:47], v[140:143], v[16:31]
    ds_read_b64_tr_b16 v[32:33], v6 offset:16384
    ds_read_b64_tr_b16 v[34:35], v9 offset:16384
    s_waitcnt lgkmcnt(8)
    v_mfma_f32_32x32x16_bf16 v[16:31], v[48:51], v[144:147], v[16:31]
    s_add_u32 m0, s69, 6144
    s_add_u32 s58, s72, 1548288
    buffer_load_dwordx4 v246, s[16:19], s58 offen lds
    ds_read_b64_tr_b16 v[36:37], v6 offset:17408
    ds_read_b64_tr_b16 v[38:39], v9 offset:17408
    s_waitcnt lgkmcnt(8)
    v_mfma_f32_32x32x16_bf16 v[16:31], v[52:55], v[148:151], v[16:31]
    ds_read_b64_tr_b16 v[40:41], v6 offset:18432
    ds_read_b64_tr_b16 v[42:43], v9 offset:18432
    s_waitcnt lgkmcnt(8)
    v_mfma_f32_32x32x16_bf16 v[16:31], v[56:59], v[152:155], v[16:31]
    s_add_u32 m0, s69, 7168
    s_add_u32 s58, s72, 1576960
    buffer_load_dwordx4 v246, s[16:19], s58 offen lds
    ds_read_b64_tr_b16 v[44:45], v6 offset:19456
    ds_read_b64_tr_b16 v[46:47], v9 offset:19456
    s_waitcnt lgkmcnt(8)
    v_mfma_f32_32x32x16_bf16 v[16:31], v[60:63], v[156:159], v[16:31]
    s_waitcnt lgkmcnt(6)
    v_mfma_f32_32x32x16_bf16 v[16:31], v[32:35], v[160:163], v[16:31]
    s_waitcnt lgkmcnt(4)
    v_mfma_f32_32x32x16_bf16 v[16:31], v[36:39], v[164:167], v[16:31]
    s_waitcnt lgkmcnt(2)
    v_mfma_f32_32x32x16_bf16 v[16:31], v[40:43], v[168:171], v[16:31]
    s_waitcnt lgkmcnt(0)
    v_mfma_f32_32x32x16_bf16 v[16:31], v[44:47], v[172:175], v[16:31]
    s_waitcnt lgkmcnt(0)

    s_barrier
    ds_read_b128 v[196:199], v10
    v_lshlrev_b32 v200, 2, v243
    v_add_u32 v200, 159744, v200
    s_add_u32 s79, s69, 0x20000
    s_cmp_eq_u32 s3, 3
    s_cselect_b32 s79, 0x16000, s79

    s_add_u32 s58, s62, 0
    buffer_load_dwordx2 v[160:161], v245, s[36:39], s58 offen offset:0 sc1
    buffer_load_dwordx2 v[162:163], v245, s[36:39], s58 offen offset:2048 sc1
    s_add_u32 s58, s62, 4096
    buffer_load_dwordx2 v[164:165], v245, s[36:39], s58 offen offset:0 sc1
    buffer_load_dwordx2 v[166:167], v245, s[36:39], s58 offen offset:2048 sc1
    s_add_u32 s58, s62, 8192
    buffer_load_dwordx2 v[168:169], v245, s[36:39], s58 offen offset:0 sc1
    buffer_load_dwordx2 v[170:171], v245, s[36:39], s58 offen offset:2048 sc1
    s_add_u32 s58, s62, 12288
    buffer_load_dwordx2 v[172:173], v245, s[36:39], s58 offen offset:0 sc1
    buffer_load_dwordx2 v[174:175], v245, s[36:39], s58 offen offset:2048 sc1
    s_add_u32 s58, s62, 16384
    buffer_load_dwordx2 v[176:177], v245, s[36:39], s58 offen offset:0 sc1
    buffer_load_dwordx2 v[178:179], v245, s[36:39], s58 offen offset:2048 sc1
    s_add_u32 s58, s62, 20480
    buffer_load_dwordx2 v[180:181], v245, s[36:39], s58 offen offset:0 sc1
    buffer_load_dwordx2 v[182:183], v245, s[36:39], s58 offen offset:2048 sc1
    s_add_u32 s58, s62, 24576
    buffer_load_dwordx2 v[184:185], v245, s[36:39], s58 offen offset:0 sc1
    buffer_load_dwordx2 v[186:187], v245, s[36:39], s58 offen offset:2048 sc1
    s_add_u32 s58, s62, 28672
    buffer_load_dwordx2 v[188:189], v245, s[36:39], s58 offen offset:0 sc1
    buffer_load_dwordx2 v[190:191], v245, s[36:39], s58 offen offset:2048 sc1

    s_waitcnt lgkmcnt(0)
    v_add_f32 v196, v196, v197
    v_add_f32 v198, v198, v199
    v_add_f32 v196, v196, v198
    ds_write_b32 v200, v196
    s_branch A1_2_cqr

A2_13_s0:
    s_add_u32 m0, s75, 32768
    s_add_u32 s58, s74, 0
    buffer_load_dwordx4 v250, s[12:15], s58 offen lds
    s_add_u32 m0, s75, 34816
    s_add_u32 s58, s74, 14336
    buffer_load_dwordx4 v250, s[12:15], s58 offen lds
    s_add_u32 m0, s75, 36864
    s_add_u32 s58, s74, 28672
    buffer_load_dwordx4 v250, s[12:15], s58 offen lds
    s_add_u32 m0, s75, 38912
    s_add_u32 s58, s74, 43008
    buffer_load_dwordx4 v250, s[12:15], s58 offen lds
    s_add_u32 m0, s75, 40960
    s_add_u32 s58, s74, 57344
    buffer_load_dwordx4 v250, s[12:15], s58 offen lds
    s_add_u32 m0, s75, 43008
    s_add_u32 s58, s74, 71680
    buffer_load_dwordx4 v250, s[12:15], s58 offen lds
    s_add_u32 m0, s75, 45056
    s_add_u32 s58, s74, 86016
    buffer_load_dwordx4 v250, s[12:15], s58 offen lds
    s_add_u32 m0, s75, 47104
    s_add_u32 s58, s74, 100352
    buffer_load_dwordx4 v250, s[12:15], s58 offen lds
    s_add_u32 m0, s75, 49152
    s_add_u32 s58, s74, 114688
    buffer_load_dwordx4 v250, s[12:15], s58 offen lds
    s_add_u32 m0, s75, 51200
    s_add_u32 s58, s74, 129024
    buffer_load_dwordx4 v250, s[12:15], s58 offen lds
    s_add_u32 m0, s75, 53248
    s_add_u32 s58, s74, 143360
    buffer_load_dwordx4 v250, s[12:15], s58 offen lds
    s_add_u32 m0, s75, 55296
    s_add_u32 s58, s74, 157696
    buffer_load_dwordx4 v250, s[12:15], s58 offen lds
    s_add_u32 m0, s75, 57344
    s_add_u32 s58, s74, 172032
    buffer_load_dwordx4 v250, s[12:15], s58 offen lds
    s_add_u32 m0, s75, 59392
    s_add_u32 s58, s74, 186368
    buffer_load_dwordx4 v250, s[12:15], s58 offen lds
    s_add_u32 m0, s75, 61440
    s_add_u32 s58, s74, 200704
    buffer_load_dwordx4 v250, s[12:15], s58 offen lds
    s_add_u32 m0, s79, 0
    s_nop 0
    s_add_u32 s58, s72, 1605632
    buffer_load_dwordx4 v246, s[16:19], s58 offen lds
    s_add_u32 m0, s79, 1024
    s_add_u32 s58, s72, 1634304
    buffer_load_dwordx4 v246, s[16:19], s58 offen lds
    s_add_u32 m0, s79, 2048
    s_add_u32 s58, s72, 1662976
    buffer_load_dwordx4 v246, s[16:19], s58 offen lds
    s_add_u32 m0, s79, 3072
    s_add_u32 s58, s72, 1691648
    buffer_load_dwordx4 v246, s[16:19], s58 offen lds
    s_add_u32 m0, s79, 4096
    s_add_u32 s58, s72, 1720320
    buffer_load_dwordx4 v246, s[16:19], s58 offen lds
    s_add_u32 m0, s79, 5120
    s_add_u32 s58, s72, 1748992
    buffer_load_dwordx4 v246, s[16:19], s58 offen lds
    s_add_u32 m0, s79, 6144
    s_add_u32 s58, s72, 1777664
    buffer_load_dwordx4 v246, s[16:19], s58 offen lds
    s_add_u32 m0, s79, 7168
    s_add_u32 s58, s72, 1806336
    buffer_load_dwordx4 v246, s[16:19], s58 offen lds

    v_lshrrev_b32 v2, 2, v244
    v_and_b32 v2, 3, v2
    v_mul_u32_u24 v3, 8, v242
    v_add_u32 v2, v2, v3
    v_bfe_u32 v3, v2, 1, 1
    v_xor_b32 v3, s53, v3
    v_lshlrev_b32 v2, 7, v2
    v_lshl_add_u32 v2, v3, 6, v2
    v_lshrrev_b32 v3, 4, v244
    v_and_b32 v3, 1, v3
    v_lshl_add_u32 v2, v3, 5, v2
    v_and_b32_e64 v3, 3, v244
    v_lshl_add_u32 v14, v3, 3, v2
    v_add_u32 v14, s55, v14
    v_xor_b32 v15, 64, v14

    s_lshl_b32 s58, s54, 5
    v_xor_b32 v14, s58, v14
    v_xor_b32 v15, s58, v15
    s_lshl_b32 s67, s3, 13
    s_sub_u32 s67, s67, s55
    v_add_u32 v12, s67, v14
    v_add_u32 v13, s67, v15
    s_waitcnt vmcnt(39)
    ds_read_b64_tr_b16 a[64:65], v12 offset:0
    ds_read_b64_tr_b16 a[66:67], v12 offset:512
    ds_read_b64_tr_b16 a[68:69], v13 offset:0
    ds_read_b64_tr_b16 a[70:71], v13 offset:512
    ds_read_b64_tr_b16 a[72:73], v12 offset:2048
    ds_read_b64_tr_b16 a[74:75], v12 offset:2560
    ds_read_b64_tr_b16 a[76:77], v13 offset:2048
    ds_read_b64_tr_b16 a[78:79], v13 offset:2560
    ds_read_b64_tr_b16 a[80:81], v12 offset:4096
    ds_read_b64_tr_b16 a[82:83], v12 offset:4608
    ds_read_b64_tr_b16 a[84:85], v13 offset:4096
    ds_read_b64_tr_b16 a[86:87], v13 offset:4608
    ds_read_b64_tr_b16 a[88:89], v12 offset:6144
    ds_read_b64_tr_b16 a[90:91], v12 offset:6656
    ds_read_b64_tr_b16 a[92:93], v13 offset:6144
    ds_read_b64_tr_b16 a[94:95], v13 offset:6656
    v_lshlrev_b32_e64 v16, 16, v224
    v_and_b32 v17, 0xffff0000, v224
    v_lshlrev_b32_e64 v18, 16, v225
    v_and_b32 v19, 0xffff0000, v225
    v_lshlrev_b32_e64 v20, 16, v226
    v_and_b32 v21, 0xffff0000, v226
    v_lshlrev_b32_e64 v22, 16, v227
    v_and_b32 v23, 0xffff0000, v227
    v_lshlrev_b32_e64 v24, 16, v236
    v_and_b32 v25, 0xffff0000, v236
    v_lshlrev_b32_e64 v26, 16, v237
    v_and_b32 v27, 0xffff0000, v237
    v_lshlrev_b32_e64 v28, 16, v238
    v_and_b32 v29, 0xffff0000, v238
    v_lshlrev_b32_e64 v30, 16, v239
    v_and_b32 v31, 0xffff0000, v239
    s_waitcnt vmcnt(23)
    s_branch A2_13_s0r
CK_14_r:
    s_cmp_le_i32 s52, 0
    s_cbranch_scc1 CK_14_k
    s_sub_u32 s52, s52, 1
    s_sleep 5
    s_add_u32 s58, s62, 0
    s_nop 0
    buffer_load_dwordx2 v[160:161], v245, s[36:39], s58 offen offset:0 sc1
    buffer_load_dwordx2 v[162:163], v245, s[36:39], s58 offen offset:2048 sc1
    s_add_u32 s58, s62, 4096
    buffer_load_dwordx2 v[164:165], v245, s[36:39], s58 offen offset:0 sc1
    buffer_load_dwordx2 v[166:167], v245, s[36:39], s58 offen offset:2048 sc1
    s_add_u32 s58, s62, 8192
    buffer_load_dwordx2 v[168:169], v245, s[36:39], s58 offen offset:0 sc1
    buffer_load_dwordx2 v[170:171], v245, s[36:39], s58 offen offset:2048 sc1
    s_add_u32 s58, s62, 12288
    buffer_load_dwordx2 v[172:173], v245, s[36:39], s58 offen offset:0 sc1
    buffer_load_dwordx2 v[174:175], v245, s[36:39], s58 offen offset:2048 sc1
    s_add_u32 s58, s62, 16384
    buffer_load_dwordx2 v[176:177], v245, s[36:39], s58 offen offset:0 sc1
    buffer_load_dwordx2 v[178:179], v245, s[36:39], s58 offen offset:2048 sc1
    s_add_u32 s58, s62, 20480
    buffer_load_dwordx2 v[180:181], v245, s[36:39], s58 offen offset:0 sc1
    buffer_load_dwordx2 v[182:183], v245, s[36:39], s58 offen offset:2048 sc1
    s_add_u32 s58, s62, 24576
    buffer_load_dwordx2 v[184:185], v245, s[36:39], s58 offen offset:0 sc1
    buffer_load_dwordx2 v[186:187], v245, s[36:39], s58 offen offset:2048 sc1
    s_add_u32 s58, s62, 28672
    buffer_load_dwordx2 v[188:189], v245, s[36:39], s58 offen offset:0 sc1
    buffer_load_dwordx2 v[190:191], v245, s[36:39], s58 offen offset:2048 sc1
    s_waitcnt vmcnt(0)
    v_max_u32 v251, v161, v163
    v_max3_u32 v251, v251, v165, v167
    v_max3_u32 v251, v251, v169, v171
    v_max3_u32 v251, v251, v173, v175
    v_max3_u32 v251, v251, v177, v179
    v_max3_u32 v251, v251, v181, v183
    v_max3_u32 v251, v251, v185, v187
    v_max3_u32 v251, v251, v189, v191
    v_cmp_eq_u32 vcc, -1, v251
    s_nop 0
    s_cbranch_vccnz CK_14_r
    s_branch CK_14_k
LS_15_g:
    buffer_store_dwordx4 v[176:179], v240, s[36:39], s63 offen sc1
    buffer_store_dwordx4 v[180:183], v240, s[36:39], s63 offen offset:1024 sc1
    s_branch LS_15_r
A2_13_s1:
    s_waitcnt vmcnt(16)
    s_barrier
    s_nop 0
    ds_read_b64_tr_b16 v[48:49], v6 offset:0
    ds_read_b64_tr_b16 v[50:51], v6 offset:512
    ds_read_b64_tr_b16 v[52:53], v7 offset:0
    ds_read_b64_tr_b16 v[54:55], v7 offset:512
    ds_read_b64_tr_b16 v[56:57], v6 offset:1024
    ds_read_b64_tr_b16 v[58:59], v6 offset:1536
    ds_read_b64_tr_b16 v[60:61], v7 offset:1024
    ds_read_b64_tr_b16 v[62:63], v7 offset:1536
    ds_read_b64_tr_b16 v[64:65], v6 offset:3584
    ds_read_b64_tr_b16 v[66:67], v6 offset:4096
    ds_read_b64_tr_b16 v[68:69], v7 offset:3584
    ds_read_b64_tr_b16 v[70:71], v7 offset:4096
    ds_read_b64_tr_b16 v[72:73], v6 offset:4608
    ds_read_b64_tr_b16 v[74:75], v6 offset:5120
    ds_read_b64_tr_b16 v[76:77], v7 offset:4608
    ds_read_b64_tr_b16 v[78:79], v7 offset:5120
    ds_read_b64_tr_b16 v[80:81], v6 offset:7168
    ds_read_b64_tr_b16 v[82:83], v6 offset:7680
    ds_read_b64_tr_b16 v[84:85], v7 offset:7168
    ds_read_b64_tr_b16 v[86:87], v7 offset:7680
    ds_read_b64_tr_b16 v[88:89], v6 offset:8192
    ds_read_b64_tr_b16 v[90:91], v6 offset:8704
    ds_read_b64_tr_b16 v[92:93], v7 offset:8192
    ds_read_b64_tr_b16 v[94:95], v7 offset:8704
    ds_read_b64_tr_b16 v[96:97], v6 offset:10752
    ds_read_b64_tr_b16 v[98:99], v6 offset:11264
    ds_read_b64_tr_b16 v[100:101], v7 offset:10752
    ds_read_b64_tr_b16 v[102:103], v7 offset:11264
    ds_read_b64_tr_b16 v[104:105], v6 offset:11776
    ds_read_b64_tr_b16 v[106:107], v6 offset:12288
    ds_read_b64_tr_b16 v[108:109], v7 offset:11776
    ds_read_b64_tr_b16 v[110:111], v7 offset:12288
    ds_read_b64_tr_b16 v[112:113], v6 offset:14336
    ds_read_b64_tr_b16 v[114:115], v6 offset:14848
    ds_read_b64_tr_b16 v[116:117], v7 offset:14336
    ds_read_b64_tr_b16 v[118:119], v7 offset:14848
    ds_read_b64_tr_b16 v[120:121], v6 offset:15360
    ds_read_b64_tr_b16 v[122:123], v6 offset:15872
    ds_read_b64_tr_b16 v[124:125], v7 offset:15360
    ds_read_b64_tr_b16 v[126:127], v7 offset:15872
    ds_read_b64_tr_b16 v[128:129], v6 offset:17920
    ds_read_b64_tr_b16 v[130:131], v6 offset:18432
    ds_read_b64_tr_b16 v[132:133], v7 offset:17920
    ds_read_b64_tr_b16 v[134:135], v7 offset:18432
    ds_read_b64_tr_b16 v[136:137], v6 offset:18944
    ds_read_b64_tr_b16 v[138:139], v6 offset:19456
    ds_read_b64_tr_b16 v[140:141], v7 offset:18944
    ds_read_b64_tr_b16 v[142:143], v7 offset:19456
    ds_read_b64_tr_b16 v[144:145], v6 offset:21504
    ds_read_b64_tr_b16 v[146:147], v6 offset:22016
    ds_read_b64_tr_b16 v[148:149], v7 offset:21504
    ds_read_b64_tr_b16 v[150:151], v7 offset:22016
    ds_read_b64_tr_b16 v[152:153], v6 offset:22528
    ds_read_b64_tr_b16 v[154:155], v6 offset:23040
    ds_read_b64_tr_b16 v[156:157], v7 offset:22528
    ds_read_b64_tr_b16 v[158:159], v7 offset:23040
    ds_read_b64_tr_b16 v[224:225], v6 offset:25088
    ds_read_b64_tr_b16 v[226:227], v6 offset:25600
    ds_read_b64_tr_b16 v[228:229], v7 offset:25088
    ds_read_b64_tr_b16 v[230:231], v7 offset:25600
    ds_read_b64_tr_b16 v[232:233], v6 offset:26112
    ds_read_b64_tr_b16 v[234:235], v6 offset:26624
    ds_read_b64_tr_b16 v[236:237], v7 offset:26112
    ds_read_b64_tr_b16 v[238:239], v7 offset:26624
    s_sub_u32 s67, s79, s55
    v_add_u32 v12, s67, v14
    v_add_u32_e64 v13, s67, v15
    ds_read_b64_tr_b16 a[96:97], v12 offset:0
    ds_read_b64_tr_b16 a[98:99], v12 offset:512
    ds_read_b64_tr_b16 a[100:101], v13 offset:0
    ds_read_b64_tr_b16 a[102:103], v13 offset:512
    ds_read_b64_tr_b16 a[104:105], v12 offset:2048
    ds_read_b64_tr_b16 a[106:107], v12 offset:2560
    ds_read_b64_tr_b16 a[108:109], v13 offset:2048
    ds_read_b64_tr_b16 a[110:111], v13 offset:2560
    ds_read_b64_tr_b16 a[112:113], v12 offset:4096
    ds_read_b64_tr_b16 a[114:115], v12 offset:4608
    ds_read_b64_tr_b16 a[116:117], v13 offset:4096
    ds_read_b64_tr_b16 a[118:119], v13 offset:4608
    ds_read_b64_tr_b16 a[120:121], v12 offset:6144
    ds_read_b64_tr_b16 a[122:123], v12 offset:6656
    ds_read_b64_tr_b16 a[124:125], v13 offset:6144
    ds_read_b64_tr_b16 a[126:127], v13 offset:6656
    s_waitcnt lgkmcnt(0)
    s_barrier
    s_branch A2_13_s1r
CK_16_r:
    s_cmp_le_i32 s52, 0
    s_cbranch_scc1 CK_16_k
    s_sub_u32 s52, s52, 1
    s_sleep 1
    s_nop 0
    buffer_load_dwordx4 v[160:163], v240, s[36:39], s88 offen offset:0 sc1
    buffer_load_dwordx4 v[164:167], v240, s[36:39], s88 offen offset:1024 sc1
    buffer_load_dwordx4 v[168:171], v240, s[36:39], s88 offen offset:2048 sc1
    buffer_load_dwordx4 v[172:175], v240, s[36:39], s88 offen offset:3072 sc1
    buffer_load_dwordx4 v[176:179], v241, s[36:39], s88 offen offset:0 sc1
    buffer_load_dwordx4 v[180:183], v241, s[36:39], s88 offen offset:1024 sc1
    buffer_load_dwordx4 v[184:187], v241, s[36:39], s88 offen offset:2048 sc1
    buffer_load_dwordx4 v[188:191], v241, s[36:39], s88 offen offset:3072 sc1
    buffer_load_dwordx4 v[192:195], v240, s[36:39], s89 offen offset:0 sc1
    buffer_load_dwordx4 v[196:199], v240, s[36:39], s89 offen offset:1024 sc1
    buffer_load_dwordx4 v[200:203], v240, s[36:39], s89 offen offset:2048 sc1
    buffer_load_dwordx4 v[204:207], v240, s[36:39], s89 offen offset:3072 sc1
    buffer_load_dwordx4 v[208:211], v241, s[36:39], s89 offen offset:0 sc1
    buffer_load_dwordx4 v[212:215], v241, s[36:39], s89 offen offset:1024 sc1
    buffer_load_dwordx4 v[216:219], v241, s[36:39], s89 offen offset:2048 sc1
    buffer_load_dwordx4 v[220:223], v241, s[36:39], s89 offen offset:3072 sc1
    s_waitcnt vmcnt(12)
    v_max_u32 v251, v163, v167
    v_max3_u32 v251, v251, v171, v175
    v_cmp_eq_u32 vcc, -1, v251
    s_nop 0
    s_cbranch_vccnz CK_16_r
    s_branch CK_16_k
CK_17_r:
    s_cmp_le_i32 s52, 0
    s_cbranch_scc1 CK_17_k
    s_sub_u32 s52, s52, 1
    s_sleep 1
    buffer_load_dwordx4 v[176:179], v241, s[36:39], s88 offen offset:0 sc1
    buffer_load_dwordx4 v[180:183], v241, s[36:39], s88 offen offset:1024 sc1
    buffer_load_dwordx4 v[184:187], v241, s[36:39], s88 offen offset:2048 sc1
    buffer_load_dwordx4 v[188:191], v241, s[36:39], s88 offen offset:3072 sc1
    buffer_load_dwordx4 v[192:195], v240, s[36:39], s89 offen offset:0 sc1
    buffer_load_dwordx4 v[196:199], v240, s[36:39], s89 offen offset:1024 sc1
    buffer_load_dwordx4 v[200:203], v240, s[36:39], s89 offen offset:2048 sc1
    buffer_load_dwordx4 v[204:207], v240, s[36:39], s89 offen offset:3072 sc1
    buffer_load_dwordx4 v[208:211], v241, s[36:39], s89 offen offset:0 sc1
    buffer_load_dwordx4 v[212:215], v241, s[36:39], s89 offen offset:1024 sc1
    buffer_load_dwordx4 v[216:219], v241, s[36:39], s89 offen offset:2048 sc1
    buffer_load_dwordx4 v[220:223], v241, s[36:39], s89 offen offset:3072 sc1
    s_waitcnt vmcnt(0)
    v_max_u32 v251, v179, v183
    v_max3_u32 v251, v251, v187, v191
    v_cmp_eq_u32 vcc, -1, v251
    s_nop 0
    s_cbranch_vccnz CK_17_r
    s_branch CK_17_k
CK_18_r:
    s_cmp_le_i32 s52, 0
    s_cbranch_scc1 CK_18_k
    s_sub_u32 s52, s52, 1
    s_sleep 1
    buffer_load_dwordx4 v[192:195], v240, s[36:39], s89 offen offset:0 sc1
    buffer_load_dwordx4 v[196:199], v240, s[36:39], s89 offen offset:1024 sc1
    buffer_load_dwordx4 v[200:203], v240, s[36:39], s89 offen offset:2048 sc1
    buffer_load_dwordx4 v[204:207], v240, s[36:39], s89 offen offset:3072 sc1
    buffer_load_dwordx4 v[208:211], v241, s[36:39], s89 offen offset:0 sc1
    buffer_load_dwordx4 v[212:215], v241, s[36:39], s89 offen offset:1024 sc1
    buffer_load_dwordx4 v[216:219], v241, s[36:39], s89 offen offset:2048 sc1
    buffer_load_dwordx4 v[220:223], v241, s[36:39], s89 offen offset:3072 sc1
    s_waitcnt vmcnt(0)
    v_max_u32 v251, v195, v199
    v_max3_u32 v251, v251, v203, v207
    v_cmp_eq_u32 vcc, -1, v251
    s_nop 0
    s_cbranch_vccnz CK_18_r
    s_branch CK_18_k
CK_19_r:
    s_cmp_le_i32 s52, 0
    s_cbranch_scc1 CK_19_k
    s_sub_u32 s52, s52, 1
    s_sleep 1
    buffer_load_dwordx4 v[208:211], v241, s[36:39], s89 offen offset:0 sc1
    buffer_load_dwordx4 v[212:215], v241, s[36:39], s89 offen offset:1024 sc1
    buffer_load_dwordx4 v[216:219], v241, s[36:39], s89 offen offset:2048 sc1
    buffer_load_dwordx4 v[220:223], v241, s[36:39], s89 offen offset:3072 sc1
    s_waitcnt vmcnt(0)
    v_max_u32 v251, v211, v215
    v_max3_u32 v251, v251, v219, v223
    v_cmp_eq_u32 vcc, -1, v251
    s_nop 0
    s_cbranch_vccnz CK_19_r
    s_branch CK_19_k
LS_20_g:
    buffer_store_dwordx2 v[80:81], v245, s[36:39], s65 offen sc1
    s_branch LS_20_r
CK_21_r:
    s_cmp_le_i32 s52, 0
    s_cbranch_scc1 CK_21_k
    s_sub_u32 s52, s52, 1
    buffer_load_dwordx2 v[96:97], v245, s[36:39], s64 offen offset:0 sc1
    buffer_load_dwordx2 v[98:99], v245, s[36:39], s64 offen offset:512 sc1
    buffer_load_dwordx2 v[100:101], v245, s[36:39], s64 offen offset:1024 sc1
    buffer_load_dwordx2 v[102:103], v245, s[36:39], s64 offen offset:1536 sc1
    buffer_load_dwordx2 v[104:105], v245, s[36:39], s64 offen offset:2048 sc1
    buffer_load_dwordx2 v[106:107], v245, s[36:39], s64 offen offset:2560 sc1
    buffer_load_dwordx2 v[108:109], v245, s[36:39], s64 offen offset:3072 sc1
    s_waitcnt vmcnt(0)
    v_max3_u32 v251, v97, v99, v101
    v_max3_u32 v251, v251, v103, v105
    v_max3_u32 v251, v251, v107, v109
    v_cmp_eq_u32 vcc, -1, v251
    s_nop 0
    s_cbranch_vccnz CK_21_r
    s_branch CK_21_k
CK_24_r:
    s_cmp_le_i32 s52, 0
    s_cbranch_scc1 CK_24_k
    s_sub_u32 s52, s52, 1
    s_sleep 1
    s_nop 0
    buffer_load_dwordx4 v[104:107], v240, s[36:39], s80 offen offset:0 sc1
    buffer_load_dwordx4 v[108:111], v240, s[36:39], s80 offen offset:1024 sc1
    buffer_load_dwordx4 v[112:115], v240, s[36:39], s80 offen offset:2048 sc1
    buffer_load_dwordx4 v[116:119], v240, s[36:39], s80 offen offset:3072 sc1
    buffer_load_dwordx4 v[120:123], v241, s[36:39], s80 offen offset:0 sc1
    buffer_load_dwordx4 v[124:127], v241, s[36:39], s80 offen offset:1024 sc1
    buffer_load_dwordx4 v[128:131], v241, s[36:39], s80 offen offset:2048 sc1
    buffer_load_dwordx4 v[132:135], v241, s[36:39], s80 offen offset:3072 sc1
    buffer_load_dwordx4 v[136:139], v240, s[36:39], s81 offen offset:0 sc1
    buffer_load_dwordx4 v[140:143], v240, s[36:39], s81 offen offset:1024 sc1
    buffer_load_dwordx4 v[144:147], v240, s[36:39], s81 offen offset:2048 sc1
    buffer_load_dwordx4 v[148:151], v240, s[36:39], s81 offen offset:3072 sc1
    s_waitcnt vmcnt(8)
    v_max_u32 v251, v107, v111
    v_max3_u32 v251, v251, v115, v119
    v_cmp_eq_u32 vcc, -1, v251
    s_nop 0
    s_cbranch_vccnz CK_24_r
    s_branch CK_24_k
CK_25_r:
    s_cmp_le_i32 s52, 0
    s_cbranch_scc1 CK_25_k
    s_sub_u32 s52, s52, 1
    s_sleep 1
    buffer_load_dwordx4 v[120:123], v241, s[36:39], s80 offen offset:0 sc1
    buffer_load_dwordx4 v[124:127], v241, s[36:39], s80 offen offset:1024 sc1
    buffer_load_dwordx4 v[128:131], v241, s[36:39], s80 offen offset:2048 sc1
    buffer_load_dwordx4 v[132:135], v241, s[36:39], s80 offen offset:3072 sc1
    buffer_load_dwordx4 v[136:139], v240, s[36:39], s81 offen offset:0 sc1
    buffer_load_dwordx4 v[140:143], v240, s[36:39], s81 offen offset:1024 sc1
    buffer_load_dwordx4 v[144:147], v240, s[36:39], s81 offen offset:2048 sc1
    buffer_load_dwordx4 v[148:151], v240, s[36:39], s81 offen offset:3072 sc1
    buffer_load_dwordx4 v[152:155], v241, s[36:39], s81 offen offset:0 sc1
    buffer_load_dwordx4 v[156:159], v241, s[36:39], s81 offen offset:1024 sc1
    buffer_load_dwordx4 v[160:163], v241, s[36:39], s81 offen offset:2048 sc1
    buffer_load_dwordx4 v[164:167], v241, s[36:39], s81 offen offset:3072 sc1
    s_waitcnt vmcnt(8)
    v_max_u32 v251, v123, v127
    v_max3_u32 v251, v251, v131, v135
    v_cmp_eq_u32 vcc, -1, v251
    s_nop 0
    s_cbranch_vccnz CK_25_r
    s_branch CK_25_k
CK_26_r:
    s_cmp_le_i32 s52, 0
    s_cbranch_scc1 CK_26_k
    s_sub_u32 s52, s52, 1
    s_sleep 1
    buffer_load_dwordx4 v[136:139], v240, s[36:39], s81 offen offset:0 sc1
    buffer_load_dwordx4 v[140:143], v240, s[36:39], s81 offen offset:1024 sc1
    buffer_load_dwordx4 v[144:147], v240, s[36:39], s81 offen offset:2048 sc1
    buffer_load_dwordx4 v[148:151], v240, s[36:39], s81 offen offset:3072 sc1
    buffer_load_dwordx4 v[152:155], v241, s[36:39], s81 offen offset:0 sc1
    buffer_load_dwordx4 v[156:159], v241, s[36:39], s81 offen offset:1024 sc1
    buffer_load_dwordx4 v[160:163], v241, s[36:39], s81 offen offset:2048 sc1
    buffer_load_dwordx4 v[164:167], v241, s[36:39], s81 offen offset:3072 sc1
    buffer_load_dwordx4 v[168:171], v240, s[36:39], s82 offen offset:0 sc1
    buffer_load_dwordx4 v[172:175], v240, s[36:39], s82 offen offset:1024 sc1
    buffer_load_dwordx4 v[176:179], v240, s[36:39], s82 offen offset:2048 sc1
    buffer_load_dwordx4 v[180:183], v240, s[36:39], s82 offen offset:3072 sc1
    s_waitcnt vmcnt(8)
    v_max_u32 v251, v139, v143
    v_max3_u32 v251, v251, v147, v151
    v_cmp_eq_u32 vcc, -1, v251
    s_nop 0
    s_cbranch_vccnz CK_26_r
    s_branch CK_26_k
CK_27_r:
    s_cmp_le_i32 s52, 0
    s_cbranch_scc1 CK_27_k
    s_sub_u32 s52, s52, 1
    s_sleep 1
    buffer_load_dwordx4 v[152:155], v241, s[36:39], s81 offen offset:0 sc1
    buffer_load_dwordx4 v[156:159], v241, s[36:39], s81 offen offset:1024 sc1
    buffer_load_dwordx4 v[160:163], v241, s[36:39], s81 offen offset:2048 sc1
    buffer_load_dwordx4 v[164:167], v241, s[36:39], s81 offen offset:3072 sc1
    buffer_load_dwordx4 v[168:171], v240, s[36:39], s82 offen offset:0 sc1
    buffer_load_dwordx4 v[172:175], v240, s[36:39], s82 offen offset:1024 sc1
    buffer_load_dwordx4 v[176:179], v240, s[36:39], s82 offen offset:2048 sc1
    buffer_load_dwordx4 v[180:183], v240, s[36:39], s82 offen offset:3072 sc1
    buffer_load_dwordx4 v[184:187], v241, s[36:39], s82 offen offset:0 sc1
    buffer_load_dwordx4 v[188:191], v241, s[36:39], s82 offen offset:1024 sc1
    buffer_load_dwordx4 v[192:195], v241, s[36:39], s82 offen offset:2048 sc1
    buffer_load_dwordx4 v[196:199], v241, s[36:39], s82 offen offset:3072 sc1
    s_waitcnt vmcnt(8)
    v_max_u32 v251, v155, v159
    v_max3_u32 v251, v251, v163, v167
    v_cmp_eq_u32 vcc, -1, v251
    s_nop 0
    s_cbranch_vccnz CK_27_r
    s_branch CK_27_k
CK_28_r:
    s_cmp_le_i32 s52, 0
    s_cbranch_scc1 CK_28_k
    s_sub_u32 s52, s52, 1
    s_sleep 1
    buffer_load_dwordx4 v[168:171], v240, s[36:39], s82 offen offset:0 sc1
    buffer_load_dwordx4 v[172:175], v240, s[36:39], s82 offen offset:1024 sc1
    buffer_load_dwordx4 v[176:179], v240, s[36:39], s82 offen offset:2048 sc1
    buffer_load_dwordx4 v[180:183], v240, s[36:39], s82 offen offset:3072 sc1
    buffer_load_dwordx4 v[184:187], v241, s[36:39], s82 offen offset:0 sc1
    buffer_load_dwordx4 v[188:191], v241, s[36:39], s82 offen offset:1024 sc1
    buffer_load_dwordx4 v[192:195], v241, s[36:39], s82 offen offset:2048 sc1
    buffer_load_dwordx4 v[196:199], v241, s[36:39], s82 offen offset:3072 sc1
    buffer_load_dwordx4 v[200:203], v240, s[36:39], s83 offen offset:0 sc1
    buffer_load_dwordx4 v[204:207], v240, s[36:39], s83 offen offset:1024 sc1
    buffer_load_dwordx4 v[208:211], v240, s[36:39], s83 offen offset:2048 sc1
    buffer_load_dwordx4 v[212:215], v240, s[36:39], s83 offen offset:3072 sc1
    s_waitcnt vmcnt(8)
    v_max_u32 v251, v171, v175
    v_max3_u32 v251, v251, v179, v183
    v_cmp_eq_u32 vcc, -1, v251
    s_nop 0
    s_cbranch_vccnz CK_28_r
    s_branch CK_28_k
CK_29_r:
    s_cmp_le_i32 s52, 0
    s_cbranch_scc1 CK_29_k
    s_sub_u32 s52, s52, 1
    s_sleep 1
    buffer_load_dwordx4 v[184:187], v241, s[36:39], s82 offen offset:0 sc1
    buffer_load_dwordx4 v[188:191], v241, s[36:39], s82 offen offset:1024 sc1
    buffer_load_dwordx4 v[192:195], v241, s[36:39], s82 offen offset:2048 sc1
    buffer_load_dwordx4 v[196:199], v241, s[36:39], s82 offen offset:3072 sc1
    buffer_load_dwordx4 v[200:203], v240, s[36:39], s83 offen offset:0 sc1
    buffer_load_dwordx4 v[204:207], v240, s[36:39], s83 offen offset:1024 sc1
    buffer_load_dwordx4 v[208:211], v240, s[36:39], s83 offen offset:2048 sc1
    buffer_load_dwordx4 v[212:215], v240, s[36:39], s83 offen offset:3072 sc1
    buffer_load_dwordx4 v[104:107], v241, s[36:39], s83 offen offset:0 sc1
    buffer_load_dwordx4 v[108:111], v241, s[36:39], s83 offen offset:1024 sc1
    buffer_load_dwordx4 v[112:115], v241, s[36:39], s83 offen offset:2048 sc1
    buffer_load_dwordx4 v[116:119], v241, s[36:39], s83 offen offset:3072 sc1
    s_waitcnt vmcnt(0)
    v_max_u32 v251, v187, v191
    v_max3_u32 v251, v251, v195, v199
    v_cmp_eq_u32 vcc, -1, v251
    s_nop 0
    s_cbranch_vccnz CK_29_r
    s_branch CK_29_k
CK_30_r:
    s_cmp_le_i32 s52, 0
    s_cbranch_scc1 CK_30_k
    s_sub_u32 s52, s52, 1
    s_sleep 1
    buffer_load_dwordx4 v[200:203], v240, s[36:39], s83 offen offset:0 sc1
    buffer_load_dwordx4 v[204:207], v240, s[36:39], s83 offen offset:1024 sc1
    buffer_load_dwordx4 v[208:211], v240, s[36:39], s83 offen offset:2048 sc1
    buffer_load_dwordx4 v[212:215], v240, s[36:39], s83 offen offset:3072 sc1
    buffer_load_dwordx4 v[104:107], v241, s[36:39], s83 offen offset:0 sc1
    buffer_load_dwordx4 v[108:111], v241, s[36:39], s83 offen offset:1024 sc1
    buffer_load_dwordx4 v[112:115], v241, s[36:39], s83 offen offset:2048 sc1
    buffer_load_dwordx4 v[116:119], v241, s[36:39], s83 offen offset:3072 sc1
    buffer_load_dwordx4 v[120:123], v240, s[36:39], s84 offen offset:0 sc1
    buffer_load_dwordx4 v[124:127], v240, s[36:39], s84 offen offset:1024 sc1
    buffer_load_dwordx4 v[128:131], v240, s[36:39], s84 offen offset:2048 sc1
    buffer_load_dwordx4 v[132:135], v240, s[36:39], s84 offen offset:3072 sc1
    s_waitcnt vmcnt(0)
    v_max_u32 v251, v203, v207
    v_max3_u32 v251, v251, v211, v215
    v_cmp_eq_u32 vcc, -1, v251
    s_nop 0
    s_cbranch_vccnz CK_30_r
    s_branch CK_30_k
CK_31_r:
    s_cmp_le_i32 s52, 0
    s_cbranch_scc1 CK_31_k
    s_sub_u32 s52, s52, 1
    s_sleep 1
    buffer_load_dwordx4 v[104:107], v241, s[36:39], s83 offen offset:0 sc1
    buffer_load_dwordx4 v[108:111], v241, s[36:39], s83 offen offset:1024 sc1
    buffer_load_dwordx4 v[112:115], v241, s[36:39], s83 offen offset:2048 sc1
    buffer_load_dwordx4 v[116:119], v241, s[36:39], s83 offen offset:3072 sc1
    buffer_load_dwordx4 v[120:123], v240, s[36:39], s84 offen offset:0 sc1
    buffer_load_dwordx4 v[124:127], v240, s[36:39], s84 offen offset:1024 sc1
    buffer_load_dwordx4 v[128:131], v240, s[36:39], s84 offen offset:2048 sc1
    buffer_load_dwordx4 v[132:135], v240, s[36:39], s84 offen offset:3072 sc1
    buffer_load_dwordx4 v[136:139], v241, s[36:39], s84 offen offset:0 sc1
    buffer_load_dwordx4 v[140:143], v241, s[36:39], s84 offen offset:1024 sc1
    buffer_load_dwordx4 v[144:147], v241, s[36:39], s84 offen offset:2048 sc1
    buffer_load_dwordx4 v[148:151], v241, s[36:39], s84 offen offset:3072 sc1
    s_waitcnt vmcnt(0)
    v_max_u32 v251, v107, v111
    v_max3_u32 v251, v251, v115, v119
    v_cmp_eq_u32 vcc, -1, v251
    s_nop 0
    s_cbranch_vccnz CK_31_r
    s_branch CK_31_k

CC_32_r:
    s_cmp_le_i32 s52, 0
    s_cbranch_scc1 CC_32_k
    s_sub_u32 s52, s52, 1
    s_sleep 8
    buffer_load_dword v252, v253, s[40:43], 0 offen offset:4 sc1
    s_waitcnt vmcnt(0)
    v_cmp_gt_u32 vcc, 32, v252
    s_nop 0
    s_cbranch_vccnz CC_32_r
    s_branch CC_32_k

CK_33_r:
    s_cmp_le_i32 s52, 0
    s_cbranch_scc1 CK_33_k
    s_sub_u32 s52, s52, 1
    s_sleep 1
    s_nop 0
    buffer_load_dwordx4 v[120:123], v240, s[36:39], s84 offen offset:0 sc1
    buffer_load_dwordx4 v[124:127], v240, s[36:39], s84 offen offset:1024 sc1
    buffer_load_dwordx4 v[128:131], v240, s[36:39], s84 offen offset:2048 sc1
    buffer_load_dwordx4 v[132:135], v240, s[36:39], s84 offen offset:3072 sc1
    buffer_load_dwordx4 v[136:139], v241, s[36:39], s84 offen offset:0 sc1
    buffer_load_dwordx4 v[140:143], v241, s[36:39], s84 offen offset:1024 sc1
    buffer_load_dwordx4 v[144:147], v241, s[36:39], s84 offen offset:2048 sc1
    buffer_load_dwordx4 v[148:151], v241, s[36:39], s84 offen offset:3072 sc1
    buffer_load_dwordx4 v[152:155], v240, s[36:39], s85 offen offset:0 sc1
    buffer_load_dwordx4 v[156:159], v240, s[36:39], s85 offen offset:1024 sc1
    buffer_load_dwordx4 v[160:163], v240, s[36:39], s85 offen offset:2048 sc1
    buffer_load_dwordx4 v[164:167], v240, s[36:39], s85 offen offset:3072 sc1
    buffer_load_dwordx4 v[168:171], v241, s[36:39], s85 offen offset:0 sc1
    buffer_load_dwordx4 v[172:175], v241, s[36:39], s85 offen offset:1024 sc1
    buffer_load_dwordx4 v[176:179], v241, s[36:39], s85 offen offset:2048 sc1
    buffer_load_dwordx4 v[180:183], v241, s[36:39], s85 offen offset:3072 sc1
    buffer_load_dwordx4 v[184:187], v240, s[36:39], s86 offen offset:0 sc1
    buffer_load_dwordx4 v[188:191], v240, s[36:39], s86 offen offset:1024 sc1
    buffer_load_dwordx4 v[192:195], v240, s[36:39], s86 offen offset:2048 sc1
    buffer_load_dwordx4 v[196:199], v240, s[36:39], s86 offen offset:3072 sc1
    s_waitcnt vmcnt(0)
    v_max_u32 v251, v123, v127
    v_max3_u32 v251, v251, v131, v135
    v_cmp_eq_u32 vcc, -1, v251
    s_nop 0
    s_cbranch_vccnz CK_33_r
    s_branch CK_33_k
CK_34_r:
    s_cmp_le_i32 s52, 0
    s_cbranch_scc1 CK_34_k
    s_sub_u32 s52, s52, 1
    s_sleep 1
    buffer_load_dwordx4 v[136:139], v241, s[36:39], s84 offen offset:0 sc1
    buffer_load_dwordx4 v[140:143], v241, s[36:39], s84 offen offset:1024 sc1
    buffer_load_dwordx4 v[144:147], v241, s[36:39], s84 offen offset:2048 sc1
    buffer_load_dwordx4 v[148:151], v241, s[36:39], s84 offen offset:3072 sc1
    buffer_load_dwordx4 v[152:155], v240, s[36:39], s85 offen offset:0 sc1
    buffer_load_dwordx4 v[156:159], v240, s[36:39], s85 offen offset:1024 sc1
    buffer_load_dwordx4 v[160:163], v240, s[36:39], s85 offen offset:2048 sc1
    buffer_load_dwordx4 v[164:167], v240, s[36:39], s85 offen offset:3072 sc1
    buffer_load_dwordx4 v[168:171], v241, s[36:39], s85 offen offset:0 sc1
    buffer_load_dwordx4 v[172:175], v241, s[36:39], s85 offen offset:1024 sc1
    buffer_load_dwordx4 v[176:179], v241, s[36:39], s85 offen offset:2048 sc1
    buffer_load_dwordx4 v[180:183], v241, s[36:39], s85 offen offset:3072 sc1
    buffer_load_dwordx4 v[184:187], v240, s[36:39], s86 offen offset:0 sc1
    buffer_load_dwordx4 v[188:191], v240, s[36:39], s86 offen offset:1024 sc1
    buffer_load_dwordx4 v[192:195], v240, s[36:39], s86 offen offset:2048 sc1
    buffer_load_dwordx4 v[196:199], v240, s[36:39], s86 offen offset:3072 sc1
    s_waitcnt vmcnt(0)
    v_max_u32 v251, v139, v143
    v_max3_u32 v251, v251, v147, v151
    v_cmp_eq_u32 vcc, -1, v251
    s_nop 0
    s_cbranch_vccnz CK_34_r
    s_branch CK_34_k
CK_35_r:
    s_cmp_le_i32 s52, 0
    s_cbranch_scc1 CK_35_k
    s_sub_u32 s52, s52, 1
    s_sleep 1
    buffer_load_dwordx4 v[152:155], v240, s[36:39], s85 offen offset:0 sc1
    buffer_load_dwordx4 v[156:159], v240, s[36:39], s85 offen offset:1024 sc1
    buffer_load_dwordx4 v[160:163], v240, s[36:39], s85 offen offset:2048 sc1
    buffer_load_dwordx4 v[164:167], v240, s[36:39], s85 offen offset:3072 sc1
    buffer_load_dwordx4 v[168:171], v241, s[36:39], s85 offen offset:0 sc1
    buffer_load_dwordx4 v[172:175], v241, s[36:39], s85 offen offset:1024 sc1
    buffer_load_dwordx4 v[176:179], v241, s[36:39], s85 offen offset:2048 sc1
    buffer_load_dwordx4 v[180:183], v241, s[36:39], s85 offen offset:3072 sc1
    buffer_load_dwordx4 v[184:187], v240, s[36:39], s86 offen offset:0 sc1
    buffer_load_dwordx4 v[188:191], v240, s[36:39], s86 offen offset:1024 sc1
    buffer_load_dwordx4 v[192:195], v240, s[36:39], s86 offen offset:2048 sc1
    buffer_load_dwordx4 v[196:199], v240, s[36:39], s86 offen offset:3072 sc1
    s_waitcnt vmcnt(0)
    v_max_u32 v251, v155, v159
    v_max3_u32 v251, v251, v163, v167
    v_cmp_eq_u32 vcc, -1, v251
    s_nop 0
    s_cbranch_vccnz CK_35_r
    s_branch CK_35_k
CK_36_r:
    s_cmp_le_i32 s52, 0
    s_cbranch_scc1 CK_36_k
    s_sub_u32 s52, s52, 1
    s_sleep 1
    buffer_load_dwordx4 v[168:171], v241, s[36:39], s85 offen offset:0 sc1
    buffer_load_dwordx4 v[172:175], v241, s[36:39], s85 offen offset:1024 sc1
    buffer_load_dwordx4 v[176:179], v241, s[36:39], s85 offen offset:2048 sc1
    buffer_load_dwordx4 v[180:183], v241, s[36:39], s85 offen offset:3072 sc1
    buffer_load_dwordx4 v[184:187], v240, s[36:39], s86 offen offset:0 sc1
    buffer_load_dwordx4 v[188:191], v240, s[36:39], s86 offen offset:1024 sc1
    buffer_load_dwordx4 v[192:195], v240, s[36:39], s86 offen offset:2048 sc1
    buffer_load_dwordx4 v[196:199], v240, s[36:39], s86 offen offset:3072 sc1
    buffer_load_dwordx4 v[200:203], v241, s[36:39], s86 offen offset:0 sc1
    buffer_load_dwordx4 v[204:207], v241, s[36:39], s86 offen offset:1024 sc1
    buffer_load_dwordx4 v[208:211], v241, s[36:39], s86 offen offset:2048 sc1
    buffer_load_dwordx4 v[212:215], v241, s[36:39], s86 offen offset:3072 sc1
    s_waitcnt vmcnt(0)
    v_max_u32 v251, v171, v175
    v_max3_u32 v251, v251, v179, v183
    v_cmp_eq_u32 vcc, -1, v251
    s_nop 0
    s_cbranch_vccnz CK_36_r
    s_branch CK_36_k
CK_37_r:
    s_cmp_le_i32 s52, 0
    s_cbranch_scc1 CK_37_k
    s_sub_u32 s52, s52, 1
    s_sleep 1
    buffer_load_dwordx4 v[184:187], v240, s[36:39], s86 offen offset:0 sc1
    buffer_load_dwordx4 v[188:191], v240, s[36:39], s86 offen offset:1024 sc1
    buffer_load_dwordx4 v[192:195], v240, s[36:39], s86 offen offset:2048 sc1
    buffer_load_dwordx4 v[196:199], v240, s[36:39], s86 offen offset:3072 sc1
    buffer_load_dwordx4 v[200:203], v241, s[36:39], s86 offen offset:0 sc1
    buffer_load_dwordx4 v[204:207], v241, s[36:39], s86 offen offset:1024 sc1
    buffer_load_dwordx4 v[208:211], v241, s[36:39], s86 offen offset:2048 sc1
    buffer_load_dwordx4 v[212:215], v241, s[36:39], s86 offen offset:3072 sc1
    buffer_load_dwordx4 v[104:107], v240, s[36:39], s87 offen offset:0 sc1
    buffer_load_dwordx4 v[108:111], v240, s[36:39], s87 offen offset:1024 sc1
    buffer_load_dwordx4 v[112:115], v240, s[36:39], s87 offen offset:2048 sc1
    buffer_load_dwordx4 v[116:119], v240, s[36:39], s87 offen offset:3072 sc1
    s_waitcnt vmcnt(0)
    v_max_u32 v251, v187, v191
    v_max3_u32 v251, v251, v195, v199
    v_cmp_eq_u32 vcc, -1, v251
    s_nop 0
    s_cbranch_vccnz CK_37_r
    s_branch CK_37_k
CK_38_r:
    s_cmp_le_i32 s52, 0
    s_cbranch_scc1 CK_38_k
    s_sub_u32 s52, s52, 1
    s_sleep 1
    buffer_load_dwordx4 v[200:203], v241, s[36:39], s86 offen offset:0 sc1
    buffer_load_dwordx4 v[204:207], v241, s[36:39], s86 offen offset:1024 sc1
    buffer_load_dwordx4 v[208:211], v241, s[36:39], s86 offen offset:2048 sc1
    buffer_load_dwordx4 v[212:215], v241, s[36:39], s86 offen offset:3072 sc1
    buffer_load_dwordx4 v[104:107], v240, s[36:39], s87 offen offset:0 sc1
    buffer_load_dwordx4 v[108:111], v240, s[36:39], s87 offen offset:1024 sc1
    buffer_load_dwordx4 v[112:115], v240, s[36:39], s87 offen offset:2048 sc1
    buffer_load_dwordx4 v[116:119], v240, s[36:39], s87 offen offset:3072 sc1
    buffer_load_dwordx4 v[120:123], v241, s[36:39], s87 offen offset:0 sc1
    buffer_load_dwordx4 v[124:127], v241, s[36:39], s87 offen offset:1024 sc1
    buffer_load_dwordx4 v[128:131], v241, s[36:39], s87 offen offset:2048 sc1
    buffer_load_dwordx4 v[132:135], v241, s[36:39], s87 offen offset:3072 sc1
    s_waitcnt vmcnt(0)
    v_max_u32 v251, v203, v207
    v_max3_u32 v251, v251, v211, v215
    v_cmp_eq_u32 vcc, -1, v251
    s_nop 0
    s_cbranch_vccnz CK_38_r
    s_branch CK_38_k
CK_39_r:
    s_cmp_le_i32 s52, 0
    s_cbranch_scc1 CK_39_k
    s_sub_u32 s52, s52, 1
    s_sleep 1
    buffer_load_dwordx4 v[104:107], v240, s[36:39], s87 offen offset:0 sc1
    buffer_load_dwordx4 v[108:111], v240, s[36:39], s87 offen offset:1024 sc1
    buffer_load_dwordx4 v[112:115], v240, s[36:39], s87 offen offset:2048 sc1
    buffer_load_dwordx4 v[116:119], v240, s[36:39], s87 offen offset:3072 sc1
    buffer_load_dwordx4 v[120:123], v241, s[36:39], s87 offen offset:0 sc1
    buffer_load_dwordx4 v[124:127], v241, s[36:39], s87 offen offset:1024 sc1
    buffer_load_dwordx4 v[128:131], v241, s[36:39], s87 offen offset:2048 sc1
    buffer_load_dwordx4 v[132:135], v241, s[36:39], s87 offen offset:3072 sc1
    buffer_load_dwordx4 v[136:139], v240, s[36:39], s88 offen offset:0 sc1
    buffer_load_dwordx4 v[140:143], v240, s[36:39], s88 offen offset:1024 sc1
    buffer_load_dwordx4 v[144:147], v240, s[36:39], s88 offen offset:2048 sc1
    buffer_load_dwordx4 v[148:151], v240, s[36:39], s88 offen offset:3072 sc1
    s_waitcnt vmcnt(0)
    v_max_u32 v251, v107, v111
    v_max3_u32 v251, v251, v115, v119
    v_cmp_eq_u32 vcc, -1, v251
    s_nop 0
    s_cbranch_vccnz CK_39_r
    s_branch CK_39_k
CK_40_r:
    s_cmp_le_i32 s52, 0
    s_cbranch_scc1 CK_40_k
    s_sub_u32 s52, s52, 1
    s_sleep 1
    buffer_load_dwordx4 v[120:123], v241, s[36:39], s87 offen offset:0 sc1
    buffer_load_dwordx4 v[124:127], v241, s[36:39], s87 offen offset:1024 sc1
    buffer_load_dwordx4 v[128:131], v241, s[36:39], s87 offen offset:2048 sc1
    buffer_load_dwordx4 v[132:135], v241, s[36:39], s87 offen offset:3072 sc1
    buffer_load_dwordx4 v[136:139], v240, s[36:39], s88 offen offset:0 sc1
    buffer_load_dwordx4 v[140:143], v240, s[36:39], s88 offen offset:1024 sc1
    buffer_load_dwordx4 v[144:147], v240, s[36:39], s88 offen offset:2048 sc1
    buffer_load_dwordx4 v[148:151], v240, s[36:39], s88 offen offset:3072 sc1
    buffer_load_dwordx4 v[152:155], v241, s[36:39], s88 offen offset:0 sc1
    buffer_load_dwordx4 v[156:159], v241, s[36:39], s88 offen offset:1024 sc1
    buffer_load_dwordx4 v[160:163], v241, s[36:39], s88 offen offset:2048 sc1
    buffer_load_dwordx4 v[164:167], v241, s[36:39], s88 offen offset:3072 sc1
    s_waitcnt vmcnt(0)
    v_max_u32 v251, v123, v127
    v_max3_u32 v251, v251, v131, v135
    v_cmp_eq_u32 vcc, -1, v251
    s_nop 0
    s_cbranch_vccnz CK_40_r
    s_branch CK_40_k
CK_41_r:
    s_cmp_le_i32 s52, 0
    s_cbranch_scc1 CK_41_k
    s_sub_u32 s52, s52, 1
    s_sleep 1
    buffer_load_dwordx4 v[136:139], v240, s[36:39], s88 offen offset:0 sc1
    buffer_load_dwordx4 v[140:143], v240, s[36:39], s88 offen offset:1024 sc1
    buffer_load_dwordx4 v[144:147], v240, s[36:39], s88 offen offset:2048 sc1
    buffer_load_dwordx4 v[148:151], v240, s[36:39], s88 offen offset:3072 sc1
    buffer_load_dwordx4 v[152:155], v241, s[36:39], s88 offen offset:0 sc1
    buffer_load_dwordx4 v[156:159], v241, s[36:39], s88 offen offset:1024 sc1
    buffer_load_dwordx4 v[160:163], v241, s[36:39], s88 offen offset:2048 sc1
    buffer_load_dwordx4 v[164:167], v241, s[36:39], s88 offen offset:3072 sc1
    buffer_load_dwordx4 v[168:171], v240, s[36:39], s89 offen offset:0 sc1
    buffer_load_dwordx4 v[172:175], v240, s[36:39], s89 offen offset:1024 sc1
    buffer_load_dwordx4 v[176:179], v240, s[36:39], s89 offen offset:2048 sc1
    buffer_load_dwordx4 v[180:183], v240, s[36:39], s89 offen offset:3072 sc1
    buffer_load_dwordx4 v[184:187], v241, s[36:39], s89 offen offset:0 sc1
    buffer_load_dwordx4 v[188:191], v241, s[36:39], s89 offen offset:1024 sc1
    buffer_load_dwordx4 v[192:195], v241, s[36:39], s89 offen offset:2048 sc1
    buffer_load_dwordx4 v[196:199], v241, s[36:39], s89 offen offset:3072 sc1
    buffer_load_dwordx4 v[200:203], v240, s[36:39], s90 offen offset:0 sc1
    buffer_load_dwordx4 v[204:207], v240, s[36:39], s90 offen offset:1024 sc1
    buffer_load_dwordx4 v[208:211], v240, s[36:39], s90 offen offset:2048 sc1
    buffer_load_dwordx4 v[212:215], v240, s[36:39], s90 offen offset:3072 sc1
    s_waitcnt vmcnt(0)
    v_max_u32 v251, v139, v143
    v_max3_u32 v251, v251, v147, v151
    v_cmp_eq_u32 vcc, -1, v251
    s_nop 0
    s_cbranch_vccnz CK_41_r
    s_branch CK_41_k
CK_42_r:
    s_cmp_le_i32 s52, 0
    s_cbranch_scc1 CK_42_k
    s_sub_u32 s52, s52, 1
    s_sleep 1
    buffer_load_dwordx4 v[152:155], v241, s[36:39], s88 offen offset:0 sc1
    buffer_load_dwordx4 v[156:159], v241, s[36:39], s88 offen offset:1024 sc1
    buffer_load_dwordx4 v[160:163], v241, s[36:39], s88 offen offset:2048 sc1
    buffer_load_dwordx4 v[164:167], v241, s[36:39], s88 offen offset:3072 sc1
    buffer_load_dwordx4 v[168:171], v240, s[36:39], s89 offen offset:0 sc1
    buffer_load_dwordx4 v[172:175], v240, s[36:39], s89 offen offset:1024 sc1
    buffer_load_dwordx4 v[176:179], v240, s[36:39], s89 offen offset:2048 sc1
    buffer_load_dwordx4 v[180:183], v240, s[36:39], s89 offen offset:3072 sc1
    buffer_load_dwordx4 v[184:187], v241, s[36:39], s89 offen offset:0 sc1
    buffer_load_dwordx4 v[188:191], v241, s[36:39], s89 offen offset:1024 sc1
    buffer_load_dwordx4 v[192:195], v241, s[36:39], s89 offen offset:2048 sc1
    buffer_load_dwordx4 v[196:199], v241, s[36:39], s89 offen offset:3072 sc1
    buffer_load_dwordx4 v[200:203], v240, s[36:39], s90 offen offset:0 sc1
    buffer_load_dwordx4 v[204:207], v240, s[36:39], s90 offen offset:1024 sc1
    buffer_load_dwordx4 v[208:211], v240, s[36:39], s90 offen offset:2048 sc1
    buffer_load_dwordx4 v[212:215], v240, s[36:39], s90 offen offset:3072 sc1
    s_waitcnt vmcnt(0)
    v_max_u32 v251, v155, v159
    v_max3_u32 v251, v251, v163, v167
    v_cmp_eq_u32 vcc, -1, v251
    s_nop 0
    s_cbranch_vccnz CK_42_r
    s_branch CK_42_k

CC_43_r:
    s_cmp_le_i32 s52, 0
    s_cbranch_scc1 CC_43_k
    s_sub_u32 s52, s52, 1
    s_sleep 8
    buffer_load_dword v252, v253, s[40:43], 0 offen offset:68 sc1
    s_waitcnt vmcnt(0)
    v_cmp_gt_u32 vcc, 32, v252
    s_nop 0
    s_cbranch_vccnz CC_43_r
    s_branch CC_43_k

CK_44_r:
    s_cmp_le_i32 s52, 0
    s_cbranch_scc1 CK_44_k
    s_sub_u32 s52, s52, 1
    s_sleep 1
    s_nop 0
    buffer_load_dwordx4 v[168:171], v240, s[36:39], s89 offen offset:0 sc1
    buffer_load_dwordx4 v[172:175], v240, s[36:39], s89 offen offset:1024 sc1
    buffer_load_dwordx4 v[176:179], v240, s[36:39], s89 offen offset:2048 sc1
    buffer_load_dwordx4 v[180:183], v240, s[36:39], s89 offen offset:3072 sc1
    buffer_load_dwordx4 v[184:187], v241, s[36:39], s89 offen offset:0 sc1
    buffer_load_dwordx4 v[188:191], v241, s[36:39], s89 offen offset:1024 sc1
    buffer_load_dwordx4 v[192:195], v241, s[36:39], s89 offen offset:2048 sc1
    buffer_load_dwordx4 v[196:199], v241, s[36:39], s89 offen offset:3072 sc1
    buffer_load_dwordx4 v[200:203], v240, s[36:39], s90 offen offset:0 sc1
    buffer_load_dwordx4 v[204:207], v240, s[36:39], s90 offen offset:1024 sc1
    buffer_load_dwordx4 v[208:211], v240, s[36:39], s90 offen offset:2048 sc1
    buffer_load_dwordx4 v[212:215], v240, s[36:39], s90 offen offset:3072 sc1
    s_waitcnt vmcnt(0)
    v_max_u32 v251, v171, v175
    v_max3_u32 v251, v251, v179, v183
    v_cmp_eq_u32 vcc, -1, v251
    s_nop 0
    s_cbranch_vccnz CK_44_r
    s_branch CK_44_k
CK_45_r:
    s_cmp_le_i32 s52, 0
    s_cbranch_scc1 CK_45_k
    s_sub_u32 s52, s52, 1
    s_sleep 1
    buffer_load_dwordx4 v[184:187], v241, s[36:39], s89 offen offset:0 sc1
    buffer_load_dwordx4 v[188:191], v241, s[36:39], s89 offen offset:1024 sc1
    buffer_load_dwordx4 v[192:195], v241, s[36:39], s89 offen offset:2048 sc1
    buffer_load_dwordx4 v[196:199], v241, s[36:39], s89 offen offset:3072 sc1
    buffer_load_dwordx4 v[200:203], v240, s[36:39], s90 offen offset:0 sc1
    buffer_load_dwordx4 v[204:207], v240, s[36:39], s90 offen offset:1024 sc1
    buffer_load_dwordx4 v[208:211], v240, s[36:39], s90 offen offset:2048 sc1
    buffer_load_dwordx4 v[212:215], v240, s[36:39], s90 offen offset:3072 sc1
    buffer_load_dwordx4 v[104:107], v241, s[36:39], s90 offen offset:0 sc1
    buffer_load_dwordx4 v[108:111], v241, s[36:39], s90 offen offset:1024 sc1
    buffer_load_dwordx4 v[112:115], v241, s[36:39], s90 offen offset:2048 sc1
    buffer_load_dwordx4 v[116:119], v241, s[36:39], s90 offen offset:3072 sc1
    s_waitcnt vmcnt(0)
    v_max_u32 v251, v187, v191
    v_max3_u32 v251, v251, v195, v199
    v_cmp_eq_u32 vcc, -1, v251
    s_nop 0
    s_cbranch_vccnz CK_45_r
    s_branch CK_45_k
CK_46_r:
    s_cmp_le_i32 s52, 0
    s_cbranch_scc1 CK_46_k
    s_sub_u32 s52, s52, 1
    s_sleep 1
    buffer_load_dwordx4 v[200:203], v240, s[36:39], s90 offen offset:0 sc1
    buffer_load_dwordx4 v[204:207], v240, s[36:39], s90 offen offset:1024 sc1
    buffer_load_dwordx4 v[208:211], v240, s[36:39], s90 offen offset:2048 sc1
    buffer_load_dwordx4 v[212:215], v240, s[36:39], s90 offen offset:3072 sc1
    buffer_load_dwordx4 v[104:107], v241, s[36:39], s90 offen offset:0 sc1
    buffer_load_dwordx4 v[108:111], v241, s[36:39], s90 offen offset:1024 sc1
    buffer_load_dwordx4 v[112:115], v241, s[36:39], s90 offen offset:2048 sc1
    buffer_load_dwordx4 v[116:119], v241, s[36:39], s90 offen offset:3072 sc1
    buffer_load_dwordx4 v[120:123], v240, s[36:39], s91 offen offset:0 sc1
    buffer_load_dwordx4 v[124:127], v240, s[36:39], s91 offen offset:1024 sc1
    buffer_load_dwordx4 v[128:131], v240, s[36:39], s91 offen offset:2048 sc1
    buffer_load_dwordx4 v[132:135], v240, s[36:39], s91 offen offset:3072 sc1
    s_waitcnt vmcnt(0)
    v_max_u32 v251, v203, v207
    v_max3_u32 v251, v251, v211, v215
    v_cmp_eq_u32 vcc, -1, v251
    s_nop 0
    s_cbranch_vccnz CK_46_r
    s_branch CK_46_k
CK_47_r:
    s_cmp_le_i32 s52, 0
    s_cbranch_scc1 CK_47_k
    s_sub_u32 s52, s52, 1
    s_sleep 1
    buffer_load_dwordx4 v[104:107], v241, s[36:39], s90 offen offset:0 sc1
    buffer_load_dwordx4 v[108:111], v241, s[36:39], s90 offen offset:1024 sc1
    buffer_load_dwordx4 v[112:115], v241, s[36:39], s90 offen offset:2048 sc1
    buffer_load_dwordx4 v[116:119], v241, s[36:39], s90 offen offset:3072 sc1
    buffer_load_dwordx4 v[120:123], v240, s[36:39], s91 offen offset:0 sc1
    buffer_load_dwordx4 v[124:127], v240, s[36:39], s91 offen offset:1024 sc1
    buffer_load_dwordx4 v[128:131], v240, s[36:39], s91 offen offset:2048 sc1
    buffer_load_dwordx4 v[132:135], v240, s[36:39], s91 offen offset:3072 sc1
    buffer_load_dwordx4 v[136:139], v240, s[36:39], s94 offen offset:0 sc1
    buffer_load_dwordx4 v[140:143], v240, s[36:39], s94 offen offset:1024 sc1
    buffer_load_dwordx4 v[144:147], v240, s[36:39], s94 offen offset:2048 sc1
    buffer_load_dwordx4 v[148:151], v240, s[36:39], s94 offen offset:3072 sc1
    s_waitcnt vmcnt(0)
    v_max_u32 v251, v107, v111
    v_max3_u32 v251, v251, v115, v119
    v_cmp_eq_u32 vcc, -1, v251
    s_nop 0
    s_cbranch_vccnz CK_47_r
    s_branch CK_47_k
CK_48_r:
    s_cmp_le_i32 s52, 0
    s_cbranch_scc1 CK_48_k
    s_sub_u32 s52, s52, 1
    s_sleep 1
    buffer_load_dwordx4 v[120:123], v240, s[36:39], s91 offen offset:0 sc1
    buffer_load_dwordx4 v[124:127], v240, s[36:39], s91 offen offset:1024 sc1
    buffer_load_dwordx4 v[128:131], v240, s[36:39], s91 offen offset:2048 sc1
    buffer_load_dwordx4 v[132:135], v240, s[36:39], s91 offen offset:3072 sc1
    buffer_load_dwordx4 v[136:139], v240, s[36:39], s94 offen offset:0 sc1
    buffer_load_dwordx4 v[140:143], v240, s[36:39], s94 offen offset:1024 sc1
    buffer_load_dwordx4 v[144:147], v240, s[36:39], s94 offen offset:2048 sc1
    buffer_load_dwordx4 v[148:151], v240, s[36:39], s94 offen offset:3072 sc1
    buffer_load_dwordx4 v[152:155], v241, s[36:39], s94 offen offset:0 sc1
    buffer_load_dwordx4 v[156:159], v241, s[36:39], s94 offen offset:1024 sc1
    buffer_load_dwordx4 v[160:163], v241, s[36:39], s94 offen offset:2048 sc1
    buffer_load_dwordx4 v[164:167], v241, s[36:39], s94 offen offset:3072 sc1
    s_waitcnt vmcnt(0)
    v_max_u32 v251, v123, v127
    v_max3_u32 v251, v251, v131, v135
    v_cmp_eq_u32 vcc, -1, v251
    s_nop 0
    s_cbranch_vccnz CK_48_r
    s_branch CK_48_k
CK_49_r:
    s_cmp_le_i32 s52, 0
    s_cbranch_scc1 CK_49_k
    s_sub_u32 s52, s52, 1
    s_sleep 1
    buffer_load_dwordx4 v[136:139], v240, s[36:39], s94 offen offset:0 sc1
    buffer_load_dwordx4 v[140:143], v240, s[36:39], s94 offen offset:1024 sc1
    buffer_load_dwordx4 v[144:147], v240, s[36:39], s94 offen offset:2048 sc1
    buffer_load_dwordx4 v[148:151], v240, s[36:39], s94 offen offset:3072 sc1
    buffer_load_dwordx4 v[152:155], v241, s[36:39], s94 offen offset:0 sc1
    buffer_load_dwordx4 v[156:159], v241, s[36:39], s94 offen offset:1024 sc1
    buffer_load_dwordx4 v[160:163], v241, s[36:39], s94 offen offset:2048 sc1
    buffer_load_dwordx4 v[164:167], v241, s[36:39], s94 offen offset:3072 sc1
    buffer_load_dwordx4 v[168:171], v240, s[36:39], s95 offen offset:0 sc1
    buffer_load_dwordx4 v[172:175], v240, s[36:39], s95 offen offset:1024 sc1
    buffer_load_dwordx4 v[176:179], v240, s[36:39], s95 offen offset:2048 sc1
    buffer_load_dwordx4 v[180:183], v240, s[36:39], s95 offen offset:3072 sc1
    s_waitcnt vmcnt(0)
    v_max_u32 v251, v139, v143
    v_max3_u32 v251, v251, v147, v151
    v_cmp_eq_u32 vcc, -1, v251
    s_nop 0
    s_cbranch_vccnz CK_49_r
    s_branch CK_49_k
CK_50_r:
    s_cmp_le_i32 s52, 0
    s_cbranch_scc1 CK_50_k
    s_sub_u32 s52, s52, 1
    s_sleep 1
    buffer_load_dwordx4 v[152:155], v241, s[36:39], s94 offen offset:0 sc1
    buffer_load_dwordx4 v[156:159], v241, s[36:39], s94 offen offset:1024 sc1
    buffer_load_dwordx4 v[160:163], v241, s[36:39], s94 offen offset:2048 sc1
    buffer_load_dwordx4 v[164:167], v241, s[36:39], s94 offen offset:3072 sc1
    buffer_load_dwordx4 v[168:171], v240, s[36:39], s95 offen offset:0 sc1
    buffer_load_dwordx4 v[172:175], v240, s[36:39], s95 offen offset:1024 sc1
    buffer_load_dwordx4 v[176:179], v240, s[36:39], s95 offen offset:2048 sc1
    buffer_load_dwordx4 v[180:183], v240, s[36:39], s95 offen offset:3072 sc1
    buffer_load_dwordx4 v[184:187], v240, s[36:39], s92 offen offset:0 sc1
    buffer_load_dwordx4 v[188:191], v240, s[36:39], s92 offen offset:1024 sc1
    buffer_load_dwordx4 v[192:195], v240, s[36:39], s92 offen offset:2048 sc1
    buffer_load_dwordx4 v[196:199], v240, s[36:39], s92 offen offset:3072 sc1
    s_waitcnt vmcnt(0)
    v_max_u32 v251, v155, v159
    v_max3_u32 v251, v251, v163, v167
    v_cmp_eq_u32 vcc, -1, v251
    s_nop 0
    s_cbranch_vccnz CK_50_r
    s_branch CK_50_k
LS_52_g:
    buffer_store_dwordx4 v[24:27], v240, s[36:39], s64 offen sc1
    buffer_store_dwordx4 v[28:31], v240, s[36:39], s64 offen offset:1024 sc1
    s_branch LS_52_r
OE_51:
    s_nop 0
    ds_read_b128 v[112:115], v1 offset:45056
    ds_read_b128 v[116:119], v1 offset:46080
    ds_read_b128 v[120:123], v1 offset:47104
    ds_read_b128 v[124:127], v1 offset:48128
    ds_read_b128 v[128:131], v2 offset:40960
    ds_read_b128 v[132:135], v2 offset:41984
    ds_read_b128 v[136:139], v2 offset:43008
    ds_read_b128 v[140:143], v2 offset:44032
    ds_read_b128 v[144:147], v3 offset:45056
    ds_read_b128 v[148:151], v3 offset:46080
    ds_read_b128 v[152:155], v3 offset:47104
    ds_read_b128 v[156:159], v3 offset:48128
    v_pk_add_f32 v[224:225], v[224:225], v[8:9]
    v_pk_add_f32 v[226:227], v[226:227], v[10:11]
    v_pk_add_f32 v[228:229], v[228:229], v[12:13]
    v_pk_add_f32 v[230:231], v[230:231], v[14:15]
    v_pk_add_f32 v[232:233], v[232:233], v[16:17]
    v_pk_add_f32 v[234:235], v[234:235], v[18:19]
    v_pk_add_f32 v[236:237], v[236:237], v[20:21]
    v_pk_add_f32 v[238:239], v[238:239], v[22:23]
    s_waitcnt lgkmcnt(8)
    s_nop 0
    v_pk_add_f32 v[224:225], v[224:225], v[112:113]
    v_pk_add_f32 v[226:227], v[226:227], v[114:115]
    v_pk_add_f32 v[228:229], v[228:229], v[116:117]
    v_pk_add_f32 v[230:231], v[230:231], v[118:119]
    v_pk_add_f32 v[232:233], v[232:233], v[120:121]
    v_pk_add_f32 v[234:235], v[234:235], v[122:123]
    v_pk_add_f32 v[236:237], v[236:237], v[124:125]
    v_pk_add_f32 v[238:239], v[238:239], v[126:127]
    s_waitcnt lgkmcnt(4)
    s_nop 0
    v_pk_add_f32 v[224:225], v[224:225], v[128:129]
    v_pk_add_f32 v[226:227], v[226:227], v[130:131]
    v_pk_add_f32 v[228:229], v[228:229], v[132:133]
    v_pk_add_f32 v[230:231], v[230:231], v[134:135]
    v_pk_add_f32 v[232:233], v[232:233], v[136:137]
    v_pk_add_f32 v[234:235], v[234:235], v[138:139]
    v_pk_add_f32 v[236:237], v[236:237], v[140:141]
    v_pk_add_f32 v[238:239], v[238:239], v[142:143]
    s_waitcnt lgkmcnt(0)
    s_nop 0
    v_pk_add_f32 v[224:225], v[224:225], v[144:145]
    v_pk_add_f32 v[226:227], v[226:227], v[146:147]
    v_pk_add_f32 v[228:229], v[228:229], v[148:149]
    v_pk_add_f32 v[230:231], v[230:231], v[150:151]
    v_pk_add_f32 v[232:233], v[232:233], v[152:153]
    v_pk_add_f32 v[234:235], v[234:235], v[154:155]
    v_pk_add_f32 v[236:237], v[236:237], v[156:157]
    v_pk_add_f32 v[238:239], v[238:239], v[158:159]
    v_cvt_pk_bf16_f32 v24, v224, v225
    v_cvt_pk_bf16_f32 v25, v226, v227
    v_cvt_pk_bf16_f32 v26, v228, v229
    v_cvt_pk_bf16_f32 v27, v230, v231
    v_cvt_pk_bf16_f32 v28, v232, v233
    v_cvt_pk_bf16_f32 v29, v234, v235
    v_cvt_pk_bf16_f32 v30, v236, v237
    v_cvt_pk_bf16_f32 v31, v238, v239
    s_cmp_eq_u32 s100, 0
    s_cbranch_scc1 LS_52_g
    buffer_store_dwordx4 v[24:27], v240, s[36:39], s64 offen
    buffer_store_dwordx4 v[28:31], v240, s[36:39], s64 offen offset:1024
LS_52_r:
    s_branch OE_51_r
CK_53_r:
    s_cmp_le_i32 s52, 0
    s_cbranch_scc1 CK_53_k
    s_sub_u32 s52, s52, 1
    s_sleep 1
    s_nop 0
    buffer_load_dwordx4 v[168:171], v240, s[36:39], s95 offen offset:0 sc1
    buffer_load_dwordx4 v[172:175], v240, s[36:39], s95 offen offset:1024 sc1
    buffer_load_dwordx4 v[176:179], v240, s[36:39], s95 offen offset:2048 sc1
    buffer_load_dwordx4 v[180:183], v240, s[36:39], s95 offen offset:3072 sc1
    buffer_load_dwordx4 v[184:187], v240, s[36:39], s92 offen offset:0 sc1
    buffer_load_dwordx4 v[188:191], v240, s[36:39], s92 offen offset:1024 sc1
    buffer_load_dwordx4 v[192:195], v240, s[36:39], s92 offen offset:2048 sc1
    buffer_load_dwordx4 v[196:199], v240, s[36:39], s92 offen offset:3072 sc1
    buffer_load_dwordx4 v[200:203], v241, s[36:39], s92 offen offset:0 sc1
    buffer_load_dwordx4 v[204:207], v241, s[36:39], s92 offen offset:1024 sc1
    buffer_load_dwordx4 v[208:211], v241, s[36:39], s92 offen offset:2048 sc1
    buffer_load_dwordx4 v[212:215], v241, s[36:39], s92 offen offset:3072 sc1
    s_waitcnt vmcnt(0)
    v_max_u32 v251, v171, v175
    v_max3_u32 v251, v251, v179, v183
    v_cmp_eq_u32 vcc, -1, v251
    s_nop 0
    s_cbranch_vccnz CK_53_r
    s_branch CK_53_k
CK_54_r:
    s_cmp_le_i32 s52, 0
    s_cbranch_scc1 CK_54_k
    s_sub_u32 s52, s52, 1
    s_sleep 1
    buffer_load_dwordx4 v[184:187], v240, s[36:39], s92 offen offset:0 sc1
    buffer_load_dwordx4 v[188:191], v240, s[36:39], s92 offen offset:1024 sc1
    buffer_load_dwordx4 v[192:195], v240, s[36:39], s92 offen offset:2048 sc1
    buffer_load_dwordx4 v[196:199], v240, s[36:39], s92 offen offset:3072 sc1
    buffer_load_dwordx4 v[200:203], v241, s[36:39], s92 offen offset:0 sc1
    buffer_load_dwordx4 v[204:207], v241, s[36:39], s92 offen offset:1024 sc1
    buffer_load_dwordx4 v[208:211], v241, s[36:39], s92 offen offset:2048 sc1
    buffer_load_dwordx4 v[212:215], v241, s[36:39], s92 offen offset:3072 sc1
    buffer_load_dwordx4 v[104:107], v240, s[36:39], s93 offen offset:0 sc1
    buffer_load_dwordx4 v[108:111], v240, s[36:39], s93 offen offset:1024 sc1
    buffer_load_dwordx4 v[112:115], v240, s[36:39], s93 offen offset:2048 sc1
    buffer_load_dwordx4 v[116:119], v240, s[36:39], s93 offen offset:3072 sc1
    s_waitcnt vmcnt(0)
    v_max_u32 v251, v187, v191
    v_max3_u32 v251, v251, v195, v199
    v_cmp_eq_u32 vcc, -1, v251
    s_nop 0
    s_cbranch_vccnz CK_54_r
    s_branch CK_54_k
CK_55_r:
    s_cmp_le_i32 s52, 0
    s_cbranch_scc1 CK_55_k
    s_sub_u32 s52, s52, 1
    s_sleep 1
    buffer_load_dwordx4 v[200:203], v241, s[36:39], s92 offen offset:0 sc1
    buffer_load_dwordx4 v[204:207], v241, s[36:39], s92 offen offset:1024 sc1
    buffer_load_dwordx4 v[208:211], v241, s[36:39], s92 offen offset:2048 sc1
    buffer_load_dwordx4 v[212:215], v241, s[36:39], s92 offen offset:3072 sc1
    buffer_load_dwordx4 v[104:107], v240, s[36:39], s93 offen offset:0 sc1
    buffer_load_dwordx4 v[108:111], v240, s[36:39], s93 offen offset:1024 sc1
    buffer_load_dwordx4 v[112:115], v240, s[36:39], s93 offen offset:2048 sc1
    buffer_load_dwordx4 v[116:119], v240, s[36:39], s93 offen offset:3072 sc1
    buffer_load_dwordx4 v[120:123], v241, s[36:39], s93 offen offset:0 sc1
    buffer_load_dwordx4 v[124:127], v241, s[36:39], s93 offen offset:1024 sc1
    buffer_load_dwordx4 v[128:131], v241, s[36:39], s93 offen offset:2048 sc1
    buffer_load_dwordx4 v[132:135], v241, s[36:39], s93 offen offset:3072 sc1
    s_waitcnt vmcnt(0)
    v_max_u32 v251, v203, v207
    v_max3_u32 v251, v251, v211, v215
    v_cmp_eq_u32 vcc, -1, v251
    s_nop 0
    s_cbranch_vccnz CK_55_r
    s_branch CK_55_k
CK_56_r:
    s_cmp_le_i32 s52, 0
    s_cbranch_scc1 CK_56_k
    s_sub_u32 s52, s52, 1
    s_sleep 1
    buffer_load_dwordx4 v[104:107], v240, s[36:39], s93 offen offset:0 sc1
    buffer_load_dwordx4 v[108:111], v240, s[36:39], s93 offen offset:1024 sc1
    buffer_load_dwordx4 v[112:115], v240, s[36:39], s93 offen offset:2048 sc1
    buffer_load_dwordx4 v[116:119], v240, s[36:39], s93 offen offset:3072 sc1
    buffer_load_dwordx4 v[120:123], v241, s[36:39], s93 offen offset:0 sc1
    buffer_load_dwordx4 v[124:127], v241, s[36:39], s93 offen offset:1024 sc1
    buffer_load_dwordx4 v[128:131], v241, s[36:39], s93 offen offset:2048 sc1
    buffer_load_dwordx4 v[132:135], v241, s[36:39], s93 offen offset:3072 sc1
    s_waitcnt vmcnt(0)
    v_max_u32 v251, v107, v111
    v_max3_u32 v251, v251, v115, v119
    v_cmp_eq_u32 vcc, -1, v251
    s_nop 0
    s_cbranch_vccnz CK_56_r
    s_branch CK_56_k
CK_57_r:
    s_cmp_le_i32 s52, 0
    s_cbranch_scc1 CK_57_k
    s_sub_u32 s52, s52, 1
    s_sleep 1
    buffer_load_dwordx4 v[120:123], v241, s[36:39], s93 offen offset:0 sc1
    buffer_load_dwordx4 v[124:127], v241, s[36:39], s93 offen offset:1024 sc1
    buffer_load_dwordx4 v[128:131], v241, s[36:39], s93 offen offset:2048 sc1
    buffer_load_dwordx4 v[132:135], v241, s[36:39], s93 offen offset:3072 sc1
    s_waitcnt vmcnt(0)
    v_max_u32 v251, v123, v127
    v_max3_u32 v251, v251, v131, v135
    v_cmp_eq_u32 vcc, -1, v251
    s_nop 0
    s_cbranch_vccnz CK_57_r
    s_branch CK_57_k
LS_59_g:
    buffer_store_dwordx4 v[152:155], v240, s[36:39], s64 offen sc1
    buffer_store_dwordx4 v[156:159], v240, s[36:39], s64 offen offset:1024 sc1
    s_branch LS_59_r
OE_58:
    s_nop 0
    ds_read_b128 v[176:179], v1 offset:36864
    ds_read_b128 v[180:183], v1 offset:37888
    ds_read_b128 v[184:187], v1 offset:38912
    ds_read_b128 v[188:191], v1 offset:39936
    ds_read_b128 v[192:195], v2 offset:32768
    ds_read_b128 v[196:199], v2 offset:33792
    ds_read_b128 v[200:203], v2 offset:34816
    ds_read_b128 v[204:207], v2 offset:35840
    ds_read_b128 v[208:211], v3 offset:36864
    ds_read_b128 v[212:215], v3 offset:37888
    ds_read_b128 v[216:219], v3 offset:38912
    ds_read_b128 v[220:223], v3 offset:39936
    v_pk_add_f32 v[224:225], v[224:225], v[40:41]
    v_pk_add_f32 v[226:227], v[226:227], v[42:43]
    v_pk_add_f32 v[228:229], v[228:229], v[44:45]
    v_pk_add_f32 v[230:231], v[230:231], v[46:47]
    v_pk_add_f32 v[232:233], v[232:233], v[48:49]
    v_pk_add_f32 v[234:235], v[234:235], v[50:51]
    v_pk_add_f32 v[236:237], v[236:237], v[52:53]
    v_pk_add_f32 v[238:239], v[238:239], v[54:55]
    s_waitcnt lgkmcnt(8)
    s_nop 0
    v_pk_add_f32 v[224:225], v[224:225], v[176:177]
    v_pk_add_f32 v[226:227], v[226:227], v[178:179]
    v_pk_add_f32 v[228:229], v[228:229], v[180:181]
    v_pk_add_f32 v[230:231], v[230:231], v[182:183]
    v_pk_add_f32 v[232:233], v[232:233], v[184:185]
    v_pk_add_f32 v[234:235], v[234:235], v[186:187]
    v_pk_add_f32 v[236:237], v[236:237], v[188:189]
    v_pk_add_f32 v[238:239], v[238:239], v[190:191]
    s_waitcnt lgkmcnt(4)
    s_nop 0
    v_pk_add_f32 v[224:225], v[224:225], v[192:193]
    v_pk_add_f32 v[226:227], v[226:227], v[194:195]
    v_pk_add_f32 v[228:229], v[228:229], v[196:197]
    v_pk_add_f32 v[230:231], v[230:231], v[198:199]
    v_pk_add_f32 v[232:233], v[232:233], v[200:201]
    v_pk_add_f32 v[234:235], v[234:235], v[202:203]
    v_pk_add_f32 v[236:237], v[236:237], v[204:205]
    v_pk_add_f32 v[238:239], v[238:239], v[206:207]
    s_waitcnt lgkmcnt(0)
    s_nop 0
    v_pk_add_f32 v[224:225], v[224:225], v[208:209]
    v_pk_add_f32 v[226:227], v[226:227], v[210:211]
    v_pk_add_f32 v[228:229], v[228:229], v[212:213]
    v_pk_add_f32 v[230:231], v[230:231], v[214:215]
    v_pk_add_f32 v[232:233], v[232:233], v[216:217]
    v_pk_add_f32 v[234:235], v[234:235], v[218:219]
    v_pk_add_f32 v[236:237], v[236:237], v[220:221]
    v_pk_add_f32 v[238:239], v[238:239], v[222:223]
    v_cvt_pk_bf16_f32 v152, v224, v225
    v_cvt_pk_bf16_f32 v153, v226, v227
    v_cvt_pk_bf16_f32 v154, v228, v229
    v_cvt_pk_bf16_f32 v155, v230, v231
    v_cvt_pk_bf16_f32 v156, v232, v233
    v_cvt_pk_bf16_f32 v157, v234, v235
    v_cvt_pk_bf16_f32 v158, v236, v237
    v_cvt_pk_bf16_f32 v159, v238, v239
    s_cmp_eq_u32 s100, 0
    s_cbranch_scc1 LS_59_g
    buffer_store_dwordx4 v[152:155], v240, s[36:39], s64 offen
    buffer_store_dwordx4 v[156:159], v240, s[36:39], s64 offen offset:1024
LS_59_r:
    s_branch OE_58_r
LS_60_g:
    buffer_store_dwordx2 v[144:145], v245, s[36:39], s65 offen sc1
    s_branch LS_60_r
CK_61_r:
    s_cmp_le_i32 s52, 0
    s_cbranch_scc1 CK_61_k
    s_sub_u32 s52, s52, 1
    s_sleep 1
    buffer_load_dwordx4 v[120:123], v240, s[36:39], s84 offen offset:0 sc1
    buffer_load_dwordx4 v[124:127], v240, s[36:39], s84 offen offset:1024 sc1
    buffer_load_dwordx4 v[128:131], v240, s[36:39], s84 offen offset:2048 sc1
    buffer_load_dwordx4 v[132:135], v240, s[36:39], s84 offen offset:3072 sc1
    buffer_load_dwordx4 v[136:139], v241, s[36:39], s84 offen offset:0 sc1
    buffer_load_dwordx4 v[140:143], v241, s[36:39], s84 offen offset:1024 sc1
    buffer_load_dwordx4 v[144:147], v241, s[36:39], s84 offen offset:2048 sc1
    buffer_load_dwordx4 v[148:151], v241, s[36:39], s84 offen offset:3072 sc1
    buffer_load_dwordx4 v[152:155], v240, s[36:39], s85 offen offset:0 sc1
    buffer_load_dwordx4 v[156:159], v240, s[36:39], s85 offen offset:1024 sc1
    buffer_load_dwordx4 v[160:163], v240, s[36:39], s85 offen offset:2048 sc1
    buffer_load_dwordx4 v[164:167], v240, s[36:39], s85 offen offset:3072 sc1
    buffer_load_dwordx4 v[168:171], v241, s[36:39], s85 offen offset:0 sc1
    buffer_load_dwordx4 v[172:175], v241, s[36:39], s85 offen offset:1024 sc1
    buffer_load_dwordx4 v[176:179], v241, s[36:39], s85 offen offset:2048 sc1
    buffer_load_dwordx4 v[180:183], v241, s[36:39], s85 offen offset:3072 sc1
    buffer_load_dwordx4 v[184:187], v240, s[36:39], s86 offen offset:0 sc1
    buffer_load_dwordx4 v[188:191], v240, s[36:39], s86 offen offset:1024 sc1
    buffer_load_dwordx4 v[192:195], v240, s[36:39], s86 offen offset:2048 sc1
    buffer_load_dwordx4 v[196:199], v240, s[36:39], s86 offen offset:3072 sc1
    s_waitcnt vmcnt(0)
    v_max_u32 v251, v123, v127
    v_max3_u32 v251, v251, v131, v135
    v_cmp_eq_u32 vcc, -1, v251
    s_nop 0
    s_cbranch_vccnz CK_61_r
    s_branch CK_61_k
CK_62_r:
    s_cmp_le_i32 s52, 0
    s_cbranch_scc1 CK_62_k
    s_sub_u32 s52, s52, 1
    s_sleep 1
    buffer_load_dwordx4 v[136:139], v241, s[36:39], s84 offen offset:0 sc1
    buffer_load_dwordx4 v[140:143], v241, s[36:39], s84 offen offset:1024 sc1
    buffer_load_dwordx4 v[144:147], v241, s[36:39], s84 offen offset:2048 sc1
    buffer_load_dwordx4 v[148:151], v241, s[36:39], s84 offen offset:3072 sc1
    buffer_load_dwordx4 v[152:155], v240, s[36:39], s85 offen offset:0 sc1
    buffer_load_dwordx4 v[156:159], v240, s[36:39], s85 offen offset:1024 sc1
    buffer_load_dwordx4 v[160:163], v240, s[36:39], s85 offen offset:2048 sc1
    buffer_load_dwordx4 v[164:167], v240, s[36:39], s85 offen offset:3072 sc1
    buffer_load_dwordx4 v[168:171], v241, s[36:39], s85 offen offset:0 sc1
    buffer_load_dwordx4 v[172:175], v241, s[36:39], s85 offen offset:1024 sc1
    buffer_load_dwordx4 v[176:179], v241, s[36:39], s85 offen offset:2048 sc1
    buffer_load_dwordx4 v[180:183], v241, s[36:39], s85 offen offset:3072 sc1
    buffer_load_dwordx4 v[184:187], v240, s[36:39], s86 offen offset:0 sc1
    buffer_load_dwordx4 v[188:191], v240, s[36:39], s86 offen offset:1024 sc1
    buffer_load_dwordx4 v[192:195], v240, s[36:39], s86 offen offset:2048 sc1
    buffer_load_dwordx4 v[196:199], v240, s[36:39], s86 offen offset:3072 sc1
    s_waitcnt vmcnt(0)
    v_max_u32 v251, v139, v143
    v_max3_u32 v251, v251, v147, v151
    v_cmp_eq_u32 vcc, -1, v251
    s_nop 0
    s_cbranch_vccnz CK_62_r
    s_branch CK_62_k
CK_63_r:
    s_cmp_le_i32 s52, 0
    s_cbranch_scc1 CK_63_k
    s_sub_u32 s52, s52, 1
    s_sleep 1
    buffer_load_dwordx4 v[152:155], v240, s[36:39], s85 offen offset:0 sc1
    buffer_load_dwordx4 v[156:159], v240, s[36:39], s85 offen offset:1024 sc1
    buffer_load_dwordx4 v[160:163], v240, s[36:39], s85 offen offset:2048 sc1
    buffer_load_dwordx4 v[164:167], v240, s[36:39], s85 offen offset:3072 sc1
    buffer_load_dwordx4 v[168:171], v241, s[36:39], s85 offen offset:0 sc1
    buffer_load_dwordx4 v[172:175], v241, s[36:39], s85 offen offset:1024 sc1
    buffer_load_dwordx4 v[176:179], v241, s[36:39], s85 offen offset:2048 sc1
    buffer_load_dwordx4 v[180:183], v241, s[36:39], s85 offen offset:3072 sc1
    buffer_load_dwordx4 v[184:187], v240, s[36:39], s86 offen offset:0 sc1
    buffer_load_dwordx4 v[188:191], v240, s[36:39], s86 offen offset:1024 sc1
    buffer_load_dwordx4 v[192:195], v240, s[36:39], s86 offen offset:2048 sc1
    buffer_load_dwordx4 v[196:199], v240, s[36:39], s86 offen offset:3072 sc1
    s_waitcnt vmcnt(0)
    v_max_u32 v251, v155, v159
    v_max3_u32 v251, v251, v163, v167
    v_cmp_eq_u32 vcc, -1, v251
    s_nop 0
    s_cbranch_vccnz CK_63_r
    s_branch CK_63_k
CK_64_r:
    s_cmp_le_i32 s52, 0
    s_cbranch_scc1 CK_64_k
    s_sub_u32 s52, s52, 1
    s_sleep 1
    buffer_load_dwordx4 v[168:171], v241, s[36:39], s85 offen offset:0 sc1
    buffer_load_dwordx4 v[172:175], v241, s[36:39], s85 offen offset:1024 sc1
    buffer_load_dwordx4 v[176:179], v241, s[36:39], s85 offen offset:2048 sc1
    buffer_load_dwordx4 v[180:183], v241, s[36:39], s85 offen offset:3072 sc1
    buffer_load_dwordx4 v[184:187], v240, s[36:39], s86 offen offset:0 sc1
    buffer_load_dwordx4 v[188:191], v240, s[36:39], s86 offen offset:1024 sc1
    buffer_load_dwordx4 v[192:195], v240, s[36:39], s86 offen offset:2048 sc1
    buffer_load_dwordx4 v[196:199], v240, s[36:39], s86 offen offset:3072 sc1
    buffer_load_dwordx4 v[200:203], v241, s[36:39], s86 offen offset:0 sc1
    buffer_load_dwordx4 v[204:207], v241, s[36:39], s86 offen offset:1024 sc1
    buffer_load_dwordx4 v[208:211], v241, s[36:39], s86 offen offset:2048 sc1
    buffer_load_dwordx4 v[212:215], v241, s[36:39], s86 offen offset:3072 sc1
    s_waitcnt vmcnt(0)
    v_max_u32 v251, v171, v175
    v_max3_u32 v251, v251, v179, v183
    v_cmp_eq_u32 vcc, -1, v251
    s_nop 0
    s_cbranch_vccnz CK_64_r
    s_branch CK_64_k
CK_65_r:
    s_cmp_le_i32 s52, 0
    s_cbranch_scc1 CK_65_k
    s_sub_u32 s52, s52, 1
    s_sleep 1
    buffer_load_dwordx4 v[184:187], v240, s[36:39], s86 offen offset:0 sc1
    buffer_load_dwordx4 v[188:191], v240, s[36:39], s86 offen offset:1024 sc1
    buffer_load_dwordx4 v[192:195], v240, s[36:39], s86 offen offset:2048 sc1
    buffer_load_dwordx4 v[196:199], v240, s[36:39], s86 offen offset:3072 sc1
    buffer_load_dwordx4 v[200:203], v241, s[36:39], s86 offen offset:0 sc1
    buffer_load_dwordx4 v[204:207], v241, s[36:39], s86 offen offset:1024 sc1
    buffer_load_dwordx4 v[208:211], v241, s[36:39], s86 offen offset:2048 sc1
    buffer_load_dwordx4 v[212:215], v241, s[36:39], s86 offen offset:3072 sc1
    buffer_load_dwordx4 v[104:107], v240, s[36:39], s87 offen offset:0 sc1
    buffer_load_dwordx4 v[108:111], v240, s[36:39], s87 offen offset:1024 sc1
    buffer_load_dwordx4 v[112:115], v240, s[36:39], s87 offen offset:2048 sc1
    buffer_load_dwordx4 v[116:119], v240, s[36:39], s87 offen offset:3072 sc1
    s_waitcnt vmcnt(0)
    v_max_u32 v251, v187, v191
    v_max3_u32 v251, v251, v195, v199
    v_cmp_eq_u32 vcc, -1, v251
    s_nop 0
    s_cbranch_vccnz CK_65_r
    s_branch CK_65_k
CK_66_r:
    s_cmp_le_i32 s52, 0
    s_cbranch_scc1 CK_66_k
    s_sub_u32 s52, s52, 1
    s_sleep 1
    buffer_load_dwordx4 v[200:203], v241, s[36:39], s86 offen offset:0 sc1
    buffer_load_dwordx4 v[204:207], v241, s[36:39], s86 offen offset:1024 sc1
    buffer_load_dwordx4 v[208:211], v241, s[36:39], s86 offen offset:2048 sc1
    buffer_load_dwordx4 v[212:215], v241, s[36:39], s86 offen offset:3072 sc1
    buffer_load_dwordx4 v[104:107], v240, s[36:39], s87 offen offset:0 sc1
    buffer_load_dwordx4 v[108:111], v240, s[36:39], s87 offen offset:1024 sc1
    buffer_load_dwordx4 v[112:115], v240, s[36:39], s87 offen offset:2048 sc1
    buffer_load_dwordx4 v[116:119], v240, s[36:39], s87 offen offset:3072 sc1
    buffer_load_dwordx4 v[120:123], v241, s[36:39], s87 offen offset:0 sc1
    buffer_load_dwordx4 v[124:127], v241, s[36:39], s87 offen offset:1024 sc1
    buffer_load_dwordx4 v[128:131], v241, s[36:39], s87 offen offset:2048 sc1
    buffer_load_dwordx4 v[132:135], v241, s[36:39], s87 offen offset:3072 sc1
    s_waitcnt vmcnt(0)
    v_max_u32 v251, v203, v207
    v_max3_u32 v251, v251, v211, v215
    v_cmp_eq_u32 vcc, -1, v251
    s_nop 0
    s_cbranch_vccnz CK_66_r
    s_branch CK_66_k
CK_67_r:
    s_cmp_le_i32 s52, 0
    s_cbranch_scc1 CK_67_k
    s_sub_u32 s52, s52, 1
    s_sleep 1
    buffer_load_dwordx4 v[104:107], v240, s[36:39], s87 offen offset:0 sc1
    buffer_load_dwordx4 v[108:111], v240, s[36:39], s87 offen offset:1024 sc1
    buffer_load_dwordx4 v[112:115], v240, s[36:39], s87 offen offset:2048 sc1
    buffer_load_dwordx4 v[116:119], v240, s[36:39], s87 offen offset:3072 sc1
    buffer_load_dwordx4 v[120:123], v241, s[36:39], s87 offen offset:0 sc1
    buffer_load_dwordx4 v[124:127], v241, s[36:39], s87 offen offset:1024 sc1
    buffer_load_dwordx4 v[128:131], v241, s[36:39], s87 offen offset:2048 sc1
    buffer_load_dwordx4 v[132:135], v241, s[36:39], s87 offen offset:3072 sc1
    buffer_load_dwordx4 v[136:139], v240, s[36:39], s88 offen offset:0 sc1
    buffer_load_dwordx4 v[140:143], v240, s[36:39], s88 offen offset:1024 sc1
    buffer_load_dwordx4 v[144:147], v240, s[36:39], s88 offen offset:2048 sc1
    buffer_load_dwordx4 v[148:151], v240, s[36:39], s88 offen offset:3072 sc1
    s_waitcnt vmcnt(0)
    v_max_u32 v251, v107, v111
    v_max3_u32 v251, v251, v115, v119
    v_cmp_eq_u32 vcc, -1, v251
    s_nop 0
    s_cbranch_vccnz CK_67_r
    s_branch CK_67_k
CK_68_r:
    s_cmp_le_i32 s52, 0
    s_cbranch_scc1 CK_68_k
    s_sub_u32 s52, s52, 1
    s_sleep 1
    buffer_load_dwordx4 v[120:123], v241, s[36:39], s87 offen offset:0 sc1
    buffer_load_dwordx4 v[124:127], v241, s[36:39], s87 offen offset:1024 sc1
    buffer_load_dwordx4 v[128:131], v241, s[36:39], s87 offen offset:2048 sc1
    buffer_load_dwordx4 v[132:135], v241, s[36:39], s87 offen offset:3072 sc1
    buffer_load_dwordx4 v[136:139], v240, s[36:39], s88 offen offset:0 sc1
    buffer_load_dwordx4 v[140:143], v240, s[36:39], s88 offen offset:1024 sc1
    buffer_load_dwordx4 v[144:147], v240, s[36:39], s88 offen offset:2048 sc1
    buffer_load_dwordx4 v[148:151], v240, s[36:39], s88 offen offset:3072 sc1
    buffer_load_dwordx4 v[152:155], v241, s[36:39], s88 offen offset:0 sc1
    buffer_load_dwordx4 v[156:159], v241, s[36:39], s88 offen offset:1024 sc1
    buffer_load_dwordx4 v[160:163], v241, s[36:39], s88 offen offset:2048 sc1
    buffer_load_dwordx4 v[164:167], v241, s[36:39], s88 offen offset:3072 sc1
    s_waitcnt vmcnt(0)
    v_max_u32 v251, v123, v127
    v_max3_u32 v251, v251, v131, v135
    v_cmp_eq_u32 vcc, -1, v251
    s_nop 0
    s_cbranch_vccnz CK_68_r
    s_branch CK_68_k
CK_69_r:
    s_cmp_le_i32 s52, 0
    s_cbranch_scc1 CK_69_k
    s_sub_u32 s52, s52, 1
    s_sleep 1
    buffer_load_dwordx4 v[136:139], v240, s[36:39], s88 offen offset:0 sc1
    buffer_load_dwordx4 v[140:143], v240, s[36:39], s88 offen offset:1024 sc1
    buffer_load_dwordx4 v[144:147], v240, s[36:39], s88 offen offset:2048 sc1
    buffer_load_dwordx4 v[148:151], v240, s[36:39], s88 offen offset:3072 sc1
    buffer_load_dwordx4 v[152:155], v241, s[36:39], s88 offen offset:0 sc1
    buffer_load_dwordx4 v[156:159], v241, s[36:39], s88 offen offset:1024 sc1
    buffer_load_dwordx4 v[160:163], v241, s[36:39], s88 offen offset:2048 sc1
    buffer_load_dwordx4 v[164:167], v241, s[36:39], s88 offen offset:3072 sc1
    buffer_load_dwordx4 v[168:171], v240, s[36:39], s89 offen offset:0 sc1
    buffer_load_dwordx4 v[172:175], v240, s[36:39], s89 offen offset:1024 sc1
    buffer_load_dwordx4 v[176:179], v240, s[36:39], s89 offen offset:2048 sc1
    buffer_load_dwordx4 v[180:183], v240, s[36:39], s89 offen offset:3072 sc1
    buffer_load_dwordx4 v[184:187], v241, s[36:39], s89 offen offset:0 sc1
    buffer_load_dwordx4 v[188:191], v241, s[36:39], s89 offen offset:1024 sc1
    buffer_load_dwordx4 v[192:195], v241, s[36:39], s89 offen offset:2048 sc1
    buffer_load_dwordx4 v[196:199], v241, s[36:39], s89 offen offset:3072 sc1
    buffer_load_dwordx4 v[200:203], v240, s[36:39], s90 offen offset:0 sc1
    buffer_load_dwordx4 v[204:207], v240, s[36:39], s90 offen offset:1024 sc1
    buffer_load_dwordx4 v[208:211], v240, s[36:39], s90 offen offset:2048 sc1
    buffer_load_dwordx4 v[212:215], v240, s[36:39], s90 offen offset:3072 sc1
    s_waitcnt vmcnt(0)
    v_max_u32 v251, v139, v143
    v_max3_u32 v251, v251, v147, v151
    v_cmp_eq_u32 vcc, -1, v251
    s_nop 0
    s_cbranch_vccnz CK_69_r
    s_branch CK_69_k
CK_70_r:
    s_cmp_le_i32 s52, 0
    s_cbranch_scc1 CK_70_k
    s_sub_u32 s52, s52, 1
    s_sleep 1
    buffer_load_dwordx4 v[152:155], v241, s[36:39], s88 offen offset:0 sc1
    buffer_load_dwordx4 v[156:159], v241, s[36:39], s88 offen offset:1024 sc1
    buffer_load_dwordx4 v[160:163], v241, s[36:39], s88 offen offset:2048 sc1
    buffer_load_dwordx4 v[164:167], v241, s[36:39], s88 offen offset:3072 sc1
    buffer_load_dwordx4 v[168:171], v240, s[36:39], s89 offen offset:0 sc1
    buffer_load_dwordx4 v[172:175], v240, s[36:39], s89 offen offset:1024 sc1
    buffer_load_dwordx4 v[176:179], v240, s[36:39], s89 offen offset:2048 sc1
    buffer_load_dwordx4 v[180:183], v240, s[36:39], s89 offen offset:3072 sc1
    buffer_load_dwordx4 v[184:187], v241, s[36:39], s89 offen offset:0 sc1
    buffer_load_dwordx4 v[188:191], v241, s[36:39], s89 offen offset:1024 sc1
    buffer_load_dwordx4 v[192:195], v241, s[36:39], s89 offen offset:2048 sc1
    buffer_load_dwordx4 v[196:199], v241, s[36:39], s89 offen offset:3072 sc1
    buffer_load_dwordx4 v[200:203], v240, s[36:39], s90 offen offset:0 sc1
    buffer_load_dwordx4 v[204:207], v240, s[36:39], s90 offen offset:1024 sc1
    buffer_load_dwordx4 v[208:211], v240, s[36:39], s90 offen offset:2048 sc1
    buffer_load_dwordx4 v[212:215], v240, s[36:39], s90 offen offset:3072 sc1
    s_waitcnt vmcnt(0)
    v_max_u32 v251, v155, v159
    v_max3_u32 v251, v251, v163, v167
    v_cmp_eq_u32 vcc, -1, v251
    s_nop 0
    s_cbranch_vccnz CK_70_r
    s_branch CK_70_k

CC_71_r:
    s_cmp_le_i32 s52, 0
    s_cbranch_scc1 CC_71_k
    s_sub_u32 s52, s52, 1
    s_sleep 8
    buffer_load_dword v252, v253, s[40:43], 0 offen offset:68 sc1
    s_waitcnt vmcnt(0)
    v_cmp_gt_u32 vcc, 32, v252
    s_nop 0
    s_cbranch_vccnz CC_71_r
    s_branch CC_71_k

CK_72_r:
    s_cmp_le_i32 s52, 0
    s_cbranch_scc1 CK_72_k
    s_sub_u32 s52, s52, 1
    s_sleep 1
    s_nop 0
    buffer_load_dwordx4 v[168:171], v240, s[36:39], s89 offen offset:0 sc1
    buffer_load_dwordx4 v[172:175], v240, s[36:39], s89 offen offset:1024 sc1
    buffer_load_dwordx4 v[176:179], v240, s[36:39], s89 offen offset:2048 sc1
    buffer_load_dwordx4 v[180:183], v240, s[36:39], s89 offen offset:3072 sc1
    buffer_load_dwordx4 v[184:187], v241, s[36:39], s89 offen offset:0 sc1
    buffer_load_dwordx4 v[188:191], v241, s[36:39], s89 offen offset:1024 sc1
    buffer_load_dwordx4 v[192:195], v241, s[36:39], s89 offen offset:2048 sc1
    buffer_load_dwordx4 v[196:199], v241, s[36:39], s89 offen offset:3072 sc1
    buffer_load_dwordx4 v[200:203], v240, s[36:39], s90 offen offset:0 sc1
    buffer_load_dwordx4 v[204:207], v240, s[36:39], s90 offen offset:1024 sc1
    buffer_load_dwordx4 v[208:211], v240, s[36:39], s90 offen offset:2048 sc1
    buffer_load_dwordx4 v[212:215], v240, s[36:39], s90 offen offset:3072 sc1
    s_waitcnt vmcnt(0)
    v_max_u32 v251, v171, v175
    v_max3_u32 v251, v251, v179, v183
    v_cmp_eq_u32 vcc, -1, v251
    s_nop 0
    s_cbranch_vccnz CK_72_r
    s_branch CK_72_k
CK_73_r:
    s_cmp_le_i32 s52, 0
    s_cbranch_scc1 CK_73_k
    s_sub_u32 s52, s52, 1
    s_sleep 1
    buffer_load_dwordx4 v[184:187], v241, s[36:39], s89 offen offset:0 sc1
    buffer_load_dwordx4 v[188:191], v241, s[36:39], s89 offen offset:1024 sc1
    buffer_load_dwordx4 v[192:195], v241, s[36:39], s89 offen offset:2048 sc1
    buffer_load_dwordx4 v[196:199], v241, s[36:39], s89 offen offset:3072 sc1
    buffer_load_dwordx4 v[200:203], v240, s[36:39], s90 offen offset:0 sc1
    buffer_load_dwordx4 v[204:207], v240, s[36:39], s90 offen offset:1024 sc1
    buffer_load_dwordx4 v[208:211], v240, s[36:39], s90 offen offset:2048 sc1
    buffer_load_dwordx4 v[212:215], v240, s[36:39], s90 offen offset:3072 sc1
    buffer_load_dwordx4 v[104:107], v241, s[36:39], s90 offen offset:0 sc1
    buffer_load_dwordx4 v[108:111], v241, s[36:39], s90 offen offset:1024 sc1
    buffer_load_dwordx4 v[112:115], v241, s[36:39], s90 offen offset:2048 sc1
    buffer_load_dwordx4 v[116:119], v241, s[36:39], s90 offen offset:3072 sc1
    s_waitcnt vmcnt(0)
    v_max_u32 v251, v187, v191
    v_max3_u32 v251, v251, v195, v199
    v_cmp_eq_u32 vcc, -1, v251
    s_nop 0
    s_cbranch_vccnz CK_73_r
    s_branch CK_73_k
CK_74_r:
    s_cmp_le_i32 s52, 0
    s_cbranch_scc1 CK_74_k
    s_sub_u32 s52, s52, 1
    s_sleep 1
    buffer_load_dwordx4 v[200:203], v240, s[36:39], s90 offen offset:0 sc1
    buffer_load_dwordx4 v[204:207], v240, s[36:39], s90 offen offset:1024 sc1
    buffer_load_dwordx4 v[208:211], v240, s[36:39], s90 offen offset:2048 sc1
    buffer_load_dwordx4 v[212:215], v240, s[36:39], s90 offen offset:3072 sc1
    buffer_load_dwordx4 v[104:107], v241, s[36:39], s90 offen offset:0 sc1
    buffer_load_dwordx4 v[108:111], v241, s[36:39], s90 offen offset:1024 sc1
    buffer_load_dwordx4 v[112:115], v241, s[36:39], s90 offen offset:2048 sc1
    buffer_load_dwordx4 v[116:119], v241, s[36:39], s90 offen offset:3072 sc1
    buffer_load_dwordx4 v[120:123], v240, s[36:39], s91 offen offset:0 sc1
    buffer_load_dwordx4 v[124:127], v240, s[36:39], s91 offen offset:1024 sc1
    buffer_load_dwordx4 v[128:131], v240, s[36:39], s91 offen offset:2048 sc1
    buffer_load_dwordx4 v[132:135], v240, s[36:39], s91 offen offset:3072 sc1
    s_waitcnt vmcnt(0)
    v_max_u32 v251, v203, v207
    v_max3_u32 v251, v251, v211, v215
    v_cmp_eq_u32 vcc, -1, v251
    s_nop 0
    s_cbranch_vccnz CK_74_r
    s_branch CK_74_k
CK_75_r:
    s_cmp_le_i32 s52, 0
    s_cbranch_scc1 CK_75_k
    s_sub_u32 s52, s52, 1
    s_sleep 1
    buffer_load_dwordx4 v[104:107], v241, s[36:39], s90 offen offset:0 sc1
    buffer_load_dwordx4 v[108:111], v241, s[36:39], s90 offen offset:1024 sc1
    buffer_load_dwordx4 v[112:115], v241, s[36:39], s90 offen offset:2048 sc1
    buffer_load_dwordx4 v[116:119], v241, s[36:39], s90 offen offset:3072 sc1
    buffer_load_dwordx4 v[120:123], v240, s[36:39], s91 offen offset:0 sc1
    buffer_load_dwordx4 v[124:127], v240, s[36:39], s91 offen offset:1024 sc1
    buffer_load_dwordx4 v[128:131], v240, s[36:39], s91 offen offset:2048 sc1
    buffer_load_dwordx4 v[132:135], v240, s[36:39], s91 offen offset:3072 sc1
    buffer_load_dwordx4 v[136:139], v240, s[36:39], s92 offen offset:0 sc1
    buffer_load_dwordx4 v[140:143], v240, s[36:39], s92 offen offset:1024 sc1
    buffer_load_dwordx4 v[144:147], v240, s[36:39], s92 offen offset:2048 sc1
    buffer_load_dwordx4 v[148:151], v240, s[36:39], s92 offen offset:3072 sc1
    s_waitcnt vmcnt(0)
    v_max_u32 v251, v107, v111
    v_max3_u32 v251, v251, v115, v119
    v_cmp_eq_u32 vcc, -1, v251
    s_nop 0
    s_cbranch_vccnz CK_75_r
    s_branch CK_75_k
CK_76_r:
    s_cmp_le_i32 s52, 0
    s_cbranch_scc1 CK_76_k
    s_sub_u32 s52, s52, 1
    s_sleep 1
    buffer_load_dwordx4 v[120:123], v240, s[36:39], s91 offen offset:0 sc1
    buffer_load_dwordx4 v[124:127], v240, s[36:39], s91 offen offset:1024 sc1
    buffer_load_dwordx4 v[128:131], v240, s[36:39], s91 offen offset:2048 sc1
    buffer_load_dwordx4 v[132:135], v240, s[36:39], s91 offen offset:3072 sc1
    buffer_load_dwordx4 v[136:139], v240, s[36:39], s92 offen offset:0 sc1
    buffer_load_dwordx4 v[140:143], v240, s[36:39], s92 offen offset:1024 sc1
    buffer_load_dwordx4 v[144:147], v240, s[36:39], s92 offen offset:2048 sc1
    buffer_load_dwordx4 v[148:151], v240, s[36:39], s92 offen offset:3072 sc1
    buffer_load_dwordx4 v[152:155], v241, s[36:39], s92 offen offset:0 sc1
    buffer_load_dwordx4 v[156:159], v241, s[36:39], s92 offen offset:1024 sc1
    buffer_load_dwordx4 v[160:163], v241, s[36:39], s92 offen offset:2048 sc1
    buffer_load_dwordx4 v[164:167], v241, s[36:39], s92 offen offset:3072 sc1
    s_waitcnt vmcnt(0)
    v_max_u32 v251, v123, v127
    v_max3_u32 v251, v251, v131, v135
    v_cmp_eq_u32 vcc, -1, v251
    s_nop 0
    s_cbranch_vccnz CK_76_r
    s_branch CK_76_k
CK_77_r:
    s_cmp_le_i32 s52, 0
    s_cbranch_scc1 CK_77_k
    s_sub_u32 s52, s52, 1
    s_sleep 1
    buffer_load_dwordx4 v[136:139], v240, s[36:39], s92 offen offset:0 sc1
    buffer_load_dwordx4 v[140:143], v240, s[36:39], s92 offen offset:1024 sc1
    buffer_load_dwordx4 v[144:147], v240, s[36:39], s92 offen offset:2048 sc1
    buffer_load_dwordx4 v[148:151], v240, s[36:39], s92 offen offset:3072 sc1
    buffer_load_dwordx4 v[152:155], v241, s[36:39], s92 offen offset:0 sc1
    buffer_load_dwordx4 v[156:159], v241, s[36:39], s92 offen offset:1024 sc1
    buffer_load_dwordx4 v[160:163], v241, s[36:39], s92 offen offset:2048 sc1
    buffer_load_dwordx4 v[164:167], v241, s[36:39], s92 offen offset:3072 sc1
    buffer_load_dwordx4 v[168:171], v240, s[36:39], s93 offen offset:0 sc1
    buffer_load_dwordx4 v[172:175], v240, s[36:39], s93 offen offset:1024 sc1
    buffer_load_dwordx4 v[176:179], v240, s[36:39], s93 offen offset:2048 sc1
    buffer_load_dwordx4 v[180:183], v240, s[36:39], s93 offen offset:3072 sc1
    s_waitcnt vmcnt(0)
    v_max_u32 v251, v139, v143
    v_max3_u32 v251, v251, v147, v151
    v_cmp_eq_u32 vcc, -1, v251
    s_nop 0
    s_cbranch_vccnz CK_77_r
    s_branch CK_77_k
CK_78_r:
    s_cmp_le_i32 s52, 0
    s_cbranch_scc1 CK_78_k
    s_sub_u32 s52, s52, 1
    s_sleep 1
    buffer_load_dwordx4 v[152:155], v241, s[36:39], s92 offen offset:0 sc1
    buffer_load_dwordx4 v[156:159], v241, s[36:39], s92 offen offset:1024 sc1
    buffer_load_dwordx4 v[160:163], v241, s[36:39], s92 offen offset:2048 sc1
    buffer_load_dwordx4 v[164:167], v241, s[36:39], s92 offen offset:3072 sc1
    buffer_load_dwordx4 v[168:171], v240, s[36:39], s93 offen offset:0 sc1
    buffer_load_dwordx4 v[172:175], v240, s[36:39], s93 offen offset:1024 sc1
    buffer_load_dwordx4 v[176:179], v240, s[36:39], s93 offen offset:2048 sc1
    buffer_load_dwordx4 v[180:183], v240, s[36:39], s93 offen offset:3072 sc1
    buffer_load_dwordx4 v[184:187], v241, s[36:39], s93 offen offset:0 sc1
    buffer_load_dwordx4 v[188:191], v241, s[36:39], s93 offen offset:1024 sc1
    buffer_load_dwordx4 v[192:195], v241, s[36:39], s93 offen offset:2048 sc1
    buffer_load_dwordx4 v[196:199], v241, s[36:39], s93 offen offset:3072 sc1
    s_waitcnt vmcnt(0)
    v_max_u32 v251, v155, v159
    v_max3_u32 v251, v251, v163, v167
    v_cmp_eq_u32 vcc, -1, v251
    s_nop 0
    s_cbranch_vccnz CK_78_r
    s_branch CK_78_k
CK_79_r:
    s_cmp_le_i32 s52, 0
    s_cbranch_scc1 CK_79_k
    s_sub_u32 s52, s52, 1
    s_sleep 1
    buffer_load_dwordx4 v[168:171], v240, s[36:39], s93 offen offset:0 sc1
    buffer_load_dwordx4 v[172:175], v240, s[36:39], s93 offen offset:1024 sc1
    buffer_load_dwordx4 v[176:179], v240, s[36:39], s93 offen offset:2048 sc1
    buffer_load_dwordx4 v[180:183], v240, s[36:39], s93 offen offset:3072 sc1
    buffer_load_dwordx4 v[184:187], v241, s[36:39], s93 offen offset:0 sc1
    buffer_load_dwordx4 v[188:191], v241, s[36:39], s93 offen offset:1024 sc1
    buffer_load_dwordx4 v[192:195], v241, s[36:39], s93 offen offset:2048 sc1
    buffer_load_dwordx4 v[196:199], v241, s[36:39], s93 offen offset:3072 sc1
    buffer_load_dwordx4 v[200:203], v240, s[36:39], s94 offen offset:0 sc1
    buffer_load_dwordx4 v[204:207], v240, s[36:39], s94 offen offset:1024 sc1
    buffer_load_dwordx4 v[208:211], v240, s[36:39], s94 offen offset:2048 sc1
    buffer_load_dwordx4 v[212:215], v240, s[36:39], s94 offen offset:3072 sc1
    s_waitcnt vmcnt(0)
    v_max_u32 v251, v171, v175
    v_max3_u32 v251, v251, v179, v183
    v_cmp_eq_u32 vcc, -1, v251
    s_nop 0
    s_cbranch_vccnz CK_79_r
    s_branch CK_79_k
CK_80_r:
    s_cmp_le_i32 s52, 0
    s_cbranch_scc1 CK_80_k
    s_sub_u32 s52, s52, 1
    s_sleep 1
    buffer_load_dwordx4 v[184:187], v241, s[36:39], s93 offen offset:0 sc1
    buffer_load_dwordx4 v[188:191], v241, s[36:39], s93 offen offset:1024 sc1
    buffer_load_dwordx4 v[192:195], v241, s[36:39], s93 offen offset:2048 sc1
    buffer_load_dwordx4 v[196:199], v241, s[36:39], s93 offen offset:3072 sc1
    buffer_load_dwordx4 v[200:203], v240, s[36:39], s94 offen offset:0 sc1
    buffer_load_dwordx4 v[204:207], v240, s[36:39], s94 offen offset:1024 sc1
    buffer_load_dwordx4 v[208:211], v240, s[36:39], s94 offen offset:2048 sc1
    buffer_load_dwordx4 v[212:215], v240, s[36:39], s94 offen offset:3072 sc1
    buffer_load_dwordx4 v[104:107], v241, s[36:39], s94 offen offset:0 sc1
    buffer_load_dwordx4 v[108:111], v241, s[36:39], s94 offen offset:1024 sc1
    buffer_load_dwordx4 v[112:115], v241, s[36:39], s94 offen offset:2048 sc1
    buffer_load_dwordx4 v[116:119], v241, s[36:39], s94 offen offset:3072 sc1
    s_waitcnt vmcnt(0)
    v_max_u32 v251, v187, v191
    v_max3_u32 v251, v251, v195, v199
    v_cmp_eq_u32 vcc, -1, v251
    s_nop 0
    s_cbranch_vccnz CK_80_r
    s_branch CK_80_k
CK_81_r:
    s_cmp_le_i32 s52, 0
    s_cbranch_scc1 CK_81_k
    s_sub_u32 s52, s52, 1
    s_sleep 1
    buffer_load_dwordx4 v[200:203], v240, s[36:39], s94 offen offset:0 sc1
    buffer_load_dwordx4 v[204:207], v240, s[36:39], s94 offen offset:1024 sc1
    buffer_load_dwordx4 v[208:211], v240, s[36:39], s94 offen offset:2048 sc1
    buffer_load_dwordx4 v[212:215], v240, s[36:39], s94 offen offset:3072 sc1
    buffer_load_dwordx4 v[104:107], v241, s[36:39], s94 offen offset:0 sc1
    buffer_load_dwordx4 v[108:111], v241, s[36:39], s94 offen offset:1024 sc1
    buffer_load_dwordx4 v[112:115], v241, s[36:39], s94 offen offset:2048 sc1
    buffer_load_dwordx4 v[116:119], v241, s[36:39], s94 offen offset:3072 sc1
    buffer_load_dwordx4 v[120:123], v240, s[36:39], s95 offen offset:0 sc1
    buffer_load_dwordx4 v[124:127], v240, s[36:39], s95 offen offset:1024 sc1
    buffer_load_dwordx4 v[128:131], v240, s[36:39], s95 offen offset:2048 sc1
    buffer_load_dwordx4 v[132:135], v240, s[36:39], s95 offen offset:3072 sc1
    s_waitcnt vmcnt(0)
    v_max_u32 v251, v203, v207
    v_max3_u32 v251, v251, v211, v215
    v_cmp_eq_u32 vcc, -1, v251
    s_nop 0
    s_cbranch_vccnz CK_81_r
    s_branch CK_81_k
CK_82_r:
    s_cmp_le_i32 s52, 0
    s_cbranch_scc1 CK_82_k
    s_sub_u32 s52, s52, 1
    s_sleep 1
    buffer_load_dwordx4 v[104:107], v241, s[36:39], s94 offen offset:0 sc1
    buffer_load_dwordx4 v[108:111], v241, s[36:39], s94 offen offset:1024 sc1
    buffer_load_dwordx4 v[112:115], v241, s[36:39], s94 offen offset:2048 sc1
    buffer_load_dwordx4 v[116:119], v241, s[36:39], s94 offen offset:3072 sc1
    buffer_load_dwordx4 v[120:123], v240, s[36:39], s95 offen offset:0 sc1
    buffer_load_dwordx4 v[124:127], v240, s[36:39], s95 offen offset:1024 sc1
    buffer_load_dwordx4 v[128:131], v240, s[36:39], s95 offen offset:2048 sc1
    buffer_load_dwordx4 v[132:135], v240, s[36:39], s95 offen offset:3072 sc1
    s_waitcnt vmcnt(0)
    v_max_u32 v251, v107, v111
    v_max3_u32 v251, v251, v115, v119
    v_cmp_eq_u32 vcc, -1, v251
    s_nop 0
    s_cbranch_vccnz CK_82_r
    s_branch CK_82_k
CK_83_r:
    s_cmp_le_i32 s52, 0
    s_cbranch_scc1 CK_83_k
    s_sub_u32 s52, s52, 1
    s_sleep 1
    buffer_load_dwordx4 v[120:123], v240, s[36:39], s95 offen offset:0 sc1
    buffer_load_dwordx4 v[124:127], v240, s[36:39], s95 offen offset:1024 sc1
    buffer_load_dwordx4 v[128:131], v240, s[36:39], s95 offen offset:2048 sc1
    buffer_load_dwordx4 v[132:135], v240, s[36:39], s95 offen offset:3072 sc1
    s_waitcnt vmcnt(0)
    v_max_u32 v251, v123, v127
    v_max3_u32 v251, v251, v131, v135
    v_cmp_eq_u32 vcc, -1, v251
    s_nop 0
    s_cbranch_vccnz CK_83_r
    s_branch CK_83_k
B_22_skip:

    s_lshl_b32 s63, s47, 1
    s_add_u32 s63, s63, s54
    v_lshlrev_b32 v3, 1, v243
    s_lshl_b32 s56, s63, 6
    buffer_load_ushort v254, v3, s[28:31], s56 offen
    s_mul_i32 s62, s46, 229376
    s_mul_i32 s56, s3, 28672
    s_add_u32 s62, s62, s56
    s_add_u32 s62, s62, s51
    s_add_u32 s62, s62, 4685824
    s_cmp_eq_u32 s50, 0
    s_cselect_b32 s56, 1, s53
    s_mul_i32 s56, s56, 114688
    s_add_u32 s92, s62, s56
    s_sub_u32 s56, 114688, s56
    s_add_u32 s88, s62, s56

    s_add_u32 s89, s88, 8192
    s_add_u32 s93, s92, 8192
    s_add_u32 s90, s88, 16384
    s_add_u32 s94, s92, 16384
    s_add_u32 s91, s88, 24576
    s_add_u32 s95, s92, 24576

    v_lshrrev_b32 v2, 2, v244
    v_and_b32 v2, 3, v2
    v_mul_u32_u24 v3, 4, v242
    v_add_u32 v2, v2, v3
    v_bfe_u32 v3, v2, 1, 1
    v_xor_b32 v3, s54, v3
    v_lshlrev_b32 v2, 7, v2
    v_lshl_add_u32 v2, v3, 6, v2
    v_lshrrev_b32 v3, 4, v244
    v_and_b32 v3, 1, v3
    v_lshl_add_u32 v2, v3, 5, v2
    v_and_b32_e64 v3, 3, v244
    v_lshl_add_u32 v218, v3, 3, v2
    v_add_u32 v218, s55, v218
    v_xor_b32 v219, 64, v218

    s_mul_i32 s69, s45, 86016
    s_add_u32 s69, s69, 16777216
    s_lshl_b32 s71, s3, 10
    s_lshl_b32 s70, s3, 14
    s_add_u32 s70, s70, s69
    s_add_u32 s69, s69, s71

    s_lshl_b32 s61, s46, 1
    s_add_u32 s61, s61, s53
    s_mul_i32 s64, s63, 28672
    s_lshl_b32 s57, s61, 11
    s_add_u32 s64, s64, s57
    s_add_u32 s64, s64, 12582912
    s_mul_i32 s65, s63, 3584
    s_lshl_b32 s57, s61, 8
    s_add_u32 s65, s65, s57
    s_add_u32 s65, s65, 14417920
    s_mul_i32 s68, s63, 28672
    s_lshl_b32 s57, s61, 6
    s_add_u32 s68, s68, s57
    s_mul_i32 s78, s50, 1048576
    s_add_u32 s78, s78, s73

    s_cmp_eq_u32 s50, 0
    s_cbranch_scc0 B_22_sk1

    v_lshrrev_b32 v13, 2, v244
    v_lshlrev_b32 v13, 12, v13
    v_and_b32 v14, 3, v244
    v_lshl_add_u32 v13, v14, 7, v13
    s_lshr_b32 s56, s2, 3
    s_sub_u32 s56, s56, 21
    s_min_u32 s56, s56, 3
    s_mul_i32 s56, s56, 65536
    s_mul_i32 s57, s3, 1835008
    s_add_u32 s56, s56, s57
    s_and_b32 s57, s2, 7
    s_lshl_b32 s57, s57, 9
    s_add_u32 s56, s56, s57

    s_add_u32 s57, s56, 0
    buffer_load_dword v15, v13, s[20:23], s57 offen
    s_add_u32 s57, s56, 196608
    buffer_load_dword v15, v13, s[20:23], s57 offen
    s_add_u32 s57, s56, 393216
    buffer_load_dword v15, v13, s[20:23], s57 offen
    s_add_u32 s57, s56, 589824
    buffer_load_dword v15, v13, s[20:23], s57 offen
    s_add_u32 m0, s55, 0
    s_add_u32 s58, s73, 0
    buffer_load_dwordx4 v247, s[20:23], s58 offen lds
    s_add_u32 m0, s55, 1024
    s_add_u32 s58, s73, 32768
    buffer_load_dwordx4 v247, s[20:23], s58 offen lds
    s_add_u32 m0, s55, 2048
    s_add_u32 s58, s73, 65536
    buffer_load_dwordx4 v247, s[20:23], s58 offen lds
    s_add_u32 m0, s55, 3072
    s_add_u32 s58, s73, 98304
    buffer_load_dwordx4 v247, s[20:23], s58 offen lds
    s_add_u32 m0, s55, 4096
    s_add_u32 s58, s73, 131072
    buffer_load_dwordx4 v247, s[20:23], s58 offen lds
    s_add_u32 m0, s55, 5120
    s_add_u32 s58, s73, 163840
    buffer_load_dwordx4 v247, s[20:23], s58 offen lds
    s_add_u32 m0, s55, 6144
    s_add_u32 s58, s73, 196608
    buffer_load_dwordx4 v247, s[20:23], s58 offen lds
    s_add_u32 m0, s55, 7168
    s_add_u32 s58, s73, 229376
    buffer_load_dwordx4 v247, s[20:23], s58 offen lds
    s_add_u32 m0, s55, 8192
    s_add_u32 s58, s73, 262144
    buffer_load_dwordx4 v247, s[20:23], s58 offen lds
    s_add_u32 m0, s55, 9216
    s_add_u32 s58, s73, 294912
    buffer_load_dwordx4 v247, s[20:23], s58 offen lds
    s_add_u32 m0, s55, 10240
    s_add_u32 s58, s73, 327680
    buffer_load_dwordx4 v247, s[20:23], s58 offen lds
    s_add_u32 m0, s55, 11264
    s_add_u32 s58, s73, 360448
    buffer_load_dwordx4 v247, s[20:23], s58 offen lds
    s_add_u32 m0, s55, 12288
    s_add_u32 s58, s73, 393216
    buffer_load_dwordx4 v247, s[20:23], s58 offen lds
    s_add_u32 m0, s55, 13312
    s_add_u32 s58, s73, 425984
    buffer_load_dwordx4 v247, s[20:23], s58 offen lds
    s_add_u32 m0, s55, 14336
    s_add_u32 s58, s73, 458752
    buffer_load_dwordx4 v247, s[20:23], s58 offen lds
    s_add_u32 m0, s55, 15360
    s_add_u32 s58, s73, 491520
    buffer_load_dwordx4 v247, s[20:23], s58 offen lds
    s_add_u32 m0, s55, 32768
    s_add_u32 s58, s73, 524288
    buffer_load_dwordx4 v247, s[20:23], s58 offen lds
    s_add_u32 m0, s55, 33792
    s_add_u32 s58, s73, 557056
    buffer_load_dwordx4 v247, s[20:23], s58 offen lds
    s_add_u32 m0, s55, 34816
    s_add_u32 s58, s73, 589824
    buffer_load_dwordx4 v247, s[20:23], s58 offen lds
    s_add_u32 m0, s55, 35840
    s_add_u32 s58, s73, 622592
    buffer_load_dwordx4 v247, s[20:23], s58 offen lds
    s_add_u32 m0, s55, 36864
    s_add_u32 s58, s73, 655360
    buffer_load_dwordx4 v247, s[20:23], s58 offen lds
    s_add_u32 m0, s55, 37888
    s_add_u32 s58, s73, 688128
    buffer_load_dwordx4 v247, s[20:23], s58 offen lds
    s_add_u32 m0, s55, 38912
    s_add_u32 s58, s73, 720896
    buffer_load_dwordx4 v247, s[20:23], s58 offen lds
    s_add_u32 m0, s55, 39936
    s_add_u32 s58, s73, 753664
    buffer_load_dwordx4 v247, s[20:23], s58 offen lds
    s_add_u32 m0, s55, 40960
    s_add_u32 s58, s73, 786432
    buffer_load_dwordx4 v247, s[20:23], s58 offen lds
    s_add_u32 m0, s55, 41984
    s_add_u32 s58, s73, 819200
    buffer_load_dwordx4 v247, s[20:23], s58 offen lds
    s_add_u32 m0, s55, 43008
    s_add_u32 s58, s73, 851968
    buffer_load_dwordx4 v247, s[20:23], s58 offen lds
    s_add_u32 m0, s55, 44032
    s_add_u32 s58, s73, 884736
    buffer_load_dwordx4 v247, s[20:23], s58 offen lds
    s_add_u32 m0, s55, 45056
    s_add_u32 s58, s73, 917504
    buffer_load_dwordx4 v247, s[20:23], s58 offen lds
    s_add_u32 m0, s55, 46080
    s_add_u32 s58, s73, 950272
    buffer_load_dwordx4 v247, s[20:23], s58 offen lds
    s_add_u32 m0, s55, 47104
    s_add_u32 s58, s73, 983040
    buffer_load_dwordx4 v247, s[20:23], s58 offen lds
    s_add_u32 m0, s55, 48128
    s_add_u32 s58, s73, 1015808
    buffer_load_dwordx4 v247, s[20:23], s58 offen lds
    s_branch B_22_sk2
B_22_sk1:
    s_add_u32 m0, s55, 0
    s_add_u32 s58, s73, 1048576
    buffer_load_dwordx4 v247, s[20:23], s58 offen lds
    s_add_u32 m0, s55, 1024
    s_add_u32 s58, s73, 1081344
    buffer_load_dwordx4 v247, s[20:23], s58 offen lds
    s_add_u32 m0, s55, 2048
    s_add_u32 s58, s73, 1114112
    buffer_load_dwordx4 v247, s[20:23], s58 offen lds
    s_add_u32 m0, s55, 3072
    s_add_u32 s58, s73, 1146880
    buffer_load_dwordx4 v247, s[20:23], s58 offen lds
    s_add_u32 m0, s55, 4096
    s_add_u32 s58, s73, 1179648
    buffer_load_dwordx4 v247, s[20:23], s58 offen lds
    s_add_u32 m0, s55, 5120
    s_add_u32 s58, s73, 1212416
    buffer_load_dwordx4 v247, s[20:23], s58 offen lds
    s_add_u32 m0, s55, 6144
    s_add_u32 s58, s73, 1245184
    buffer_load_dwordx4 v247, s[20:23], s58 offen lds
    s_add_u32 m0, s55, 7168
    s_add_u32 s58, s73, 1277952
    buffer_load_dwordx4 v247, s[20:23], s58 offen lds
B_22_sk2:

    v_lshlrev_b32 v3, 6, v244
    s_mov_b64 exec, 1
CW_84_p:
    buffer_load_dword v2, v3, s[40:43], 0 offen offset:4 sc1
    s_waitcnt vmcnt(0)
    v_cmp_gt_u32 vcc, 32, v2
    s_nop 0
    s_cbranch_vccz CW_84_o
    s_cmp_le_i32 s52, 0
    s_cbranch_scc1 CW_84_o
    s_sub_u32 s52, s52, 1
    s_sleep 12
    s_branch CW_84_p
CW_84_o:
    s_mov_b64 exec, -1

    v_min_u32 v253, 0, v244
    v_lshlrev_b32 v253, 6, v253
    buffer_load_dword v252, v253, s[40:43], 0 offen offset:68 sc1
    v_min_u32 v4, 27, v244
    v_lshlrev_b32 v4, 10, v4
    v_add_u32 v4, 1020, v4
    s_branch PB_85_q
PB_85_p:
    s_sleep 4
PB_85_q:
    buffer_load_dword v5, v4, s[36:39], s88 offen sc1
    s_sub_u32 s52, s52, 1
PB_85_c:
    s_waitcnt vmcnt(0)
    v_cmp_eq_u32 vcc, -1, v5

    s_cmp_gt_i32 s52, 0
    s_cselect_b64 vcc, vcc, 0
    s_cbranch_vccnz PB_85_p

    buffer_load_dwordx4 v[136:139], v240, s[36:39], s88 offen offset:0 sc1
    buffer_load_dwordx4 v[140:143], v240, s[36:39], s88 offen offset:1024 sc1
    buffer_load_dwordx4 v[144:147], v240, s[36:39], s88 offen offset:2048 sc1
    buffer_load_dwordx4 v[148:151], v240, s[36:39], s88 offen offset:3072 sc1
    buffer_load_dwordx4 v[152:155], v241, s[36:39], s88 offen offset:0 sc1
    buffer_load_dwordx4 v[156:159], v241, s[36:39], s88 offen offset:1024 sc1
    buffer_load_dwordx4 v[160:163], v241, s[36:39], s88 offen offset:2048 sc1
    buffer_load_dwordx4 v[164:167], v241, s[36:39], s88 offen offset:3072 sc1
    buffer_load_dwordx4 v[168:171], v240, s[36:39], s89 offen offset:0 sc1
    buffer_load_dwordx4 v[172:175], v240, s[36:39], s89 offen offset:1024 sc1
    buffer_load_dwordx4 v[176:179], v240, s[36:39], s89 offen offset:2048 sc1
    buffer_load_dwordx4 v[180:183], v240, s[36:39], s89 offen offset:3072 sc1
    buffer_load_dwordx4 v[184:187], v241, s[36:39], s89 offen offset:0 sc1
    buffer_load_dwordx4 v[188:191], v241, s[36:39], s89 offen offset:1024 sc1
    buffer_load_dwordx4 v[192:195], v241, s[36:39], s89 offen offset:2048 sc1
    buffer_load_dwordx4 v[196:199], v241, s[36:39], s89 offen offset:3072 sc1
    buffer_load_dwordx4 v[200:203], v240, s[36:39], s90 offen offset:0 sc1
    buffer_load_dwordx4 v[204:207], v240, s[36:39], s90 offen offset:1024 sc1
    buffer_load_dwordx4 v[208:211], v240, s[36:39], s90 offen offset:2048 sc1
    buffer_load_dwordx4 v[212:215], v240, s[36:39], s90 offen offset:3072 sc1
    s_waitcnt vmcnt(0)
    s_cmp_eq_u32 s50, 0
    s_cbranch_scc1 B_22_e0
    s_branch B_22_e1
CK_86_r:
    s_cmp_le_i32 s52, 0
    s_cbranch_scc1 CK_86_k
    s_sub_u32 s52, s52, 1
    s_sleep 5
    s_add_u32 s58, s62, 0
    s_nop 0
    buffer_load_dwordx2 v[160:161], v245, s[36:39], s58 offen offset:0 sc1
    buffer_load_dwordx2 v[162:163], v245, s[36:39], s58 offen offset:2048 sc1
    s_add_u32 s58, s62, 4096
    buffer_load_dwordx2 v[164:165], v245, s[36:39], s58 offen offset:0 sc1
    buffer_load_dwordx2 v[166:167], v245, s[36:39], s58 offen offset:2048 sc1
    s_add_u32 s58, s62, 8192
    buffer_load_dwordx2 v[168:169], v245, s[36:39], s58 offen offset:0 sc1
    buffer_load_dwordx2 v[170:171], v245, s[36:39], s58 offen offset:2048 sc1
    s_add_u32 s58, s62, 12288
    buffer_load_dwordx2 v[172:173], v245, s[36:39], s58 offen offset:0 sc1
    buffer_load_dwordx2 v[174:175], v245, s[36:39], s58 offen offset:2048 sc1
    s_add_u32 s58, s62, 16384
    buffer_load_dwordx2 v[176:177], v245, s[36:39], s58 offen offset:0 sc1
    buffer_load_dwordx2 v[178:179], v245, s[36:39], s58 offen offset:2048 sc1
    s_add_u32 s58, s62, 20480
    buffer_load_dwordx2 v[180:181], v245, s[36:39], s58 offen offset:0 sc1
    buffer_load_dwordx2 v[182:183], v245, s[36:39], s58 offen offset:2048 sc1
    s_add_u32 s58, s62, 24576
    buffer_load_dwordx2 v[184:185], v245, s[36:39], s58 offen offset:0 sc1
    buffer_load_dwordx2 v[186:187], v245, s[36:39], s58 offen offset:2048 sc1
    s_add_u32 s58, s62, 28672
    buffer_load_dwordx2 v[188:189], v245, s[36:39], s58 offen offset:0 sc1
    buffer_load_dwordx2 v[190:191], v245, s[36:39], s58 offen offset:2048 sc1
    s_waitcnt vmcnt(0)
    v_max_u32 v251, v161, v163
    v_max3_u32 v251, v251, v165, v167
    v_max3_u32 v251, v251, v169, v171
    v_max3_u32 v251, v251, v173, v175
    v_max3_u32 v251, v251, v177, v179
    v_max3_u32 v251, v251, v181, v183
    v_max3_u32 v251, v251, v185, v187
    v_max3_u32 v251, v251, v189, v191
    v_cmp_eq_u32 vcc, -1, v251
    s_nop 0
    s_cbranch_vccnz CK_86_r
    s_branch CK_86_k
LS_87_g:
    buffer_store_dwordx4 v[176:179], v240, s[36:39], s63 offen sc1
    buffer_store_dwordx4 v[180:183], v240, s[36:39], s63 offen offset:1024 sc1
    s_branch LS_87_r
LS_92_g:
    buffer_store_dwordx4 v[8:11], v240, s[36:39], s57 offen sc1
    s_branch LS_92_r
LS_94_g:
    buffer_store_dwordx4 v[8:11], v240, s[36:39], s57 offen sc1
    s_branch LS_94_r
LS_100_g:
    buffer_store_dwordx4 v[8:11], v240, s[36:39], s57 offen sc1
    s_branch LS_100_r
LS_102_g:
    buffer_store_dwordx4 v[8:11], v240, s[36:39], s57 offen sc1
    s_branch LS_102_r
L_codeend:
.section .rodata,"a"
.p2align 6
.amdhsa_kernel interleave_layers__linear_attn_block__mixer_token_mlp__prompt_kernel
  .amdhsa_next_free_vgpr 512
  .amdhsa_next_free_sgpr 102
  .amdhsa_accum_offset 256
  .amdhsa_group_segment_fixed_size 0
  .amdhsa_kernarg_size 88
  .amdhsa_user_sgpr_count 2
  .amdhsa_user_sgpr_kernarg_segment_ptr 1
  .amdhsa_system_sgpr_workgroup_id_x 1
.end_amdhsa_kernel
```
